```python
import torch

def _softmax(x, axis=-1):
    return torch.softmax(x, dim=axis)
def _gelu(x):
    return torch.nn.functional.gelu(x, approximate="tanh")
def _silu(x):
    return torch.nn.functional.silu(x)
def _sigmoid(x):
    return torch.sigmoid(x)
def _layernorm(x, axis=-1, eps=1e-5):
    m = x.mean(dim=axis, keepdim=True)
    v = x.var(dim=axis, keepdim=True, unbiased=False)
    return (x - m) / torch.sqrt(v + eps)
def _scatter_add(tgt, idx, src, axis=0):
    return tgt.clone().index_add_(axis, idx, src)
def _segment_sum(src, seg, n):
    out = torch.zeros((n,) + src.shape[1:], dtype=src.dtype)
    return out.index_add_(0, seg, src)
def _pad(x, pw):
    flat = tuple(v for pair in reversed(pw) for v in pair)
    return torch.nn.functional.pad(x, flat)

kernel_name = 'standalone__mha_softmax__near_ridge'

def setup_inputs():

    _w = (lambda a: (lambda t: t.to(torch.bfloat16) if t.is_floating_point() else t)(torch.as_tensor(a)))
    B, H, Sq, Sk, D = 8, 32, 736, 512, 128
    return {
        "q": _w((lambda *s: torch.randn(*s, dtype=torch.bfloat16) * 0.8)(B, H, Sq, D)),
        "k": _w((lambda *s: torch.randn(*s, dtype=torch.bfloat16) * 0.8)(B, H, Sk, D)),
        "v": _w((lambda *s: torch.randn(*s, dtype=torch.bfloat16) * 0.05)(B, H, Sk, D)),
    }

def reference(q, k, v):
    scale = q.shape[-1] ** -0.5
    scores = torch.einsum("bhqd,bhkd->bhqk", q, k) * scale
    p = _softmax(scores, axis=-1)
    return torch.einsum("bhqk,bhkd->bhqd", p, v)
```

```asm
; @launch grid=(256,1,1) block=(256,1,1) lds=163840
.amdgcn_target "amdgcn-amd-amdhsa--gfx950"
.text
.globl standalone__mha_softmax__near_ridge_kernel
.p2align 8
.type standalone__mha_softmax__near_ridge_kernel,@function
standalone__mha_softmax__near_ridge_kernel:
    s_load_dwordx2 s[4:5], s[0:1], 8
    s_load_dwordx2 s[12:13], s[0:1], 0
    s_cmp_ge_u32 s2, 256
    s_cbranch_scc1 L_end
    s_getpc_b64 s[76:77]
L_pc:
    s_mov_b32 s78, L_slow_item-L_pc
    s_mov_b32 s79, 0x00020000
    s_lshr_b32 s62, s2, 3
    s_lshl_b32 s62, s62, 12
    v_lshl_add_u32 v244, v0, 4, s62
    buffer_load_dwordx4 v[4:7], v244, s[76:79], 0 offen
    v_lshrrev_b32 v240, 6, v0
    v_and_b32 v241, 63, v0
    v_readfirstlane_b32 s29, v240
    s_and_b32 s48, s2, 7
    s_lshr_b32 s49, s2, 3
    s_lshl_b32 s48, s48, 5
    s_mul_i32 s63, s49, 171
    s_lshr_b32 s63, s63, 9
    s_mul_i32 s62, s63, 3
    s_sub_u32 s62, s49, s62
    s_add_u32 s63, s63, s48
    s_lshl_b32 s30, s63, 17
    v_and_b32 v242, 15, v241
    v_lshrrev_b32 v243, 4, v241
    v_lshlrev_b32 v244, 12, v243
    v_lshl_add_u32 v252, v242, 4, v244
    v_lshl_add_u32 v236, v240, 10, v252
    s_mul_i32 s60, s29, 4224
    s_mov_b32 s6, 33554432
    s_mov_b32 s7, 0x00020000
    s_waitcnt lgkmcnt(0)
    s_add_u32 s40, s30, 0
    s_add_u32 m0, s60, 0
    s_nop 0
    buffer_load_dwordx4 v236, s[4:7], s40 offen offset:0 nt lds
    s_add_u32 m0, s60, 800
    s_nop 0
    buffer_load_dwordx4 v236, s[4:7], s40 offen offset:256 nt lds
    s_add_u32 m0, s60, 1600
    s_nop 0
    buffer_load_dwordx4 v236, s[4:7], s40 offen offset:512 nt lds
    s_add_u32 m0, s60, 2400
    s_nop 0
    buffer_load_dwordx4 v236, s[4:7], s40 offen offset:768 nt lds
    s_load_dwordx2 s[8:9], s[0:1], 16
    s_load_dwordx2 s[20:21], s[0:1], 24
    s_mul_i32 s33, s63, 188416
    s_lshl_b32 s62, s62, 2
    s_add_u32 s62, s62, s29
    s_cmp_eq_u32 s62, 11
    s_cselect_b32 s36, 0, 48234496
    s_lshl_b32 s62, s62, 14
    s_add_u32 s33, s33, s62
    v_lshrrev_b32 v245, 2, v241
    v_and_b32 v246, 3, v241
    v_lshrrev_b32 v244, 3, v241
    v_and_b32 v247, 7, v241
    v_xor_b32 v247, v247, v244
    v_lshlrev_b32 v244, 8, v244
    v_lshl_add_u32 v238, v247, 4, v244
    s_mov_b32 s14, 48234496
    s_mov_b32 s15, 0x00020000
    s_add_u32 s56, s33, 0
    s_add_u32 s57, s33, 4096
    s_add_u32 s58, s33, 8192
    s_add_u32 s59, s33, 12288
    s_add_u32 m0, s60, 101376
    s_nop 0
    buffer_load_dwordx4 v238, s[12:15], s56 offen offset:0 nt lds
    s_add_u32 m0, s60, 100352
    s_nop 0
    buffer_load_dwordx4 v238, s[12:15], s56 offen offset:2048 nt lds
    s_add_u32 m0, s60, 103296
    s_nop 0
    buffer_load_dwordx4 v238, s[12:15], s56 offen offset:128 nt lds
    s_add_u32 m0, s60, 102272
    s_nop 0
    buffer_load_dwordx4 v238, s[12:15], s56 offen offset:2176 nt lds
    s_mov_b32 s16, s12
    s_mov_b32 s17, s13
    s_mov_b32 s18, s36
    s_mov_b32 s19, 0x00020000
    s_add_u32 s40, s30, 16384
    s_add_u32 m0, s60, 33792
    s_nop 0
    buffer_load_dwordx4 v236, s[4:7], s40 offen offset:0 nt lds
    s_add_u32 m0, s60, 34592
    s_nop 0
    buffer_load_dwordx4 v236, s[4:7], s40 offen offset:256 nt lds
    s_mov_b32 s28, 1040356334
    s_mov_b32 s64, 1040356334
    s_mov_b32 s65, 1040356334
    s_mov_b32 s51, 3187839982
    v_mul_u32_u24 v244, 1056, v242
    v_lshl_add_u32 v232, v243, 4, v244
    v_add_u32 v233, 67584, v232
    v_mul_u32_u24 v244, 1056, v245
    v_lshl_add_u32 v244, v246, 3, v244
    v_add_u32 v234, 16896, v244
    v_add_u32 v235, 67584, v234
    s_mul_i32 s68, s29, 7168
    s_add_u32 s68, s68, 135168
    v_and_b32 v247, 7, v241
    v_lshrrev_b32 v244, 1, v243
    v_xor_b32 v244, v244, v247
    v_lshlrev_b32 v244, 4, v244
    v_lshl_add_u32 v244, v242, 7, v244
    v_lshrrev_b32 v240, 3, v242
    v_xor_b32 v240, v240, v243
    v_and_b32 v240, 1, v240
    v_lshl_add_u32 v244, v240, 3, v244
    v_add_u32 v248, s68, v244
    v_xor_b32 v249, 32, v248
    v_lshlrev_b32 v244, 4, v241
    v_add_u32 v250, s68, v244
    s_mov_b32 s66, s68
    v_xor_b32 v244, v243, v247
    v_lshlrev_b32 v244, 4, v244
    v_lshl_add_u32 v244, v242, 7, v244
    v_add_u32 v237, s68, v244
    v_xor_b32 v252, 64, v237
    s_add_u32 s68, s60, 101376
    v_add_u32 v251, s68, v244
    v_xor_b32 v246, 64, v251
    s_add_u32 s68, s60, 16896
    v_add_u32 v244, s68, v244
    v_xor_b32 v245, 64, v244
    v_lshrrev_b32 v242, 5, v241
    v_bfe_u32 v240, v241, 1, 1
    v_cmp_eq_u32 vcc, v242, v240
    v_mov_b32 v243, 0x3f803f80
    v_and_b32 v240, 3, v241
    v_cndmask_b32 v242, 0, v243, vcc
    v_accvgpr_write_b32 a184, v242
    v_accvgpr_write_b32 a185, v242
    v_accvgpr_write_b32 a186, v242
    v_accvgpr_write_b32 a187, v242
    v_cmp_eq_u32 vcc, 0, v240
    v_accvgpr_write_b32 a176, 0
    v_accvgpr_write_b32 a177, 0
    v_accvgpr_write_b32 a178, 0
    v_accvgpr_write_b32 a179, 0
    v_cndmask_b32 v228, 0, v243, vcc
    v_cndmask_b32 v229, 0, v243, vcc
    v_cndmask_b32 v230, 0, v243, vcc
    v_cndmask_b32 v231, 0, v243, vcc
    v_cmp_eq_u32 vcc, 2, v240
    v_accvgpr_write_b32 a180, 0
    v_accvgpr_write_b32 a181, 0
    v_accvgpr_write_b32 a182, 0
    v_accvgpr_write_b32 a183, 0
    v_cndmask_b32 v242, 0, v243, vcc
    v_accvgpr_write_b32 a188, v242
    v_accvgpr_write_b32 a189, v242
    v_accvgpr_write_b32 a190, v242
    v_accvgpr_write_b32 a191, v242
    v_and_b32 v247, 1, v241
    v_mul_u32_u24 v247, 0xaaaa, v247
    v_add_u32 v247, 0x4444, v247
    s_add_u32 m0, s60, 35392
    s_nop 0
    buffer_load_dwordx4 v236, s[4:7], s40 offen offset:512 nt lds
    s_add_u32 m0, s60, 36192
    s_nop 0
    buffer_load_dwordx4 v236, s[4:7], s40 offen offset:768 nt lds
    s_waitcnt lgkmcnt(0)
    s_mov_b32 s10, 33554432
    s_mov_b32 s11, 0x00020000
    s_add_u32 s41, s30, 0
    s_add_u32 m0, s60, 50688
    s_nop 0
    buffer_load_dwordx4 v236, s[8:11], s41 offen offset:0 nt lds
    s_add_u32 m0, s60, 51488
    s_nop 0
    buffer_load_dwordx4 v236, s[8:11], s41 offen offset:256 nt lds
    s_add_u32 m0, s60, 52288
    s_nop 0
    buffer_load_dwordx4 v236, s[8:11], s41 offen offset:512 nt lds
    s_add_u32 m0, s60, 53088
    s_nop 0
    buffer_load_dwordx4 v236, s[8:11], s41 offen offset:768 nt lds
    s_waitcnt vmcnt(12)
    s_barrier
    ds_read_b128 a[128:131], v232 offset:0
    ds_read_b128 a[132:135], v232 offset:64
    ds_read_b128 a[136:139], v232 offset:128
    ds_read_b128 a[140:143], v232 offset:192
    ds_read_b128 a[144:147], v232 offset:256
    ds_read_b128 a[148:151], v232 offset:320
    ds_read_b128 a[152:155], v232 offset:384
    ds_read_b128 a[156:159], v232 offset:448
    ds_read_b128 a[160:163], v232 offset:512
    ds_read_b128 a[164:167], v232 offset:576
    ds_read_b128 a[168:171], v232 offset:640
    ds_read_b128 a[172:175], v232 offset:704
    ds_read_b128 v[96:99], v232 offset:768
    ds_read_b128 v[100:103], v232 offset:832
    ds_read_b128 v[104:107], v232 offset:896
    ds_read_b128 v[108:111], v232 offset:960
    s_add_u32 m0, s60, 118272
    s_nop 0
    buffer_load_dwordx4 v238, s[12:15], s57 offen offset:0 nt lds
    s_add_u32 m0, s60, 117248
    s_nop 0
    buffer_load_dwordx4 v238, s[12:15], s57 offen offset:2048 nt lds
    s_add_u32 m0, s60, 120192
    s_nop 0
    buffer_load_dwordx4 v238, s[12:15], s57 offen offset:128 nt lds
    s_add_u32 m0, s60, 119168
    s_nop 0
    buffer_load_dwordx4 v238, s[12:15], s57 offen offset:2176 nt lds
    s_mov_b64 exec, 0
    s_cmp_eq_u32 s29, 0
    s_cbranch_scc1 L_pad0
    s_cmp_eq_u32 s29, 1
    s_cbranch_scc1 L_pad1
    s_cmp_eq_u32 s29, 2
    s_cbranch_scc1 L_pad2
    s_branch L_pad3
L_walk_ret:
    s_mov_b64 exec, -1
    s_waitcnt vmcnt(12)
    ds_read_b128 a[0:3], v251 offset:0
    ds_read_b128 a[4:7], v246 offset:0
    ds_read_b128 a[8:11], v251 offset:2048
    ds_read_b128 a[12:15], v246 offset:2048
    s_branch L_main
    .p2align 12
L_main:
    s_waitcnt lgkmcnt(3)
    v_mfma_f32_16x16x32_bf16 v[128:131], a[128:131], a[0:3], 0
    s_waitcnt lgkmcnt(2)
    v_mfma_f32_16x16x32_bf16 v[128:131], a[132:135], a[4:7], v[128:131]
    s_waitcnt lgkmcnt(1)
    v_mfma_f32_16x16x32_bf16 v[128:131], a[136:139], a[8:11], v[128:131]
    s_add_u32 m0, s60, 16896
L_pad0:
    s_cbranch_execz L_pad4
    s_waitcnt lgkmcnt(0)
    v_mfma_f32_16x16x32_bf16 v[128:131], a[140:143], a[12:15], v[128:131]
    buffer_load_dwordx4 v238, s[16:19], s58 offen offset:0 nt lds
    v_mfma_f32_16x16x32_bf16 v[132:135], a[144:147], a[0:3], 0
    v_mfma_f32_16x16x32_bf16 v[132:135], a[148:151], a[4:7], v[132:135]
    v_mfma_f32_16x16x32_bf16 v[132:135], a[152:155], a[8:11], v[132:135]
    s_nop 3
    v_max3_f32 v240, v128, v129, v130
    v_max_f32 v240, v240, v131
    v_mfma_f32_16x16x32_bf16 v[132:135], a[156:159], a[12:15], v[132:135]
    v_mov_b32 v241, v240
    v_mfma_f32_16x16x32_bf16 v[160:163], a[160:163], a[0:3], 0
    s_nop 0
    v_permlane16_swap_b32 v240, v241
    v_mfma_f32_16x16x32_bf16 v[160:163], a[164:167], a[4:7], v[160:163]
    v_max_f32 v240, v240, v241
    v_mov_b32 v241, v240
    v_mfma_f32_16x16x32_bf16 v[160:163], a[168:171], a[8:11], v[160:163]
    s_add_u32 m0, s60, 15872
    v_permlane32_swap_b32 v240, v241
    v_mfma_f32_16x16x32_bf16 v[160:163], a[172:175], a[12:15], v[160:163]
    buffer_load_dwordx4 v238, s[16:19], s58 offen offset:2048 nt lds
    v_max_f32 v240, v240, v241
    v_mfma_f32_16x16x32_bf16 v[164:167], v[96:99], a[0:3], 0
    v_mul_f32 v224, s51, v240
    v_fma_f32 v128, v128, s28, v224
    v_mfma_f32_16x16x32_bf16 v[164:167], v[100:103], a[4:7], v[164:167]
    s_waitcnt vmcnt(6) lgkmcnt(0)
    s_barrier
    v_fma_f32 v129, v129, s28, v224
    v_fma_f32 v130, v130, s28, v224
    v_exp_f32 v128, v128
    v_mfma_f32_16x16x32_bf16 v[164:167], v[104:107], a[8:11], v[164:167]
    v_exp_f32 v129, v129
    v_fma_f32 v131, v131, s28, v224
    v_exp_f32 v130, v130
    v_exp_f32 v131, v131
    v_mfma_f32_16x16x32_bf16 v[164:167], v[108:111], a[12:15], v[164:167]
    ds_read_b128 a[64:67], v232 offset:33792
    ds_read_b128 a[68:71], v232 offset:33856
    v_cvt_pk_bf16_f32 v192, v128, v129
    v_cvt_pk_bf16_f32 v193, v130, v131
    v_fma_f32 v132, v132, s28, v224
    s_waitcnt lgkmcnt(1)
    v_mfma_f32_16x16x32_bf16 v[128:131], a[64:67], a[0:3], 0
    s_waitcnt lgkmcnt(0)
    ds_read_b128 a[72:75], v232 offset:33920
    ds_read_b128 a[76:79], v232 offset:33984
    v_fma_f32 v133, v133, s28, v224
    v_exp_f32 v132, v132
    v_mfma_f32_16x16x32_bf16 v[128:131], a[68:71], a[4:7], v[128:131]
    s_waitcnt lgkmcnt(1)
    ds_read_b128 a[80:83], v232 offset:34048
    ds_read_b128 a[84:87], v232 offset:34112
    v_fma_f32 v134, v134, s28, v224
    v_exp_f32 v133, v133
    v_fma_f32 v135, v135, s28, v224
    v_mfma_f32_16x16x32_bf16 v[128:131], a[72:75], a[8:11], v[128:131]
    s_add_u32 m0, s60, 18816
    s_waitcnt lgkmcnt(2)
    ds_read_b128 a[88:91], v232 offset:34176
    ds_read_b128 a[92:95], v232 offset:34240
    v_exp_f32 v134, v134
    v_exp_f32 v135, v135
    v_cvt_pk_bf16_f32 v194, v132, v133
    v_mfma_f32_16x16x32_bf16 v[128:131], a[76:79], a[12:15], v[128:131]
    s_waitcnt lgkmcnt(3)
    buffer_load_dwordx4 v238, s[16:19], s58 offen offset:128 nt lds
    ds_read_b64_tr_b16 a[192:193], v234 offset:33792
    ds_read_b64_tr_b16 a[194:195], v234 offset:34048
    v_cvt_pk_bf16_f32 v195, v134, v135
    v_mfma_f32_16x16x32_bf16 v[132:135], a[80:83], a[0:3], 0
    s_waitcnt lgkmcnt(4)
    ds_read_b64_tr_b16 a[196:197], v234 offset:33824
    ds_read_b64_tr_b16 a[198:199], v234 offset:34080
    ds_read_b64_tr_b16 a[200:201], v234 offset:33856
    v_fma_f32 v160, v160, s28, v224
    v_mfma_f32_16x16x32_bf16 v[132:135], a[84:87], a[4:7], v[132:135]
    s_waitcnt lgkmcnt(6)
    ds_read_b64_tr_b16 a[202:203], v234 offset:34112
    ds_read_b64_tr_b16 a[204:205], v234 offset:33888
    v_exp_f32 v160, v160
    v_mfma_f32_16x16x32_bf16 v[132:135], a[88:91], a[8:11], v[132:135]
    s_waitcnt lgkmcnt(7)
    ds_read_b64_tr_b16 a[206:207], v234 offset:34144
    ds_read_b64_tr_b16 a[208:209], v234 offset:33920
    v_fma_f32 v161, v161, s28, v224
    v_mfma_f32_16x16x32_bf16 v[132:135], a[92:95], a[12:15], v[132:135]
    s_waitcnt lgkmcnt(7)
    ds_read_b64_tr_b16 a[210:211], v234 offset:34176
    ds_read_b64_tr_b16 a[212:213], v234 offset:33952
    v_exp_f32 v161, v161
    v_mfma_f32_16x16x32_bf16 v[0:3], a[192:195], v[192:195], 0
    s_waitcnt lgkmcnt(7)
    ds_read_b64_tr_b16 a[214:215], v234 offset:34208
    ds_read_b64_tr_b16 a[216:217], v234 offset:33984
    ds_read_b64_tr_b16 a[218:219], v234 offset:34240
    v_fma_f32 v162, v162, s28, v224
    v_cvt_pk_bf16_f32 v208, v160, v161
    v_mfma_f32_16x16x32_bf16 v[4:7], a[196:199], v[192:195], 0
    s_waitcnt lgkmcnt(8)
    ds_read_b64_tr_b16 a[220:221], v234 offset:34016
    ds_read_b64_tr_b16 a[222:223], v234 offset:34272
    v_exp_f32 v162, v162
    v_fma_f32 v163, v163, s28, v224
    v_mfma_f32_16x16x32_bf16 v[8:11], a[200:203], v[192:195], 0
    s_add_u32 m0, s60, 17792
    s_waitcnt lgkmcnt(8)
    ds_read_b128 a[96:99], v232 offset:34304
    ds_read_b128 a[100:103], v232 offset:34368
    v_exp_f32 v163, v163
    v_mfma_f32_16x16x32_bf16 v[12:15], a[204:207], v[192:195], 0
    s_waitcnt lgkmcnt(8)
    buffer_load_dwordx4 v238, s[16:19], s58 offen offset:2176 nt lds
    ds_read_b128 a[104:107], v232 offset:34432
    ds_read_b128 a[108:111], v232 offset:34496
    v_fma_f32 v164, v164, s28, v224
    v_cvt_pk_bf16_f32 v209, v162, v163
    v_mfma_f32_16x16x32_bf16 v[16:19], a[208:211], v[192:195], 0
    s_waitcnt lgkmcnt(8)
    ds_read_b128 a[112:115], v232 offset:34560
    ds_read_b128 a[116:119], v232 offset:34624
    v_exp_f32 v164, v164
    v_mfma_f32_16x16x32_bf16 v[20:23], a[212:215], v[192:195], 0
    s_waitcnt lgkmcnt(8)
    ds_read_b128 a[120:123], v232 offset:34688
    ds_read_b128 a[124:127], v232 offset:34752
    v_fma_f32 v165, v165, s28, v224
    v_mfma_f32_16x16x32_bf16 v[24:27], a[216:219], v[192:195], 0
    s_waitcnt lgkmcnt(8)
    v_exp_f32 v165, v165
    v_mfma_f32_16x16x32_bf16 v[28:31], a[220:223], v[192:195], 0
    v_fma_f32 v166, v166, s28, v224
    v_cvt_pk_bf16_f32 v210, v164, v165
    v_mfma_f32_16x16x32_bf16 a[176:179], v[228:231], v[192:195], a[176:179]
    s_waitcnt lgkmcnt(7)
    v_exp_f32 v166, v166
    v_fma_f32 v167, v167, s28, v224
    v_mfma_f32_16x16x32_bf16 v[160:163], a[96:99], a[0:3], 0
    s_waitcnt lgkmcnt(6)
    s_waitcnt vmcnt(4)
    v_exp_f32 v167, v167
    v_mfma_f32_16x16x32_bf16 v[160:163], a[100:103], a[4:7], v[160:163]
    s_add_u32 m0, s66, 0
    s_waitcnt lgkmcnt(5)
    ds_read_b64_tr_b16 a[224:225], v234 offset:34304
    v_cvt_pk_bf16_f32 v211, v166, v167
    v_mfma_f32_16x16x32_bf16 v[160:163], a[104:107], a[8:11], v[160:163]
    s_waitcnt lgkmcnt(5)
    ds_read_b128 a[16:19], v251 offset:16896
    ds_read_b128 a[20:23], v246 offset:16896
    ds_read_b128 a[24:27], v251 offset:18944
    ds_read_b128 a[28:31], v246 offset:18944
    buffer_load_dwordx4 v238, s[16:19], s59 offen offset:0 nt lds
    ds_read_b64_tr_b16 a[226:227], v234 offset:34560
    ds_read_b64_tr_b16 a[228:229], v234 offset:34336
    v_mfma_f32_16x16x32_bf16 v[160:163], a[108:111], a[12:15], v[160:163]
    s_waitcnt lgkmcnt(10)
    ds_read_b64_tr_b16 a[230:231], v234 offset:34592
    v_fma_f32 v128, v128, s28, v224
    v_mfma_f32_16x16x32_bf16 v[164:167], a[112:115], a[0:3], 0
    s_waitcnt lgkmcnt(10)
    ds_read_b64_tr_b16 a[232:233], v234 offset:34368
    ds_read_b64_tr_b16 a[234:235], v234 offset:34624
    v_exp_f32 v128, v128
    v_mfma_f32_16x16x32_bf16 v[164:167], a[116:119], a[4:7], v[164:167]
    s_waitcnt lgkmcnt(11)
    ds_read_b64_tr_b16 a[236:237], v234 offset:34400
    ds_read_b64_tr_b16 a[238:239], v234 offset:34656
    v_fma_f32 v129, v129, s28, v224
    v_mfma_f32_16x16x32_bf16 v[164:167], a[120:123], a[8:11], v[164:167]
    s_waitcnt lgkmcnt(12)
    ds_read_b64_tr_b16 a[240:241], v234 offset:34432
    v_exp_f32 v129, v129
    v_fma_f32 v130, v130, s28, v224
    v_mfma_f32_16x16x32_bf16 v[164:167], a[124:127], a[12:15], v[164:167]
    s_waitcnt lgkmcnt(8)
    ds_read_b64_tr_b16 a[242:243], v234 offset:34688
    ds_read_b64_tr_b16 a[244:245], v234 offset:34464
    v_cvt_pk_bf16_f32 v192, v128, v129
    v_exp_f32 v130, v130
    v_mfma_f32_16x16x32_bf16 v[136:139], a[128:131], a[16:19], 0
    ds_read_b64_tr_b16 a[246:247], v234 offset:34720
    ds_read_b64_tr_b16 a[248:249], v234 offset:34496
    v_fma_f32 v131, v131, s28, v224
    v_mfma_f32_16x16x32_bf16 v[136:139], a[132:135], a[20:23], v[136:139]
    s_add_u32 m0, s66, 4294966272
    ds_read_b64_tr_b16 a[250:251], v234 offset:34752
    v_exp_f32 v131, v131
    v_fma_f32 v132, v132, s28, v224
    v_mfma_f32_16x16x32_bf16 v[136:139], a[136:139], a[24:27], v[136:139]
    buffer_load_dwordx4 v238, s[16:19], s59 offen offset:2048 nt lds
    ds_read_b64_tr_b16 a[252:253], v234 offset:34528
    ds_read_b64_tr_b16 a[254:255], v234 offset:34784
    v_cvt_pk_bf16_f32 v193, v130, v131
    v_exp_f32 v132, v132
    v_mfma_f32_16x16x32_bf16 v[136:139], a[140:143], a[28:31], v[136:139]
    v_fma_f32 v133, v133, s28, v224
    v_fma_f32 v134, v134, s28, v224
    v_mfma_f32_16x16x32_bf16 v[140:143], a[144:147], a[16:19], 0
    v_exp_f32 v133, v133
    v_mfma_f32_16x16x32_bf16 v[140:143], a[148:151], a[20:23], v[140:143]
    v_cvt_pk_bf16_f32 v194, v132, v133
    v_fma_f32 v135, v135, s28, v224
    v_exp_f32 v134, v134
    v_mfma_f32_16x16x32_bf16 v[140:143], a[152:155], a[24:27], v[140:143]
    v_mov_b32 v251, v247
    v_max3_f32 v240, v136, v137, v138
    v_mfma_f32_16x16x32_bf16 v[140:143], a[156:159], a[28:31], v[140:143]
    s_waitcnt lgkmcnt(14)
    v_exp_f32 v135, v135
    v_mfma_f32_16x16x32_bf16 v[0:3], a[224:227], v[208:211], v[0:3]
    s_waitcnt lgkmcnt(12)
    v_max_f32 v240, v240, v139
    v_cvt_pk_bf16_f32 v195, v134, v135
    v_mov_b32 v241, v240
    v_mfma_f32_16x16x32_bf16 v[4:7], a[228:231], v[208:211], v[4:7]
    s_add_u32 m0, s66, 1920
    s_waitcnt lgkmcnt(10)
    v_permlane16_swap_b32 v240, v241
    v_max_f32 v240, v240, v241
    v_mfma_f32_16x16x32_bf16 v[8:11], a[232:235], v[208:211], v[8:11]
    s_waitcnt lgkmcnt(8)
    buffer_load_dwordx4 v238, s[16:19], s59 offen offset:128 nt lds
    v_mov_b32 v241, v240
    v_mfma_f32_16x16x32_bf16 v[12:15], a[236:239], v[208:211], v[12:15]
    s_waitcnt lgkmcnt(6)
    v_permlane32_swap_b32 v240, v241
    v_max_f32 v240, v240, v241
    v_mfma_f32_16x16x32_bf16 v[16:19], a[240:243], v[208:211], v[16:19]
    s_waitcnt lgkmcnt(4)
    v_mul_f32 v225, s51, v240
    v_fma_f32 v136, v136, s28, v225
    v_mfma_f32_16x16x32_bf16 v[20:23], a[244:247], v[208:211], v[20:23]
    s_waitcnt lgkmcnt(2)
    v_exp_f32 v136, v136
    v_mfma_f32_16x16x32_bf16 v[24:27], a[248:251], v[208:211], v[24:27]
    s_waitcnt lgkmcnt(0)
    v_fma_f32 v137, v137, s28, v225
    v_fma_f32 v138, v138, s28, v225
    v_mfma_f32_16x16x32_bf16 v[28:31], a[252:255], v[208:211], v[28:31]
    v_exp_f32 v137, v137
    v_mfma_f32_16x16x32_bf16 a[176:179], v[228:231], v[208:211], a[176:179]
    v_cvt_pk_bf16_f32 v196, v136, v137
    v_fma_f32 v139, v139, s28, v225
    v_mfma_f32_16x16x32_bf16 v[168:171], a[160:163], a[16:19], 0
    s_add_u32 m0, s66, 896
    v_exp_f32 v138, v138
    v_mfma_f32_16x16x32_bf16 v[168:171], a[164:167], a[20:23], v[168:171]
    buffer_load_dwordx4 v238, s[16:19], s59 offen offset:2176 nt lds
    v_mfma_f32_16x16x32_bf16 v[168:171], a[168:171], a[24:27], v[168:171]
    v_exp_f32 v139, v139
    v_mfma_f32_16x16x32_bf16 v[168:171], a[172:175], a[28:31], v[168:171]
    s_add_u32 s50, s49, 32
    v_fma_f32 v140, v140, s28, v225
    v_cvt_pk_bf16_f32 v197, v138, v139
    v_mfma_f32_16x16x32_bf16 v[172:175], v[96:99], a[16:19], 0
    s_mul_i32 s63, s50, 171
    v_exp_f32 v140, v140
    v_fma_f32 v141, v141, s28, v225
    v_mfma_f32_16x16x32_bf16 v[172:175], v[100:103], a[20:23], v[172:175]
    s_lshr_b32 s63, s63, 9
    v_exp_f32 v141, v141
    v_mfma_f32_16x16x32_bf16 v[172:175], v[104:107], a[24:27], v[172:175]
    s_mul_i32 s62, s63, 3
    v_fma_f32 v142, v142, s28, v225
    v_cvt_pk_bf16_f32 v198, v140, v141
    v_mfma_f32_16x16x32_bf16 v[172:175], v[108:111], a[28:31], v[172:175]
    s_sub_u32 s62, s50, s62
    v_exp_f32 v142, v142
    v_mfma_f32_16x16x32_bf16 v[136:139], a[64:67], a[16:19], 0
    s_add_u32 s40, s30, 32768
    v_fma_f32 v143, v143, s28, v225
    v_fma_f32 v168, v168, s28, v225
    v_mfma_f32_16x16x32_bf16 v[136:139], a[68:71], a[20:23], v[136:139]
    s_add_u32 m0, s60, 67584
    v_exp_f32 v143, v143
    v_mfma_f32_16x16x32_bf16 v[136:139], a[72:75], a[24:27], v[136:139]
    s_add_u32 s63, s63, s48
    buffer_load_dwordx4 v236, s[4:7], s40 offen offset:0 nt lds
    v_cvt_pk_bf16_f32 v199, v142, v143
    v_mfma_f32_16x16x32_bf16 v[136:139], a[76:79], a[28:31], v[136:139]
    s_lshl_b32 s31, s63, 17
    v_exp_f32 v168, v168
    v_mfma_f32_16x16x32_bf16 v[140:143], a[80:83], a[16:19], 0
    s_mul_i32 s34, s63, 188416
    v_fma_f32 v169, v169, s28, v225
    v_fma_f32 v170, v170, s28, v225
    v_mfma_f32_16x16x32_bf16 v[140:143], a[84:87], a[20:23], v[140:143]
    s_lshl_b32 s62, s62, 2
    v_exp_f32 v169, v169
    v_mfma_f32_16x16x32_bf16 v[140:143], a[88:91], a[24:27], v[140:143]
    s_add_u32 m0, s60, 68384
    v_cvt_pk_bf16_f32 v212, v168, v169
    v_fma_f32 v171, v171, s28, v225
    v_mfma_f32_16x16x32_bf16 v[140:143], a[92:95], a[28:31], v[140:143]
    s_add_u32 s62, s62, s29
    buffer_load_dwordx4 v236, s[4:7], s40 offen offset:256 nt lds
    v_mfma_f32_16x16x32_bf16 v[32:35], a[192:195], v[196:199], 0
    s_cmp_eq_u32 s62, 11
    s_cselect_b32 s37, 0, 48234496
    v_exp_f32 v170, v170
    v_mfma_f32_16x16x32_bf16 v[36:39], a[196:199], v[196:199], 0
    s_lshl_b32 s62, s62, 14
    v_exp_f32 v171, v171
    v_mfma_f32_16x16x32_bf16 v[40:43], a[200:203], v[196:199], 0
    s_add_u32 s34, s34, s62
    v_fma_f32 v172, v172, s28, v225
    v_cvt_pk_bf16_f32 v213, v170, v171
    v_mfma_f32_16x16x32_bf16 v[44:47], a[204:207], v[196:199], 0
    s_add_u32 s50, s49, 64
    v_exp_f32 v172, v172
    v_mfma_f32_16x16x32_bf16 v[48:51], a[208:211], v[196:199], 0
    s_add_u32 m0, s60, 69184
    v_fma_f32 v173, v173, s28, v225
    v_fma_f32 v174, v174, s28, v225
    v_mfma_f32_16x16x32_bf16 v[52:55], a[212:215], v[196:199], 0
    s_mul_i32 s63, s50, 171
    buffer_load_dwordx4 v236, s[4:7], s40 offen offset:512 nt lds
    v_mfma_f32_16x16x32_bf16 v[56:59], a[216:219], v[196:199], 0
    s_lshr_b32 s63, s63, 9
    v_exp_f32 v173, v173
    v_mfma_f32_16x16x32_bf16 v[60:63], a[220:223], v[196:199], 0
    s_mul_i32 s62, s63, 3
    v_cvt_pk_bf16_f32 v214, v172, v173
    v_fma_f32 v175, v175, s28, v225
    v_mfma_f32_16x16x32_bf16 a[176:179], a[188:191], v[196:199], a[176:179]
    s_sub_u32 s62, s50, s62
    v_exp_f32 v174, v174
    v_mfma_f32_16x16x32_bf16 v[168:171], a[96:99], a[16:19], 0
    s_waitcnt vmcnt(7)
    v_exp_f32 v175, v175
    v_mfma_f32_16x16x32_bf16 v[168:171], a[100:103], a[20:23], v[168:171]
    s_add_u32 m0, s60, 69984
    ds_read_b128 a[32:35], v244 offset:0
    v_cvt_pk_bf16_f32 v215, v174, v175
    v_mfma_f32_16x16x32_bf16 v[168:171], a[104:107], a[24:27], v[168:171]
    s_add_u32 s63, s63, s48
    ds_read_b128 a[36:39], v245 offset:0
    ds_read_b128 a[40:43], v244 offset:2048
    ds_read_b128 a[44:47], v245 offset:2048
    buffer_load_dwordx4 v236, s[4:7], s40 offen offset:768 nt lds
    v_mfma_f32_16x16x32_bf16 v[168:171], a[108:111], a[28:31], v[168:171]
    s_lshl_b32 s32, s63, 17
    v_fma_f32 v136, v136, s28, v225
    v_fma_f32 v137, v137, s28, v225
    v_mfma_f32_16x16x32_bf16 v[172:175], a[112:115], a[16:19], 0
    s_mul_i32 s35, s63, 188416
    v_exp_f32 v136, v136
    v_mfma_f32_16x16x32_bf16 v[172:175], a[116:119], a[20:23], v[172:175]
    s_lshl_b32 s62, s62, 2
    v_exp_f32 v137, v137
    v_mfma_f32_16x16x32_bf16 v[172:175], a[120:123], a[24:27], v[172:175]
    s_add_u32 s62, s62, s29
    v_fma_f32 v138, v138, s28, v225
    v_cvt_pk_bf16_f32 v196, v136, v137
    v_mfma_f32_16x16x32_bf16 v[172:175], a[124:127], a[28:31], v[172:175]
    s_waitcnt lgkmcnt(0)
    v_exp_f32 v138, v138
    v_mfma_f32_16x16x32_bf16 v[144:147], a[128:131], a[32:35], 0
    s_add_u32 s41, s30, 16384
    v_fma_f32 v139, v139, s28, v225
    v_fma_f32 v140, v140, s28, v225
    v_mfma_f32_16x16x32_bf16 v[144:147], a[132:135], a[36:39], v[144:147]
    s_add_u32 m0, s60, 84480
    v_exp_f32 v139, v139
    v_mfma_f32_16x16x32_bf16 v[144:147], a[136:139], a[40:43], v[144:147]
    s_cmp_eq_u32 s62, 11
    s_cselect_b32 s38, 0, 48234496
    buffer_load_dwordx4 v236, s[8:11], s41 offen offset:0 nt lds
    v_cvt_pk_bf16_f32 v197, v138, v139
    v_exp_f32 v140, v140
    v_mfma_f32_16x16x32_bf16 v[144:147], a[140:143], a[44:47], v[144:147]
    s_lshl_b32 s62, s62, 14
    v_fma_f32 v141, v141, s28, v225
    v_fma_f32 v142, v142, s28, v225
    v_mfma_f32_16x16x32_bf16 v[148:151], a[144:147], a[32:35], 0
    s_add_u32 s35, s35, s62
    v_exp_f32 v141, v141
    v_mfma_f32_16x16x32_bf16 v[148:151], a[148:151], a[36:39], v[148:151]
    s_add_u32 m0, s60, 85280
    v_cvt_pk_bf16_f32 v198, v140, v141
    v_fma_f32 v143, v143, s28, v225
    v_exp_f32 v142, v142
    v_mfma_f32_16x16x32_bf16 v[148:151], a[152:155], a[40:43], v[148:151]
    s_mov_b32 s22, 0
    buffer_load_dwordx4 v236, s[8:11], s41 offen offset:256 nt lds
    v_mfma_f32_16x16x32_bf16 v[148:151], a[156:159], a[44:47], v[148:151]
    s_mov_b32 s23, 0x00020000
    v_exp_f32 v143, v143
    v_mfma_f32_16x16x32_bf16 v[32:35], a[224:227], v[212:215], v[32:35]
    s_mov_b32 s26, 0
    v_max3_f32 v240, v144, v145, v146
    v_max_f32 v240, v240, v147
    v_cvt_pk_bf16_f32 v199, v142, v143
    v_mov_b32 v241, v240
    v_mfma_f32_16x16x32_bf16 v[36:39], a[228:231], v[212:215], v[36:39]
    s_mov_b32 s27, 0x00020000
    v_permlane16_swap_b32 v240, v241
    v_max_f32 v240, v240, v241
    v_mfma_f32_16x16x32_bf16 v[40:43], a[232:235], v[212:215], v[40:43]
    s_mov_b32 s24, s20
    v_mov_b32 v241, v240
    v_mfma_f32_16x16x32_bf16 v[44:47], a[236:239], v[212:215], v[44:47]
    s_add_u32 m0, s60, 86080
    v_permlane32_swap_b32 v240, v241
    v_max_f32 v240, v240, v241
    v_mfma_f32_16x16x32_bf16 v[48:51], a[240:243], v[212:215], v[48:51]
    s_mov_b32 s25, s21
    buffer_load_dwordx4 v236, s[8:11], s41 offen offset:512 nt lds
    v_mul_f32 v226, s51, v240
    v_fma_f32 v144, v144, s28, v226
    v_mfma_f32_16x16x32_bf16 v[52:55], a[244:247], v[212:215], v[52:55]
    s_mov_b32 s84, s30
    v_exp_f32 v144, v144
    v_mfma_f32_16x16x32_bf16 v[56:59], a[248:251], v[212:215], v[56:59]
    s_mov_b32 s87, s33
    v_fma_f32 v145, v145, s28, v226
    v_fma_f32 v146, v146, s28, v226
    v_mfma_f32_16x16x32_bf16 v[60:63], a[252:255], v[212:215], v[60:63]
    s_mov_b32 s90, s36
    v_exp_f32 v145, v145
    v_mfma_f32_16x16x32_bf16 a[176:179], a[188:191], v[212:215], a[176:179]
    s_mov_b32 s85, s31
    v_cvt_pk_bf16_f32 v200, v144, v145
    v_fma_f32 v147, v147, s28, v226
    v_mfma_f32_16x16x32_bf16 v[176:179], a[160:163], a[32:35], 0
    s_add_u32 m0, s60, 86880
    v_exp_f32 v146, v146
    v_mfma_f32_16x16x32_bf16 v[176:179], a[164:167], a[36:39], v[176:179]
    s_mov_b32 s88, s34
    buffer_load_dwordx4 v236, s[8:11], s41 offen offset:768 nt lds
    v_mfma_f32_16x16x32_bf16 v[176:179], a[168:171], a[40:43], v[176:179]
    s_mov_b32 s91, s37
    v_exp_f32 v147, v147
    v_mfma_f32_16x16x32_bf16 v[176:179], a[172:175], a[44:47], v[176:179]
    s_mov_b32 s86, s32
    v_fma_f32 v148, v148, s28, v226
    v_cvt_pk_bf16_f32 v201, v146, v147
    v_mfma_f32_16x16x32_bf16 v[180:183], v[96:99], a[32:35], 0
    s_mov_b32 s89, s35
    v_exp_f32 v148, v148
    v_fma_f32 v149, v149, s28, v226
    v_mfma_f32_16x16x32_bf16 v[180:183], v[100:103], a[36:39], v[180:183]
    s_mov_b32 s92, s38
    v_exp_f32 v149, v149
    v_mfma_f32_16x16x32_bf16 v[180:183], v[104:107], a[40:43], v[180:183]
    s_add_u32 s40, s30, 49152
    v_fma_f32 v150, v150, s28, v226
    v_cvt_pk_bf16_f32 v202, v148, v149
    v_mfma_f32_16x16x32_bf16 v[180:183], v[108:111], a[44:47], v[180:183]
    s_add_u32 m0, s60, 101376
    v_exp_f32 v150, v150
    v_mfma_f32_16x16x32_bf16 v[144:147], a[64:67], a[32:35], 0
    s_mov_b32 s61, 1568669696
    buffer_load_dwordx4 v236, s[4:7], s40 offen offset:0 nt lds
    v_fma_f32 v151, v151, s28, v226
    v_mfma_f32_16x16x32_bf16 v[144:147], a[68:71], a[36:39], v[144:147]
    s_mov_b32 s47, 0
    v_exp_f32 v151, v151
    v_mfma_f32_16x16x32_bf16 v[144:147], a[72:75], a[40:43], v[144:147]
    s_sub_u32 s69, s35, 16896
    v_cvt_pk_bf16_f32 v203, v150, v151
    v_fma_f32 v176, v176, s28, v226
    v_mfma_f32_16x16x32_bf16 v[144:147], a[76:79], a[44:47], v[144:147]
    s_add_u32 m0, s60, 102176
    v_exp_f32 v176, v176
    v_mfma_f32_16x16x32_bf16 v[148:151], a[80:83], a[32:35], 0
    s_min_u32 s78, s38, 8192
    buffer_load_dwordx4 v236, s[4:7], s40 offen offset:256 nt lds
    v_mfma_f32_16x16x32_bf16 v[148:151], a[84:87], a[36:39], v[148:151]
    s_add_u32 s78, s78, 25088
    v_fma_f32 v177, v177, s28, v226
    v_fma_f32 v178, v178, s28, v226
    v_mfma_f32_16x16x32_bf16 v[148:151], a[88:91], a[40:43], v[148:151]
    s_add_u32 s76, s12, s69
    s_addc_u32 s77, s13, 0
    v_exp_f32 v177, v177
    v_mfma_f32_16x16x32_bf16 v[148:151], a[92:95], a[44:47], v[148:151]
    s_mov_b32 s39, 48234496
    v_cvt_pk_bf16_f32 v216, v176, v177
    v_fma_f32 v179, v179, s28, v226
    v_mfma_f32_16x16x32_bf16 v[64:67], a[192:195], v[200:203], 0
    s_add_u32 m0, s60, 102976
    v_exp_f32 v178, v178
    v_mfma_f32_16x16x32_bf16 v[68:71], a[196:199], v[200:203], 0
    s_mov_b32 s42, 33554432
    buffer_load_dwordx4 v236, s[4:7], s40 offen offset:512 nt lds
    v_mfma_f32_16x16x32_bf16 v[72:75], a[200:203], v[200:203], 0
    s_mov_b32 s46, 0
    v_exp_f32 v179, v179
    v_mfma_f32_16x16x32_bf16 v[76:79], a[204:207], v[200:203], 0
    s_and_b32 s67, s49, 31
    v_fma_f32 v180, v180, s28, v226
    v_cvt_pk_bf16_f32 v217, v178, v179
    v_mfma_f32_16x16x32_bf16 v[80:83], a[208:211], v[200:203], 0
    s_or_b32 s67, s67, s29
    v_exp_f32 v180, v180
    v_mfma_f32_16x16x32_bf16 v[84:87], a[212:215], v[200:203], 0
    s_add_u32 m0, s60, 103776
    v_fma_f32 v181, v181, s28, v226
    v_fma_f32 v182, v182, s28, v226
    v_mfma_f32_16x16x32_bf16 v[88:91], a[216:219], v[200:203], 0
    s_cmp_eq_u32 s67, 0
    s_cselect_b32 s67, 2, 99
    buffer_load_dwordx4 v236, s[4:7], s40 offen offset:768 nt lds
    v_exp_f32 v181, v181
    v_mfma_f32_16x16x32_bf16 v[92:95], a[220:223], v[200:203], 0
    s_mov_b32 s52, 0
    v_cvt_pk_bf16_f32 v218, v180, v181
    v_fma_f32 v183, v183, s28, v226
    v_mfma_f32_16x16x32_bf16 a[180:183], v[228:231], v[200:203], a[180:183]
    s_mov_b32 s53, 0
    v_exp_f32 v182, v182
    v_mfma_f32_16x16x32_bf16 v[176:179], a[96:99], a[32:35], 0
    s_waitcnt vmcnt(12)
    v_exp_f32 v183, v183
    v_mfma_f32_16x16x32_bf16 v[176:179], a[100:103], a[36:39], v[176:179]
    s_add_u32 s41, s30, 32768
    ds_read_b128 a[48:51], v237 offset:0
    v_cvt_pk_bf16_f32 v219, v182, v183
    v_mfma_f32_16x16x32_bf16 v[176:179], a[104:107], a[40:43], v[176:179]
    s_add_u32 m0, s60, 118272
    ds_read_b128 a[52:55], v252 offset:0
    ds_read_b128 a[56:59], v237 offset:2048
    ds_read_b128 a[60:63], v252 offset:2048
    v_mfma_f32_16x16x32_bf16 v[176:179], a[108:111], a[44:47], v[176:179]
    s_mov_b32 s54, 0
    buffer_load_dwordx4 v236, s[8:11], s41 offen offset:0 nt lds
    v_fma_f32 v144, v144, s28, v226
    v_mfma_f32_16x16x32_bf16 v[180:183], a[112:115], a[32:35], 0
    s_mov_b32 s55, 0
    v_exp_f32 v144, v144
    v_mfma_f32_16x16x32_bf16 v[180:183], a[116:119], a[36:39], v[180:183]
    s_add_u32 s56, s34, 0
    v_fma_f32 v145, v145, s28, v226
    v_fma_f32 v146, v146, s28, v226
    v_mfma_f32_16x16x32_bf16 v[180:183], a[120:123], a[40:43], v[180:183]
    s_add_u32 m0, s60, 119072
    v_exp_f32 v145, v145
    v_mfma_f32_16x16x32_bf16 v[180:183], a[124:127], a[44:47], v[180:183]
    s_waitcnt lgkmcnt(0)
    buffer_load_dwordx4 v236, s[8:11], s41 offen offset:256 nt lds
    v_cvt_pk_bf16_f32 v200, v144, v145
    v_exp_f32 v146, v146
    v_mfma_f32_16x16x32_bf16 v[152:155], a[128:131], a[48:51], 0
    s_add_u32 s57, s34, 4096
    v_fma_f32 v147, v147, s28, v226
    v_fma_f32 v148, v148, s28, v226
    v_mfma_f32_16x16x32_bf16 v[152:155], a[132:135], a[52:55], v[152:155]
    s_add_u32 s58, s34, 8192
    v_exp_f32 v147, v147
    v_mfma_f32_16x16x32_bf16 v[152:155], a[136:139], a[56:59], v[152:155]
    s_add_u32 s59, s34, 12288
    v_cvt_pk_bf16_f32 v201, v146, v147
    v_fma_f32 v149, v149, s28, v226
    v_exp_f32 v148, v148
    v_mfma_f32_16x16x32_bf16 v[152:155], a[140:143], a[60:63], v[152:155]
    s_add_u32 m0, s60, 119872
    v_exp_f32 v149, v149
    v_mfma_f32_16x16x32_bf16 v[156:159], a[144:147], a[48:51], 0
    s_mov_b32 s18, s37
    buffer_load_dwordx4 v236, s[8:11], s41 offen offset:512 nt lds
    v_fma_f32 v150, v150, s28, v226
    v_mfma_f32_16x16x32_bf16 v[156:159], a[148:151], a[52:55], v[156:159]
    v_cvt_pk_bf16_f32 v202, v148, v149
    v_fma_f32 v151, v151, s28, v226
    v_exp_f32 v150, v150
    v_mfma_f32_16x16x32_bf16 v[156:159], a[152:155], a[56:59], v[156:159]
    v_exp_f32 v151, v151
    v_mfma_f32_16x16x32_bf16 v[156:159], a[156:159], a[60:63], v[156:159]
    v_max3_f32 v240, v152, v153, v154
    v_max_f32 v240, v240, v155
    v_mfma_f32_16x16x32_bf16 v[64:67], a[224:227], v[216:219], v[64:67]
    s_add_u32 m0, s60, 120672
    v_cvt_pk_bf16_f32 v203, v150, v151
    v_mov_b32 v241, v240
    v_mfma_f32_16x16x32_bf16 v[68:71], a[228:231], v[216:219], v[68:71]
    buffer_load_dwordx4 v236, s[8:11], s41 offen offset:768 nt lds
    v_permlane16_swap_b32 v240, v241
    v_max_f32 v240, v240, v241
    v_mfma_f32_16x16x32_bf16 v[72:75], a[232:235], v[216:219], v[72:75]
    v_mov_b32 v241, v240
    v_mfma_f32_16x16x32_bf16 v[76:79], a[236:239], v[216:219], v[76:79]
    s_nop 0
    v_permlane32_swap_b32 v240, v241
    v_max_f32 v240, v240, v241
    v_mfma_f32_16x16x32_bf16 v[80:83], a[240:243], v[216:219], v[80:83]
    v_mul_f32 v227, s51, v240
    v_fma_f32 v152, v152, s28, v227
    v_mfma_f32_16x16x32_bf16 v[84:87], a[244:247], v[216:219], v[84:87]
    v_exp_f32 v152, v152
    v_mfma_f32_16x16x32_bf16 v[88:91], a[248:251], v[216:219], v[88:91]
    v_fma_f32 v153, v153, s28, v227
    v_fma_f32 v154, v154, s28, v227
    v_mfma_f32_16x16x32_bf16 v[92:95], a[252:255], v[216:219], v[92:95]
    s_add_u32 s40, s30, 65536
    v_exp_f32 v153, v153
    v_mfma_f32_16x16x32_bf16 a[180:183], v[228:231], v[216:219], a[180:183]
    s_add_u32 m0, s60, 0
    v_cvt_pk_bf16_f32 v204, v152, v153
    v_fma_f32 v155, v155, s28, v227
    v_mfma_f32_16x16x32_bf16 v[184:187], a[160:163], a[48:51], 0
    buffer_load_dwordx4 v236, s[4:7], s40 offen offset:0 nt lds
    v_exp_f32 v154, v154
    v_mfma_f32_16x16x32_bf16 v[184:187], a[164:167], a[52:55], v[184:187]
    v_exp_f32 v155, v155
    v_mfma_f32_16x16x32_bf16 v[184:187], a[168:171], a[56:59], v[184:187]
L_pad1:
    s_cbranch_execz L_pad5
    v_fma_f32 v156, v156, s28, v227
    v_cvt_pk_bf16_f32 v205, v154, v155
    v_mfma_f32_16x16x32_bf16 v[184:187], a[172:175], a[60:63], v[184:187]
    s_add_u32 m0, s60, 800
    v_exp_f32 v156, v156
    v_mfma_f32_16x16x32_bf16 v[188:191], v[96:99], a[48:51], 0
    buffer_load_dwordx4 v236, s[4:7], s40 offen offset:256 nt lds
    v_fma_f32 v157, v157, s28, v227
    v_mfma_f32_16x16x32_bf16 v[188:191], v[100:103], a[52:55], v[188:191]
    v_exp_f32 v157, v157
    v_mfma_f32_16x16x32_bf16 v[188:191], v[104:107], a[56:59], v[188:191]
    v_fma_f32 v158, v158, s28, v227
    v_cvt_pk_bf16_f32 v206, v156, v157
    v_mfma_f32_16x16x32_bf16 v[188:191], v[108:111], a[60:63], v[188:191]
    v_exp_f32 v158, v158
    v_mfma_f32_16x16x32_bf16 v[152:155], a[64:67], a[48:51], 0
    s_add_u32 m0, s60, 1600
    v_fma_f32 v159, v159, s28, v227
    v_fma_f32 v184, v184, s28, v227
    v_mfma_f32_16x16x32_bf16 v[152:155], a[68:71], a[52:55], v[152:155]
    buffer_load_dwordx4 v236, s[4:7], s40 offen offset:512 nt lds
    v_exp_f32 v159, v159
    v_mfma_f32_16x16x32_bf16 v[152:155], a[72:75], a[56:59], v[152:155]
    v_cvt_pk_bf16_f32 v207, v158, v159
    v_fma_f32 v185, v185, s28, v227
    v_mfma_f32_16x16x32_bf16 v[152:155], a[76:79], a[60:63], v[152:155]
    v_exp_f32 v184, v184
    v_mfma_f32_16x16x32_bf16 v[156:159], a[80:83], a[48:51], 0
    v_exp_f32 v185, v185
    v_mfma_f32_16x16x32_bf16 v[156:159], a[84:87], a[52:55], v[156:159]
    s_add_u32 m0, s60, 2400
    v_fma_f32 v186, v186, s28, v227
    v_cvt_pk_bf16_f32 v220, v184, v185
    v_mfma_f32_16x16x32_bf16 v[156:159], a[88:91], a[56:59], v[156:159]
    buffer_load_dwordx4 v236, s[4:7], s40 offen offset:768 nt lds
    v_mfma_f32_16x16x32_bf16 v[156:159], a[92:95], a[60:63], v[156:159]
    v_exp_f32 v186, v186
    v_mfma_f32_16x16x32_bf16 v[96:99], a[192:195], v[204:207], 0
    v_fma_f32 v187, v187, s28, v227
    v_fma_f32 v188, v188, s28, v227
    v_mfma_f32_16x16x32_bf16 v[100:103], a[196:199], v[204:207], 0
    v_exp_f32 v187, v187
    v_mfma_f32_16x16x32_bf16 v[104:107], a[200:203], v[204:207], 0
    s_add_u32 s41, s30, 49152
    v_cvt_pk_bf16_f32 v221, v186, v187
    v_fma_f32 v189, v189, s28, v227
    v_mfma_f32_16x16x32_bf16 v[108:111], a[204:207], v[204:207], 0
    s_add_u32 m0, s60, 16896
    v_exp_f32 v188, v188
    v_mfma_f32_16x16x32_bf16 v[112:115], a[208:211], v[204:207], 0
    buffer_load_dwordx4 v236, s[8:11], s41 offen offset:0 nt lds
    v_mfma_f32_16x16x32_bf16 v[116:119], a[212:215], v[204:207], 0
    v_exp_f32 v189, v189
    v_mfma_f32_16x16x32_bf16 v[120:123], a[216:219], v[204:207], 0
    v_fma_f32 v190, v190, s28, v227
    v_cvt_pk_bf16_f32 v222, v188, v189
    v_mfma_f32_16x16x32_bf16 v[124:127], a[220:223], v[204:207], 0
    s_add_u32 m0, s60, 17696
    v_exp_f32 v190, v190
    v_mfma_f32_16x16x32_bf16 a[180:183], a[188:191], v[204:207], a[180:183]
    s_waitcnt vmcnt(13) lgkmcnt(0)
    s_barrier
    buffer_load_dwordx4 v236, s[8:11], s41 offen offset:256 nt lds
    v_fma_f32 v191, v191, s28, v227
    v_mfma_f32_16x16x32_bf16 v[184:187], a[96:99], a[48:51], 0
    v_exp_f32 v191, v191
    v_mfma_f32_16x16x32_bf16 v[184:187], a[100:103], a[52:55], v[184:187]
    ds_read_b128 a[128:131], v233 offset:0
    v_cvt_pk_bf16_f32 v223, v190, v191
    v_mfma_f32_16x16x32_bf16 v[184:187], a[104:107], a[56:59], v[184:187]
    ds_read_b128 a[132:135], v233 offset:64
    v_fma_f32 v152, v152, s28, v227
    v_mfma_f32_16x16x32_bf16 v[184:187], a[108:111], a[60:63], v[184:187]
    s_add_u32 m0, s60, 18496
    v_exp_f32 v152, v152
    v_mfma_f32_16x16x32_bf16 v[188:191], a[112:115], a[48:51], 0
    buffer_load_dwordx4 v236, s[8:11], s41 offen offset:512 nt lds
    v_mfma_f32_16x16x32_bf16 v[188:191], a[116:119], a[52:55], v[188:191]
    ds_read_b128 a[136:139], v233 offset:128
    v_fma_f32 v153, v153, s28, v227
    v_mfma_f32_16x16x32_bf16 v[188:191], a[120:123], a[56:59], v[188:191]
    v_exp_f32 v153, v153
    v_fma_f32 v154, v154, s28, v227
    v_mfma_f32_16x16x32_bf16 v[188:191], a[124:127], a[60:63], v[188:191]
    ds_read_b128 a[140:143], v233 offset:192
    v_cvt_pk_bf16_f32 v204, v152, v153
    v_exp_f32 v154, v154
    v_mfma_f32_16x16x32_bf16 v[96:99], a[224:227], v[220:223], v[96:99]
    s_add_u32 m0, s60, 19296
    ds_read_b64_tr_b16 a[160:161], v235 offset:0
    v_fma_f32 v155, v155, s28, v227
    v_mfma_f32_16x16x32_bf16 v[100:103], a[228:231], v[220:223], v[100:103]
    buffer_load_dwordx4 v236, s[8:11], s41 offen offset:768 nt lds
    v_exp_f32 v155, v155
    v_fma_f32 v156, v156, s28, v227
    v_mfma_f32_16x16x32_bf16 v[104:107], a[232:235], v[220:223], v[104:107]
    ds_read_b64_tr_b16 a[162:163], v235 offset:256
    v_cvt_pk_bf16_f32 v205, v154, v155
    v_exp_f32 v156, v156
    v_mfma_f32_16x16x32_bf16 v[108:111], a[236:239], v[220:223], v[108:111]
    ds_read_b64_tr_b16 a[164:165], v235 offset:32
    v_fma_f32 v157, v157, s28, v227
    v_mfma_f32_16x16x32_bf16 v[112:115], a[240:243], v[220:223], v[112:115]
    v_exp_f32 v157, v157
    v_fma_f32 v158, v158, s28, v227
    v_mfma_f32_16x16x32_bf16 v[116:119], a[244:247], v[220:223], v[116:119]
    v_cvt_pk_bf16_f32 v206, v156, v157
    v_fma_f32 v159, v159, s28, v227
    v_exp_f32 v158, v158
    v_mfma_f32_16x16x32_bf16 v[120:123], a[248:251], v[220:223], v[120:123]
    ds_read_b64_tr_b16 a[166:167], v235 offset:288
    v_exp_f32 v159, v159
    v_mfma_f32_16x16x32_bf16 v[124:127], a[252:255], v[220:223], v[124:127]
    v_cvt_pk_bf16_f32 v207, v158, v159
    v_mfma_f32_16x16x32_bf16 a[180:183], a[188:191], v[220:223], a[180:183]
    s_waitcnt lgkmcnt(4)
L_B1:
    v_mfma_f32_16x16x32_bf16 v[128:131], a[128:131], a[0:3], 0
    ds_read_b64_tr_b16 a[168:169], v235 offset:64
    ds_read_b64_tr_b16 a[170:171], v235 offset:320
    v_fma_f32 v164, v164, s28, v224
    v_fma_f32 v165, v165, s28, v224
    v_pk_fma_f32 v[160:161], v[160:161], s[64:65], v[224:225] op_sel_hi:[1,1,0]
    v_pk_fma_f32 v[162:163], v[162:163], s[64:65], v[224:225] op_sel_hi:[1,1,0]
    v_pk_fma_f32 v[168:169], v[168:169], s[64:65], v[224:225] op_sel:[0,0,1] op_sel_hi:[1,1,1]
    v_pk_fma_f32 v[170:171], v[170:171], s[64:65], v[224:225] op_sel:[0,0,1] op_sel_hi:[1,1,1]
    v_pk_fma_f32 v[176:177], v[176:177], s[64:65], v[226:227] op_sel_hi:[1,1,0]
    v_pk_fma_f32 v[178:179], v[178:179], s[64:65], v[226:227] op_sel_hi:[1,1,0]
    v_pk_fma_f32 v[184:185], v[184:185], s[64:65], v[226:227] op_sel:[0,0,1] op_sel_hi:[1,1,1]
    v_pk_fma_f32 v[186:187], v[186:187], s[64:65], v[226:227] op_sel:[0,0,1] op_sel_hi:[1,1,1]
    s_nop 0
    v_mfma_f32_16x16x32_bf16 v[128:131], a[132:135], a[4:7], v[128:131]
    v_exp_f32 v160, v160
    v_mfma_f32_16x16x32_bf16 v[128:131], a[136:139], a[8:11], v[128:131]
    v_exp_f32 v161, v161
    v_mfma_f32_16x16x32_bf16 v[128:131], a[140:143], a[12:15], v[128:131]
    v_exp_f32 v162, v162
    v_mfma_f32_16x16x32_bf16 v[136:139], a[128:131], a[16:19], 0
    s_add_u32 m0, s66, 0
    v_cvt_pk_bf16_f32 v208, v160, v161
    v_fma_f32 v166, v166, s28, v224
    v_mfma_f32_16x16x32_bf16 v[136:139], a[132:135], a[20:23], v[136:139]
    buffer_load_dwordx4 v238, s[12:15], s56 offen offset:0 nt lds
    v_mfma_f32_16x16x32_bf16 v[136:139], a[136:139], a[24:27], v[136:139]
    v_exp_f32 v163, v163
    v_mfma_f32_16x16x32_bf16 v[136:139], a[140:143], a[28:31], v[136:139]
    ds_read_b64_tr_b16 a[172:173], v235 offset:96
    v_cvt_pk_bf16_f32 v209, v162, v163
    v_smfmac_f32_16x16x64_bf16 a[176:179], a[184:187], v[192:199], v251
    ds_read_b128 a[144:147], v233 offset:256
    v_fma_f32 v167, v167, s28, v224
    v_smfmac_f32_16x16x64_bf16 a[180:183], a[184:187], v[200:207], v251
    s_waitcnt lgkmcnt(4)
    ds_read_b64_tr_b16 a[174:175], v235 offset:352
    v_mfma_f32_16x16x32_bf16 v[0:3], a[160:163], v[192:195], v[0:3]
    v_exp_f32 v168, v168
    v_mfma_f32_16x16x32_bf16 v[4:7], a[164:167], v[192:195], v[4:7]
    s_add_u32 m0, s66, 4294966272
    v_exp_f32 v169, v169
    v_mfma_f32_16x16x32_bf16 v[32:35], a[160:163], v[196:199], v[32:35]
    buffer_load_dwordx4 v238, s[12:15], s56 offen offset:2048 nt lds
    v_mfma_f32_16x16x32_bf16 v[36:39], a[164:167], v[196:199], v[36:39]
    ds_read_b128 a[148:151], v233 offset:320
    v_cvt_pk_bf16_f32 v212, v168, v169
    v_mfma_f32_16x16x32_bf16 v[64:67], a[160:163], v[200:203], v[64:67]
    v_exp_f32 v170, v170
    v_mfma_f32_16x16x32_bf16 v[68:71], a[164:167], v[200:203], v[68:71]
    v_exp_f32 v171, v171
    v_mfma_f32_16x16x32_bf16 v[96:99], a[160:163], v[204:207], v[96:99]
    v_fma_f32 v172, v172, s28, v225
    v_cvt_pk_bf16_f32 v213, v170, v171
    v_mfma_f32_16x16x32_bf16 v[100:103], a[164:167], v[204:207], v[100:103]
    v_exp_f32 v176, v176
    v_mfma_f32_16x16x32_bf16 v[144:147], a[128:131], a[32:35], 0
    ds_read_b128 a[152:155], v233 offset:384
    v_fma_f32 v173, v173, s28, v225
    v_mfma_f32_16x16x32_bf16 v[144:147], a[132:135], a[36:39], v[144:147]
    s_add_u32 m0, s66, 1920
    v_exp_f32 v177, v177
    v_mfma_f32_16x16x32_bf16 v[144:147], a[136:139], a[40:43], v[144:147]
    buffer_load_dwordx4 v238, s[12:15], s56 offen offset:128 nt lds
    v_mfma_f32_16x16x32_bf16 v[144:147], a[140:143], a[44:47], v[144:147]
    ds_read_b64_tr_b16 a[160:161], v235 offset:128
    ds_read_b128 a[156:159], v233 offset:448
    v_mfma_f32_16x16x32_bf16 v[152:155], a[128:131], a[48:51], 0
    ds_read_b64_tr_b16 a[162:163], v235 offset:384
    v_cvt_pk_bf16_f32 v216, v176, v177
    v_mfma_f32_16x16x32_bf16 v[152:155], a[132:135], a[52:55], v[152:155]
    v_exp_f32 v178, v178
    v_mfma_f32_16x16x32_bf16 v[152:155], a[136:139], a[56:59], v[152:155]
    v_exp_f32 v179, v179
    v_mfma_f32_16x16x32_bf16 v[152:155], a[140:143], a[60:63], v[152:155]
    s_waitcnt lgkmcnt(5)
    v_fma_f32 v174, v174, s28, v225
    v_cvt_pk_bf16_f32 v217, v178, v179
    v_mfma_f32_16x16x32_bf16 v[8:11], a[168:171], v[192:195], v[8:11]
    v_exp_f32 v184, v184
    v_mfma_f32_16x16x32_bf16 v[12:15], a[172:175], v[192:195], v[12:15]
    s_add_u32 m0, s66, 896
    ds_read_b64_tr_b16 a[164:165], v235 offset:160
    v_fma_f32 v175, v175, s28, v225
    v_mfma_f32_16x16x32_bf16 v[40:43], a[168:171], v[196:199], v[40:43]
    buffer_load_dwordx4 v238, s[12:15], s56 offen offset:2176 nt lds
    v_mfma_f32_16x16x32_bf16 v[44:47], a[172:175], v[196:199], v[44:47]
    v_exp_f32 v185, v185
    v_mfma_f32_16x16x32_bf16 v[72:75], a[168:171], v[200:203], v[72:75]
    ds_read_b64_tr_b16 a[166:167], v235 offset:416
    v_cvt_pk_bf16_f32 v220, v184, v185
    v_mfma_f32_16x16x32_bf16 v[76:79], a[172:175], v[200:203], v[76:79]
    v_exp_f32 v186, v186
    v_mfma_f32_16x16x32_bf16 v[104:107], a[168:171], v[204:207], v[104:107]
    v_exp_f32 v187, v187
    v_mfma_f32_16x16x32_bf16 v[108:111], a[172:175], v[204:207], v[108:111]
    s_waitcnt lgkmcnt(3)
    v_fma_f32 v180, v180, s28, v226
    v_cvt_pk_bf16_f32 v221, v186, v187
    v_mfma_f32_16x16x32_bf16 v[132:135], a[144:147], a[0:3], 0
    s_add_u32 s40, s30, 81920
    v_exp_f32 v164, v164
    v_mfma_f32_16x16x32_bf16 v[132:135], a[148:151], a[4:7], v[132:135]
    s_add_u32 m0, s60, 33792
    v_exp_f32 v165, v165
    v_mfma_f32_16x16x32_bf16 v[132:135], a[152:155], a[8:11], v[132:135]
    buffer_load_dwordx4 v236, s[4:7], s40 offen offset:0 nt lds
    v_mfma_f32_16x16x32_bf16 v[132:135], a[156:159], a[12:15], v[132:135]
    ds_read_b64_tr_b16 a[168:169], v235 offset:192
    v_fma_f32 v181, v181, s28, v226
    v_mfma_f32_16x16x32_bf16 v[140:143], a[144:147], a[16:19], 0
    ds_read_b64_tr_b16 a[170:171], v235 offset:448
    v_cvt_pk_bf16_f32 v210, v164, v165
    v_mfma_f32_16x16x32_bf16 v[140:143], a[148:151], a[20:23], v[140:143]
    v_exp_f32 v166, v166
    v_mfma_f32_16x16x32_bf16 v[140:143], a[152:155], a[24:27], v[140:143]
    v_exp_f32 v167, v167
    v_mfma_f32_16x16x32_bf16 v[140:143], a[156:159], a[28:31], v[140:143]
    s_waitcnt lgkmcnt(2)
    v_fma_f32 v182, v182, s28, v226
    v_cvt_pk_bf16_f32 v211, v166, v167
    v_mfma_f32_16x16x32_bf16 v[16:19], a[160:163], v[192:195], v[16:19]
    v_exp_f32 v172, v172
    v_mfma_f32_16x16x32_bf16 v[20:23], a[164:167], v[192:195], v[20:23]
    s_add_u32 m0, s60, 34592
    ds_read_b64_tr_b16 a[172:173], v235 offset:224
    v_fma_f32 v183, v183, s28, v226
    v_mfma_f32_16x16x32_bf16 v[48:51], a[160:163], v[196:199], v[48:51]
    buffer_load_dwordx4 v236, s[4:7], s40 offen offset:256 nt lds
    v_mfma_f32_16x16x32_bf16 v[52:55], a[164:167], v[196:199], v[52:55]
    v_exp_f32 v173, v173
    v_mfma_f32_16x16x32_bf16 v[80:83], a[160:163], v[200:203], v[80:83]
    ds_read_b128 a[128:131], v233 offset:512
    ds_read_b64_tr_b16 a[174:175], v235 offset:480
    v_mfma_f32_16x16x32_bf16 v[84:87], a[164:167], v[200:203], v[84:87]
    ds_read_b128 a[132:135], v233 offset:576
    v_cvt_pk_bf16_f32 v214, v172, v173
    v_mfma_f32_16x16x32_bf16 v[112:115], a[160:163], v[204:207], v[112:115]
    v_exp_f32 v174, v174
    v_mfma_f32_16x16x32_bf16 v[116:119], a[164:167], v[204:207], v[116:119]
    v_exp_f32 v175, v175
    v_mfma_f32_16x16x32_bf16 v[148:151], a[144:147], a[32:35], 0
    v_fma_f32 v188, v188, s28, v227
    v_cvt_pk_bf16_f32 v215, v174, v175
    v_mfma_f32_16x16x32_bf16 v[148:151], a[148:151], a[36:39], v[148:151]
    s_add_u32 m0, s60, 35392
    v_exp_f32 v180, v180
    v_mfma_f32_16x16x32_bf16 v[148:151], a[152:155], a[40:43], v[148:151]
    buffer_load_dwordx4 v236, s[4:7], s40 offen offset:512 nt lds
    ds_read_b128 a[136:139], v233 offset:640
    v_mfma_f32_16x16x32_bf16 v[148:151], a[156:159], a[44:47], v[148:151]
    v_exp_f32 v181, v181
    v_mfma_f32_16x16x32_bf16 v[156:159], a[144:147], a[48:51], 0
    ds_read_b128 a[140:143], v233 offset:704
    v_fma_f32 v189, v189, s28, v227
    v_mfma_f32_16x16x32_bf16 v[156:159], a[148:151], a[52:55], v[156:159]
    ds_read_b64_tr_b16 a[160:161], v235 offset:512
    v_cvt_pk_bf16_f32 v218, v180, v181
    v_mfma_f32_16x16x32_bf16 v[156:159], a[152:155], a[56:59], v[156:159]
    v_exp_f32 v182, v182
    v_mfma_f32_16x16x32_bf16 v[156:159], a[156:159], a[60:63], v[156:159]
    s_waitcnt lgkmcnt(4)
    v_exp_f32 v183, v183
    v_mfma_f32_16x16x32_bf16 v[24:27], a[168:171], v[192:195], v[24:27]
    ds_read_b64_tr_b16 a[162:163], v235 offset:768
    v_fma_f32 v190, v190, s28, v227
    v_mfma_f32_16x16x32_bf16 v[28:31], a[172:175], v[192:195], v[28:31]
    s_add_u32 m0, s60, 36192
    v_cvt_pk_bf16_f32 v219, v182, v183
    v_fma_f32 v191, v191, s28, v227
    v_mfma_f32_16x16x32_bf16 v[56:59], a[168:171], v[196:199], v[56:59]
    buffer_load_dwordx4 v236, s[4:7], s40 offen offset:768 nt lds
    v_exp_f32 v188, v188
    v_mfma_f32_16x16x32_bf16 v[60:63], a[172:175], v[196:199], v[60:63]
    v_exp_f32 v189, v189
    v_mfma_f32_16x16x32_bf16 v[88:91], a[168:171], v[200:203], v[88:91]
    ds_read_b64_tr_b16 a[164:165], v235 offset:544
    v_cvt_pk_bf16_f32 v222, v188, v189
    v_mfma_f32_16x16x32_bf16 v[92:95], a[172:175], v[200:203], v[92:95]
    v_exp_f32 v190, v190
    v_mfma_f32_16x16x32_bf16 v[120:123], a[168:171], v[204:207], v[120:123]
    v_exp_f32 v191, v191
    v_mfma_f32_16x16x32_bf16 v[124:127], a[172:175], v[204:207], v[124:127]
    s_waitcnt lgkmcnt(3)
    ds_read_b64_tr_b16 a[166:167], v235 offset:800
    ds_read_b64_tr_b16 a[168:169], v235 offset:576
    v_fma_f32 v132, v132, s28, v224
    v_cvt_pk_bf16_f32 v223, v190, v191
    v_pk_fma_f32 v[128:129], v[128:129], s[64:65], v[224:225] op_sel_hi:[1,1,0]
    v_pk_fma_f32 v[130:131], v[130:131], s[64:65], v[224:225] op_sel_hi:[1,1,0]
    v_pk_fma_f32 v[136:137], v[136:137], s[64:65], v[224:225] op_sel:[0,0,1] op_sel_hi:[1,1,1]
    v_pk_fma_f32 v[138:139], v[138:139], s[64:65], v[224:225] op_sel:[0,0,1] op_sel_hi:[1,1,1]
    v_pk_fma_f32 v[144:145], v[144:145], s[64:65], v[226:227] op_sel_hi:[1,1,0]
    v_pk_fma_f32 v[146:147], v[146:147], s[64:65], v[226:227] op_sel_hi:[1,1,0]
    v_pk_fma_f32 v[152:153], v[152:153], s[64:65], v[226:227] op_sel:[0,0,1] op_sel_hi:[1,1,1]
    v_pk_fma_f32 v[154:155], v[154:155], s[64:65], v[226:227] op_sel:[0,0,1] op_sel_hi:[1,1,1]
    v_fma_f32 v133, v133, s28, v224
    v_mfma_f32_16x16x32_bf16 v[160:163], a[128:131], a[0:3], 0
    s_add_u32 s41, s30, 65536
    v_exp_f32 v128, v128
    v_mfma_f32_16x16x32_bf16 v[160:163], a[132:135], a[4:7], v[160:163]
    s_add_u32 m0, s60, 50688
    v_exp_f32 v129, v129
    v_mfma_f32_16x16x32_bf16 v[160:163], a[136:139], a[8:11], v[160:163]
    buffer_load_dwordx4 v236, s[8:11], s41 offen offset:0 nt lds
    v_mfma_f32_16x16x32_bf16 v[160:163], a[140:143], a[12:15], v[160:163]
    v_cvt_pk_bf16_f32 v192, v128, v129
    v_fma_f32 v134, v134, s28, v224
    v_mfma_f32_16x16x32_bf16 v[168:171], a[128:131], a[16:19], 0
    v_exp_f32 v130, v130
    v_mfma_f32_16x16x32_bf16 v[168:171], a[132:135], a[20:23], v[168:171]
    v_exp_f32 v131, v131
    v_mfma_f32_16x16x32_bf16 v[168:171], a[136:139], a[24:27], v[168:171]
    ds_read_b64_tr_b16 a[170:171], v235 offset:832
    v_cvt_pk_bf16_f32 v193, v130, v131
    v_mfma_f32_16x16x32_bf16 v[168:171], a[140:143], a[28:31], v[168:171]
    v_exp_f32 v136, v136
    v_smfmac_f32_16x16x64_bf16 a[176:179], a[184:187], v[208:215], v251
    ds_read_b64_tr_b16 a[172:173], v235 offset:608
    v_fma_f32 v135, v135, s28, v224
    v_smfmac_f32_16x16x64_bf16 a[180:183], a[184:187], v[216:223], v251
    s_waitcnt lgkmcnt(3)
    ds_read_b128 a[144:147], v233 offset:768
    ds_read_b64_tr_b16 a[174:175], v235 offset:864
    v_mfma_f32_16x16x32_bf16 v[0:3], a[160:163], v[208:211], v[0:3]
    s_add_u32 m0, s60, 51488
    v_exp_f32 v137, v137
    v_mfma_f32_16x16x32_bf16 v[4:7], a[164:167], v[208:211], v[4:7]
    buffer_load_dwordx4 v236, s[8:11], s41 offen offset:256 nt lds
    v_mfma_f32_16x16x32_bf16 v[32:35], a[160:163], v[212:215], v[32:35]
    v_cvt_pk_bf16_f32 v196, v136, v137
    v_fma_f32 v140, v140, s28, v225
    v_mfma_f32_16x16x32_bf16 v[36:39], a[164:167], v[212:215], v[36:39]
    v_exp_f32 v138, v138
    v_mfma_f32_16x16x32_bf16 v[64:67], a[160:163], v[216:219], v[64:67]
    v_exp_f32 v139, v139
    v_mfma_f32_16x16x32_bf16 v[68:71], a[164:167], v[216:219], v[68:71]
    ds_read_b128 a[148:151], v233 offset:832
    v_cvt_pk_bf16_f32 v197, v138, v139
    v_mfma_f32_16x16x32_bf16 v[96:99], a[160:163], v[220:223], v[96:99]
    v_exp_f32 v144, v144
    v_mfma_f32_16x16x32_bf16 v[100:103], a[164:167], v[220:223], v[100:103]
    s_add_u32 m0, s60, 52288
    ds_read_b128 a[152:155], v233 offset:896
    v_fma_f32 v141, v141, s28, v225
    v_mfma_f32_16x16x32_bf16 v[176:179], a[128:131], a[32:35], 0
    buffer_load_dwordx4 v236, s[8:11], s41 offen offset:512 nt lds
    v_mfma_f32_16x16x32_bf16 v[176:179], a[132:135], a[36:39], v[176:179]
    v_exp_f32 v145, v145
    v_mfma_f32_16x16x32_bf16 v[176:179], a[136:139], a[40:43], v[176:179]
    ds_read_b64_tr_b16 a[160:161], v235 offset:640
    v_cvt_pk_bf16_f32 v200, v144, v145
    v_mfma_f32_16x16x32_bf16 v[176:179], a[140:143], a[44:47], v[176:179]
    v_exp_f32 v146, v146
    v_mfma_f32_16x16x32_bf16 v[184:187], a[128:131], a[48:51], 0
    ds_read_b128 a[156:159], v233 offset:960
    v_fma_f32 v142, v142, s28, v225
    v_mfma_f32_16x16x32_bf16 v[184:187], a[132:135], a[52:55], v[184:187]
    v_exp_f32 v147, v147
    v_mfma_f32_16x16x32_bf16 v[184:187], a[136:139], a[56:59], v[184:187]
    ds_read_b64_tr_b16 a[162:163], v235 offset:896
    v_cvt_pk_bf16_f32 v201, v146, v147
    v_mfma_f32_16x16x32_bf16 v[184:187], a[140:143], a[60:63], v[184:187]
    s_waitcnt lgkmcnt(5)
    v_exp_f32 v152, v152
    v_mfma_f32_16x16x32_bf16 v[8:11], a[168:171], v[208:211], v[8:11]
    s_add_u32 m0, s60, 53088
    ds_read_b64_tr_b16 a[164:165], v235 offset:672
    v_fma_f32 v143, v143, s28, v225
    v_mfma_f32_16x16x32_bf16 v[12:15], a[172:175], v[208:211], v[12:15]
    buffer_load_dwordx4 v236, s[8:11], s41 offen offset:768 nt lds
    v_mfma_f32_16x16x32_bf16 v[40:43], a[168:171], v[212:215], v[40:43]
    v_exp_f32 v153, v153
    v_mfma_f32_16x16x32_bf16 v[44:47], a[172:175], v[212:215], v[44:47]
    ds_read_b64_tr_b16 a[166:167], v235 offset:928
    v_cvt_pk_bf16_f32 v204, v152, v153
    v_mfma_f32_16x16x32_bf16 v[72:75], a[168:171], v[216:219], v[72:75]
    v_exp_f32 v154, v154
    v_mfma_f32_16x16x32_bf16 v[76:79], a[172:175], v[216:219], v[76:79]
    v_exp_f32 v155, v155
    v_mfma_f32_16x16x32_bf16 v[104:107], a[168:171], v[220:223], v[104:107]
    v_fma_f32 v148, v148, s28, v226
    v_cvt_pk_bf16_f32 v205, v154, v155
    v_mfma_f32_16x16x32_bf16 v[108:111], a[172:175], v[220:223], v[108:111]
    s_waitcnt lgkmcnt(3)
    v_exp_f32 v132, v132
    v_mfma_f32_16x16x32_bf16 v[164:167], a[144:147], a[0:3], 0
    v_exp_f32 v133, v133
    v_mfma_f32_16x16x32_bf16 v[164:167], a[148:151], a[4:7], v[164:167]
    v_fma_f32 v149, v149, s28, v226
    v_cvt_pk_bf16_f32 v194, v132, v133
    v_mfma_f32_16x16x32_bf16 v[164:167], a[152:155], a[8:11], v[164:167]
    ds_read_b64_tr_b16 a[168:169], v235 offset:704
    v_fma_f32 v150, v150, s28, v226
    v_mfma_f32_16x16x32_bf16 v[164:167], a[156:159], a[12:15], v[164:167]
    v_exp_f32 v134, v134
    v_mfma_f32_16x16x32_bf16 v[172:175], a[144:147], a[16:19], 0
    v_exp_f32 v135, v135
    v_mfma_f32_16x16x32_bf16 v[172:175], a[148:151], a[20:23], v[172:175]
    ds_read_b64_tr_b16 a[170:171], v235 offset:960
    v_cvt_pk_bf16_f32 v195, v134, v135
    v_mfma_f32_16x16x32_bf16 v[172:175], a[152:155], a[24:27], v[172:175]
    v_exp_f32 v140, v140
    v_mfma_f32_16x16x32_bf16 v[172:175], a[156:159], a[28:31], v[172:175]
    s_waitcnt lgkmcnt(2)
    ds_read_b64_tr_b16 a[172:173], v235 offset:736
    ds_read_b64_tr_b16 a[174:175], v235 offset:992
    v_mfma_f32_16x16x32_bf16 v[16:19], a[160:163], v[208:211], v[16:19]
    v_exp_f32 v141, v141
    v_mfma_f32_16x16x32_bf16 v[20:23], a[164:167], v[208:211], v[20:23]
    v_fma_f32 v151, v151, s28, v226
    v_cvt_pk_bf16_f32 v198, v140, v141
    v_mfma_f32_16x16x32_bf16 v[48:51], a[160:163], v[212:215], v[48:51]
    v_exp_f32 v142, v142
    v_mfma_f32_16x16x32_bf16 v[52:55], a[164:167], v[212:215], v[52:55]
    v_exp_f32 v143, v143
    v_mfma_f32_16x16x32_bf16 v[80:83], a[160:163], v[216:219], v[80:83]
    v_fma_f32 v156, v156, s28, v227
    v_cvt_pk_bf16_f32 v199, v142, v143
    v_mfma_f32_16x16x32_bf16 v[84:87], a[164:167], v[216:219], v[84:87]
    v_exp_f32 v148, v148
    v_mfma_f32_16x16x32_bf16 v[112:115], a[160:163], v[220:223], v[112:115]
    s_waitcnt vmcnt(20) lgkmcnt(0)
    s_barrier
    ds_read_b128 a[128:131], v233 offset:33792
    ds_read_b128 a[132:135], v233 offset:33856
    v_mfma_f32_16x16x32_bf16 v[116:119], a[164:167], v[220:223], v[116:119]
    v_exp_f32 v149, v149
    v_mfma_f32_16x16x32_bf16 v[180:183], a[144:147], a[32:35], 0
    v_fma_f32 v157, v157, s28, v227
    v_cvt_pk_bf16_f32 v202, v148, v149
    v_mfma_f32_16x16x32_bf16 v[180:183], a[148:151], a[36:39], v[180:183]
    ds_read_b128 a[136:139], v233 offset:33920
    ds_read_b128 a[140:143], v233 offset:33984
    v_mfma_f32_16x16x32_bf16 v[180:183], a[152:155], a[40:43], v[180:183]
    v_exp_f32 v150, v150
    v_mfma_f32_16x16x32_bf16 v[180:183], a[156:159], a[44:47], v[180:183]
    v_exp_f32 v151, v151
    v_mfma_f32_16x16x32_bf16 v[188:191], a[144:147], a[48:51], 0
    ds_read_b64_tr_b16 a[160:161], v235 offset:33792
    v_fma_f32 v158, v158, s28, v227
    v_mfma_f32_16x16x32_bf16 v[188:191], a[148:151], a[52:55], v[188:191]
    ds_read_b64_tr_b16 a[162:163], v235 offset:34048
    v_cvt_pk_bf16_f32 v203, v150, v151
    v_mfma_f32_16x16x32_bf16 v[188:191], a[152:155], a[56:59], v[188:191]
    v_exp_f32 v156, v156
    v_mfma_f32_16x16x32_bf16 v[188:191], a[156:159], a[60:63], v[188:191]
    v_exp_f32 v157, v157
    v_mfma_f32_16x16x32_bf16 v[24:27], a[168:171], v[208:211], v[24:27]
    ds_read_b64_tr_b16 a[164:165], v235 offset:33824
    v_fma_f32 v159, v159, s28, v227
    v_mfma_f32_16x16x32_bf16 v[28:31], a[172:175], v[208:211], v[28:31]
    ds_read_b64_tr_b16 a[166:167], v235 offset:34080
    v_cvt_pk_bf16_f32 v206, v156, v157
    v_mfma_f32_16x16x32_bf16 v[56:59], a[168:171], v[212:215], v[56:59]
    v_exp_f32 v158, v158
    v_mfma_f32_16x16x32_bf16 v[60:63], a[172:175], v[212:215], v[60:63]
    v_exp_f32 v159, v159
    v_mfma_f32_16x16x32_bf16 v[88:91], a[168:171], v[216:219], v[88:91]
    v_cvt_pk_bf16_f32 v207, v158, v159
    v_mfma_f32_16x16x32_bf16 v[92:95], a[172:175], v[216:219], v[92:95]
    v_mfma_f32_16x16x32_bf16 v[120:123], a[168:171], v[220:223], v[120:123]
    v_mfma_f32_16x16x32_bf16 v[124:127], a[172:175], v[220:223], v[124:127]
    s_waitcnt lgkmcnt(4)
    v_mfma_f32_16x16x32_bf16 v[128:131], a[128:131], a[0:3], 0
    ds_read_b64_tr_b16 a[168:169], v235 offset:33856
    ds_read_b64_tr_b16 a[170:171], v235 offset:34112
    v_fma_f32 v164, v164, s28, v224
    v_fma_f32 v165, v165, s28, v224
    v_pk_fma_f32 v[160:161], v[160:161], s[64:65], v[224:225] op_sel_hi:[1,1,0]
    v_pk_fma_f32 v[162:163], v[162:163], s[64:65], v[224:225] op_sel_hi:[1,1,0]
    v_pk_fma_f32 v[168:169], v[168:169], s[64:65], v[224:225] op_sel:[0,0,1] op_sel_hi:[1,1,1]
    v_pk_fma_f32 v[170:171], v[170:171], s[64:65], v[224:225] op_sel:[0,0,1] op_sel_hi:[1,1,1]
    v_pk_fma_f32 v[176:177], v[176:177], s[64:65], v[226:227] op_sel_hi:[1,1,0]
    v_pk_fma_f32 v[178:179], v[178:179], s[64:65], v[226:227] op_sel_hi:[1,1,0]
    v_pk_fma_f32 v[184:185], v[184:185], s[64:65], v[226:227] op_sel:[0,0,1] op_sel_hi:[1,1,1]
    v_pk_fma_f32 v[186:187], v[186:187], s[64:65], v[226:227] op_sel:[0,0,1] op_sel_hi:[1,1,1]
    s_nop 0
    v_mfma_f32_16x16x32_bf16 v[128:131], a[132:135], a[4:7], v[128:131]
    v_exp_f32 v160, v160
    v_mfma_f32_16x16x32_bf16 v[128:131], a[136:139], a[8:11], v[128:131]
    v_exp_f32 v161, v161
    v_mfma_f32_16x16x32_bf16 v[128:131], a[140:143], a[12:15], v[128:131]
    v_exp_f32 v162, v162
    v_mfma_f32_16x16x32_bf16 v[136:139], a[128:131], a[16:19], 0
    s_add_u32 m0, s66, 4096
    v_cvt_pk_bf16_f32 v208, v160, v161
    v_fma_f32 v166, v166, s28, v224
    v_mfma_f32_16x16x32_bf16 v[136:139], a[132:135], a[20:23], v[136:139]
    buffer_load_dwordx4 v238, s[12:15], s57 offen offset:0 nt lds
    v_mfma_f32_16x16x32_bf16 v[136:139], a[136:139], a[24:27], v[136:139]
    v_exp_f32 v163, v163
    v_mfma_f32_16x16x32_bf16 v[136:139], a[140:143], a[28:31], v[136:139]
    ds_read_b64_tr_b16 a[172:173], v235 offset:33888
    v_cvt_pk_bf16_f32 v209, v162, v163
    v_smfmac_f32_16x16x64_bf16 a[176:179], a[184:187], v[192:199], v251
    ds_read_b128 a[144:147], v233 offset:34048
    v_fma_f32 v167, v167, s28, v224
    v_smfmac_f32_16x16x64_bf16 a[180:183], a[184:187], v[200:207], v251
    s_waitcnt lgkmcnt(4)
    ds_read_b64_tr_b16 a[174:175], v235 offset:34144
    v_mfma_f32_16x16x32_bf16 v[0:3], a[160:163], v[192:195], v[0:3]
    v_exp_f32 v168, v168
    v_mfma_f32_16x16x32_bf16 v[4:7], a[164:167], v[192:195], v[4:7]
    v_exp_f32 v169, v169
    v_mfma_f32_16x16x32_bf16 v[32:35], a[160:163], v[196:199], v[32:35]
    buffer_store_dwordx4 a[224:227], v238, s[24:27], s54 offen offset:0 sc0 sc1
    v_mfma_f32_16x16x32_bf16 v[36:39], a[164:167], v[196:199], v[36:39]
    ds_read_b128 a[148:151], v233 offset:34112
    v_cvt_pk_bf16_f32 v212, v168, v169
    v_mfma_f32_16x16x32_bf16 v[64:67], a[160:163], v[200:203], v[64:67]
    v_exp_f32 v170, v170
    v_mfma_f32_16x16x32_bf16 v[68:71], a[164:167], v[200:203], v[68:71]
    v_exp_f32 v171, v171
    v_mfma_f32_16x16x32_bf16 v[96:99], a[160:163], v[204:207], v[96:99]
    v_fma_f32 v172, v172, s28, v225
    v_cvt_pk_bf16_f32 v213, v170, v171
    v_mfma_f32_16x16x32_bf16 v[100:103], a[164:167], v[204:207], v[100:103]
    s_add_u32 m0, s66, 3072
    v_exp_f32 v176, v176
    v_mfma_f32_16x16x32_bf16 v[144:147], a[128:131], a[32:35], 0
    buffer_load_dwordx4 v238, s[12:15], s57 offen offset:2048 nt lds
    v_mfma_f32_16x16x32_bf16 v[144:147], a[132:135], a[36:39], v[144:147]
    ds_read_b128 a[152:155], v233 offset:34176
    v_fma_f32 v173, v173, s28, v225
    v_mfma_f32_16x16x32_bf16 v[144:147], a[136:139], a[40:43], v[144:147]
    v_exp_f32 v177, v177
    v_mfma_f32_16x16x32_bf16 v[144:147], a[140:143], a[44:47], v[144:147]
    ds_read_b64_tr_b16 a[160:161], v235 offset:33920
    ds_read_b128 a[156:159], v233 offset:34240
    v_mfma_f32_16x16x32_bf16 v[152:155], a[128:131], a[48:51], 0
    ds_read_b64_tr_b16 a[162:163], v235 offset:34176
    v_cvt_pk_bf16_f32 v216, v176, v177
    v_mfma_f32_16x16x32_bf16 v[152:155], a[132:135], a[52:55], v[152:155]
    v_exp_f32 v178, v178
    v_mfma_f32_16x16x32_bf16 v[152:155], a[136:139], a[56:59], v[152:155]
    s_add_u32 s40, s30, 98304
    v_exp_f32 v179, v179
    v_mfma_f32_16x16x32_bf16 v[152:155], a[140:143], a[60:63], v[152:155]
    s_waitcnt lgkmcnt(5)
    v_fma_f32 v174, v174, s28, v225
    v_cvt_pk_bf16_f32 v217, v178, v179
    v_mfma_f32_16x16x32_bf16 v[8:11], a[168:171], v[192:195], v[8:11]
    s_add_u32 m0, s60, 67584
    v_exp_f32 v184, v184
    v_mfma_f32_16x16x32_bf16 v[12:15], a[172:175], v[192:195], v[12:15]
    buffer_load_dwordx4 v236, s[4:7], s40 offen offset:0 nt lds
    v_mfma_f32_16x16x32_bf16 v[40:43], a[168:171], v[196:199], v[40:43]
    ds_read_b64_tr_b16 a[164:165], v235 offset:33952
    v_fma_f32 v175, v175, s28, v225
    v_mfma_f32_16x16x32_bf16 v[44:47], a[172:175], v[196:199], v[44:47]
    v_exp_f32 v185, v185
    v_mfma_f32_16x16x32_bf16 v[72:75], a[168:171], v[200:203], v[72:75]
    ds_read_b64_tr_b16 a[166:167], v235 offset:34208
    v_cvt_pk_bf16_f32 v220, v184, v185
    v_mfma_f32_16x16x32_bf16 v[76:79], a[172:175], v[200:203], v[76:79]
L_pad2:
    s_cbranch_execz L_pad6
    v_exp_f32 v186, v186
    v_mfma_f32_16x16x32_bf16 v[104:107], a[168:171], v[204:207], v[104:107]
    s_add_u32 m0, s60, 68384
    v_exp_f32 v187, v187
    v_mfma_f32_16x16x32_bf16 v[108:111], a[172:175], v[204:207], v[108:111]
    s_waitcnt lgkmcnt(3)
    buffer_load_dwordx4 v236, s[4:7], s40 offen offset:256 nt lds
    v_mfma_f32_16x16x32_bf16 v[132:135], a[144:147], a[0:3], 0
    v_fma_f32 v180, v180, s28, v226
    v_cvt_pk_bf16_f32 v221, v186, v187
    v_mfma_f32_16x16x32_bf16 v[132:135], a[148:151], a[4:7], v[132:135]
    v_exp_f32 v164, v164
    v_mfma_f32_16x16x32_bf16 v[132:135], a[152:155], a[8:11], v[132:135]
    v_exp_f32 v165, v165
    v_mfma_f32_16x16x32_bf16 v[132:135], a[156:159], a[12:15], v[132:135]
    ds_read_b64_tr_b16 a[168:169], v235 offset:33984
    v_fma_f32 v181, v181, s28, v226
    v_mfma_f32_16x16x32_bf16 v[140:143], a[144:147], a[16:19], 0
    ds_read_b64_tr_b16 a[170:171], v235 offset:34240
    v_cvt_pk_bf16_f32 v210, v164, v165
    v_mfma_f32_16x16x32_bf16 v[140:143], a[148:151], a[20:23], v[140:143]
    v_exp_f32 v166, v166
    v_mfma_f32_16x16x32_bf16 v[140:143], a[152:155], a[24:27], v[140:143]
    v_exp_f32 v167, v167
    v_mfma_f32_16x16x32_bf16 v[140:143], a[156:159], a[28:31], v[140:143]
    s_waitcnt lgkmcnt(2)
    v_fma_f32 v182, v182, s28, v226
    v_cvt_pk_bf16_f32 v211, v166, v167
    v_mfma_f32_16x16x32_bf16 v[16:19], a[160:163], v[192:195], v[16:19]
    buffer_store_dwordx4 a[228:231], v238, s[24:27], s54 offen offset:2048 sc0 sc1
    v_mfma_f32_16x16x32_bf16 v[20:23], a[164:167], v[192:195], v[20:23]
    v_exp_f32 v172, v172
    v_mfma_f32_16x16x32_bf16 v[48:51], a[160:163], v[196:199], v[48:51]
    ds_read_b64_tr_b16 a[172:173], v235 offset:34016
    v_fma_f32 v183, v183, s28, v226
    v_mfma_f32_16x16x32_bf16 v[52:55], a[164:167], v[196:199], v[52:55]
    v_exp_f32 v173, v173
    v_mfma_f32_16x16x32_bf16 v[80:83], a[160:163], v[200:203], v[80:83]
    ds_read_b128 a[128:131], v233 offset:34304
    ds_read_b64_tr_b16 a[174:175], v235 offset:34272
    v_mfma_f32_16x16x32_bf16 v[84:87], a[164:167], v[200:203], v[84:87]
    s_add_u32 m0, s60, 69184
    ds_read_b128 a[132:135], v233 offset:34368
    v_cvt_pk_bf16_f32 v214, v172, v173
    v_mfma_f32_16x16x32_bf16 v[112:115], a[160:163], v[204:207], v[112:115]
    buffer_load_dwordx4 v236, s[4:7], s40 offen offset:512 nt lds
    v_exp_f32 v174, v174
    v_mfma_f32_16x16x32_bf16 v[116:119], a[164:167], v[204:207], v[116:119]
    v_exp_f32 v175, v175
    v_mfma_f32_16x16x32_bf16 v[148:151], a[144:147], a[32:35], 0
    v_fma_f32 v188, v188, s28, v227
    v_cvt_pk_bf16_f32 v215, v174, v175
    v_mfma_f32_16x16x32_bf16 v[148:151], a[148:151], a[36:39], v[148:151]
    v_exp_f32 v180, v180
    v_mfma_f32_16x16x32_bf16 v[148:151], a[152:155], a[40:43], v[148:151]
    ds_read_b128 a[136:139], v233 offset:34432
    v_fma_f32 v189, v189, s28, v227
    v_mfma_f32_16x16x32_bf16 v[148:151], a[156:159], a[44:47], v[148:151]
    v_exp_f32 v181, v181
    v_mfma_f32_16x16x32_bf16 v[156:159], a[144:147], a[48:51], 0
    ds_read_b128 a[140:143], v233 offset:34496
    v_cvt_pk_bf16_f32 v218, v180, v181
    v_mfma_f32_16x16x32_bf16 v[156:159], a[148:151], a[52:55], v[156:159]
    s_add_u32 m0, s60, 69984
    v_exp_f32 v182, v182
    v_mfma_f32_16x16x32_bf16 v[156:159], a[152:155], a[56:59], v[156:159]
    buffer_load_dwordx4 v236, s[4:7], s40 offen offset:768 nt lds
    ds_read_b64_tr_b16 a[160:161], v235 offset:34304
    v_mfma_f32_16x16x32_bf16 v[156:159], a[156:159], a[60:63], v[156:159]
    s_waitcnt lgkmcnt(4)
    v_exp_f32 v183, v183
    v_mfma_f32_16x16x32_bf16 v[24:27], a[168:171], v[192:195], v[24:27]
    ds_read_b64_tr_b16 a[162:163], v235 offset:34560
    v_fma_f32 v190, v190, s28, v227
    v_mfma_f32_16x16x32_bf16 v[28:31], a[172:175], v[192:195], v[28:31]
    v_cvt_pk_bf16_f32 v219, v182, v183
    v_fma_f32 v191, v191, s28, v227
    v_mfma_f32_16x16x32_bf16 v[56:59], a[168:171], v[196:199], v[56:59]
    v_exp_f32 v188, v188
    v_mfma_f32_16x16x32_bf16 v[60:63], a[172:175], v[196:199], v[60:63]
    v_exp_f32 v189, v189
    v_mfma_f32_16x16x32_bf16 v[88:91], a[168:171], v[200:203], v[88:91]
    ds_read_b64_tr_b16 a[164:165], v235 offset:34336
    v_cvt_pk_bf16_f32 v222, v188, v189
    v_mfma_f32_16x16x32_bf16 v[92:95], a[172:175], v[200:203], v[92:95]
    v_exp_f32 v190, v190
    v_mfma_f32_16x16x32_bf16 v[120:123], a[168:171], v[204:207], v[120:123]
    buffer_store_dwordx4 a[240:243], v238, s[24:27], s55 offen offset:0 sc0 sc1
    v_mfma_f32_16x16x32_bf16 v[124:127], a[172:175], v[204:207], v[124:127]
    s_waitcnt lgkmcnt(3)
    ds_read_b64_tr_b16 a[166:167], v235 offset:34592
    ds_read_b64_tr_b16 a[168:169], v235 offset:34368
    v_exp_f32 v191, v191
    v_fma_f32 v132, v132, s28, v224
    v_pk_fma_f32 v[128:129], v[128:129], s[64:65], v[224:225] op_sel_hi:[1,1,0]
    v_pk_fma_f32 v[130:131], v[130:131], s[64:65], v[224:225] op_sel_hi:[1,1,0]
    v_pk_fma_f32 v[136:137], v[136:137], s[64:65], v[224:225] op_sel:[0,0,1] op_sel_hi:[1,1,1]
    v_pk_fma_f32 v[138:139], v[138:139], s[64:65], v[224:225] op_sel:[0,0,1] op_sel_hi:[1,1,1]
    v_pk_fma_f32 v[144:145], v[144:145], s[64:65], v[226:227] op_sel_hi:[1,1,0]
    v_pk_fma_f32 v[146:147], v[146:147], s[64:65], v[226:227] op_sel_hi:[1,1,0]
    v_pk_fma_f32 v[152:153], v[152:153], s[64:65], v[226:227] op_sel:[0,0,1] op_sel_hi:[1,1,1]
    v_pk_fma_f32 v[154:155], v[154:155], s[64:65], v[226:227] op_sel:[0,0,1] op_sel_hi:[1,1,1]
    v_fma_f32 v133, v133, s28, v224
    v_mfma_f32_16x16x32_bf16 v[160:163], a[128:131], a[0:3], 0
    v_exp_f32 v128, v128
    v_mfma_f32_16x16x32_bf16 v[160:163], a[132:135], a[4:7], v[160:163]
    v_exp_f32 v129, v129
    v_cvt_pk_bf16_f32 v223, v190, v191
    v_mfma_f32_16x16x32_bf16 v[160:163], a[136:139], a[8:11], v[160:163]
    s_add_u32 s41, s30, 81920
    v_exp_f32 v130, v130
    v_mfma_f32_16x16x32_bf16 v[160:163], a[140:143], a[12:15], v[160:163]
    s_add_u32 m0, s60, 84480
    v_cvt_pk_bf16_f32 v192, v128, v129
    v_fma_f32 v134, v134, s28, v224
    v_mfma_f32_16x16x32_bf16 v[168:171], a[128:131], a[16:19], 0
    buffer_load_dwordx4 v236, s[8:11], s41 offen offset:0 nt lds
    v_mfma_f32_16x16x32_bf16 v[168:171], a[132:135], a[20:23], v[168:171]
    v_exp_f32 v131, v131
    v_mfma_f32_16x16x32_bf16 v[168:171], a[136:139], a[24:27], v[168:171]
    ds_read_b64_tr_b16 a[170:171], v235 offset:34624
    v_cvt_pk_bf16_f32 v193, v130, v131
    v_mfma_f32_16x16x32_bf16 v[168:171], a[140:143], a[28:31], v[168:171]
    v_exp_f32 v136, v136
    v_smfmac_f32_16x16x64_bf16 a[176:179], a[184:187], v[208:215], v251
    ds_read_b64_tr_b16 a[172:173], v235 offset:34400
    v_fma_f32 v135, v135, s28, v224
    v_smfmac_f32_16x16x64_bf16 a[180:183], a[184:187], v[216:223], v251
    s_waitcnt lgkmcnt(3)
    ds_read_b128 a[144:147], v233 offset:34560
    ds_read_b64_tr_b16 a[174:175], v235 offset:34656
    v_mfma_f32_16x16x32_bf16 v[0:3], a[160:163], v[208:211], v[0:3]
    v_exp_f32 v137, v137
    v_mfma_f32_16x16x32_bf16 v[4:7], a[164:167], v[208:211], v[4:7]
    s_add_u32 m0, s60, 85280
    v_cvt_pk_bf16_f32 v196, v136, v137
    v_fma_f32 v140, v140, s28, v225
    v_mfma_f32_16x16x32_bf16 v[32:35], a[160:163], v[212:215], v[32:35]
    buffer_load_dwordx4 v236, s[8:11], s41 offen offset:256 nt lds
    v_mfma_f32_16x16x32_bf16 v[36:39], a[164:167], v[212:215], v[36:39]
    v_exp_f32 v138, v138
    v_mfma_f32_16x16x32_bf16 v[64:67], a[160:163], v[216:219], v[64:67]
    v_exp_f32 v139, v139
    v_mfma_f32_16x16x32_bf16 v[68:71], a[164:167], v[216:219], v[68:71]
    ds_read_b128 a[148:151], v233 offset:34624
    v_cvt_pk_bf16_f32 v197, v138, v139
    v_mfma_f32_16x16x32_bf16 v[96:99], a[160:163], v[220:223], v[96:99]
    v_exp_f32 v144, v144
    v_mfma_f32_16x16x32_bf16 v[100:103], a[164:167], v[220:223], v[100:103]
    ds_read_b128 a[152:155], v233 offset:34688
    v_fma_f32 v141, v141, s28, v225
    v_mfma_f32_16x16x32_bf16 v[176:179], a[128:131], a[32:35], 0
    s_add_u32 m0, s60, 86080
    v_exp_f32 v145, v145
    v_mfma_f32_16x16x32_bf16 v[176:179], a[132:135], a[36:39], v[176:179]
    buffer_load_dwordx4 v236, s[8:11], s41 offen offset:512 nt lds
    v_mfma_f32_16x16x32_bf16 v[176:179], a[136:139], a[40:43], v[176:179]
    ds_read_b64_tr_b16 a[160:161], v235 offset:34432
    v_cvt_pk_bf16_f32 v200, v144, v145
    v_mfma_f32_16x16x32_bf16 v[176:179], a[140:143], a[44:47], v[176:179]
    v_exp_f32 v146, v146
    v_mfma_f32_16x16x32_bf16 v[184:187], a[128:131], a[48:51], 0
    ds_read_b128 a[156:159], v233 offset:34752
    v_fma_f32 v142, v142, s28, v225
    v_mfma_f32_16x16x32_bf16 v[184:187], a[132:135], a[52:55], v[184:187]
    v_exp_f32 v147, v147
    v_mfma_f32_16x16x32_bf16 v[184:187], a[136:139], a[56:59], v[184:187]
    ds_read_b64_tr_b16 a[162:163], v235 offset:34688
    v_cvt_pk_bf16_f32 v201, v146, v147
    v_mfma_f32_16x16x32_bf16 v[184:187], a[140:143], a[60:63], v[184:187]
    s_waitcnt lgkmcnt(5)
    v_exp_f32 v152, v152
    v_mfma_f32_16x16x32_bf16 v[8:11], a[168:171], v[208:211], v[8:11]
    ds_read_b64_tr_b16 a[164:165], v235 offset:34464
    v_fma_f32 v143, v143, s28, v225
    v_mfma_f32_16x16x32_bf16 v[12:15], a[172:175], v[208:211], v[12:15]
    v_exp_f32 v153, v153
    v_mfma_f32_16x16x32_bf16 v[40:43], a[168:171], v[212:215], v[40:43]
    buffer_store_dwordx4 a[244:247], v238, s[24:27], s55 offen offset:2048 sc0 sc1
    v_mfma_f32_16x16x32_bf16 v[44:47], a[172:175], v[212:215], v[44:47]
    ds_read_b64_tr_b16 a[166:167], v235 offset:34720
    v_cvt_pk_bf16_f32 v204, v152, v153
    v_mfma_f32_16x16x32_bf16 v[72:75], a[168:171], v[216:219], v[72:75]
    v_exp_f32 v154, v154
    v_mfma_f32_16x16x32_bf16 v[76:79], a[172:175], v[216:219], v[76:79]
    v_exp_f32 v155, v155
    v_mfma_f32_16x16x32_bf16 v[104:107], a[168:171], v[220:223], v[104:107]
    v_fma_f32 v148, v148, s28, v226
    v_cvt_pk_bf16_f32 v205, v154, v155
    v_mfma_f32_16x16x32_bf16 v[108:111], a[172:175], v[220:223], v[108:111]
    s_waitcnt lgkmcnt(3)
    v_exp_f32 v132, v132
    v_mfma_f32_16x16x32_bf16 v[164:167], a[144:147], a[0:3], 0
    s_add_u32 m0, s60, 86880
    v_exp_f32 v133, v133
    v_mfma_f32_16x16x32_bf16 v[164:167], a[148:151], a[4:7], v[164:167]
    buffer_load_dwordx4 v236, s[8:11], s41 offen offset:768 nt lds
    v_mfma_f32_16x16x32_bf16 v[164:167], a[152:155], a[8:11], v[164:167]
    v_fma_f32 v149, v149, s28, v226
    v_cvt_pk_bf16_f32 v194, v132, v133
    v_mfma_f32_16x16x32_bf16 v[164:167], a[156:159], a[12:15], v[164:167]
    ds_read_b64_tr_b16 a[168:169], v235 offset:34496
    v_fma_f32 v150, v150, s28, v226
    v_mfma_f32_16x16x32_bf16 v[172:175], a[144:147], a[16:19], 0
    v_exp_f32 v134, v134
    v_mfma_f32_16x16x32_bf16 v[172:175], a[148:151], a[20:23], v[172:175]
    v_exp_f32 v135, v135
    v_mfma_f32_16x16x32_bf16 v[172:175], a[152:155], a[24:27], v[172:175]
    ds_read_b64_tr_b16 a[170:171], v235 offset:34752
    v_cvt_pk_bf16_f32 v195, v134, v135
    v_mfma_f32_16x16x32_bf16 v[172:175], a[156:159], a[28:31], v[172:175]
    s_waitcnt lgkmcnt(2)
    v_exp_f32 v140, v140
    v_mfma_f32_16x16x32_bf16 v[16:19], a[160:163], v[208:211], v[16:19]
    ds_read_b64_tr_b16 a[172:173], v235 offset:34528
    ds_read_b64_tr_b16 a[174:175], v235 offset:34784
    v_mfma_f32_16x16x32_bf16 v[20:23], a[164:167], v[208:211], v[20:23]
    v_exp_f32 v141, v141
    v_mfma_f32_16x16x32_bf16 v[48:51], a[160:163], v[212:215], v[48:51]
    v_fma_f32 v151, v151, s28, v226
    v_cvt_pk_bf16_f32 v198, v140, v141
    v_mfma_f32_16x16x32_bf16 v[52:55], a[164:167], v[212:215], v[52:55]
    v_exp_f32 v142, v142
    v_mfma_f32_16x16x32_bf16 v[80:83], a[160:163], v[216:219], v[80:83]
    v_exp_f32 v143, v143
    v_mfma_f32_16x16x32_bf16 v[84:87], a[164:167], v[216:219], v[84:87]
    v_fma_f32 v156, v156, s28, v227
    v_cvt_pk_bf16_f32 v199, v142, v143
    v_mfma_f32_16x16x32_bf16 v[112:115], a[160:163], v[220:223], v[112:115]
    s_waitcnt vmcnt(22) lgkmcnt(0)
    s_barrier
    v_exp_f32 v148, v148
    v_mfma_f32_16x16x32_bf16 v[116:119], a[164:167], v[220:223], v[116:119]
    ds_read_b128 a[128:131], v232 offset:0
    ds_read_b128 a[64:67], v237 offset:0
    v_mfma_f32_16x16x32_bf16 v[180:183], a[144:147], a[32:35], 0
    v_exp_f32 v149, v149
    v_mfma_f32_16x16x32_bf16 v[180:183], a[148:151], a[36:39], v[180:183]
    ds_read_b128 a[132:135], v232 offset:64
    v_fma_f32 v157, v157, s28, v227
    v_mfma_f32_16x16x32_bf16 v[180:183], a[152:155], a[40:43], v[180:183]
    ds_read_b128 a[68:71], v252 offset:0
    v_cvt_pk_bf16_f32 v202, v148, v149
    v_mfma_f32_16x16x32_bf16 v[180:183], a[156:159], a[44:47], v[180:183]
    ds_read_b128 a[136:139], v232 offset:128
    ds_read_b128 a[72:75], v237 offset:2048
    v_mfma_f32_16x16x32_bf16 v[188:191], a[144:147], a[48:51], 0
    v_exp_f32 v150, v150
    v_mfma_f32_16x16x32_bf16 v[188:191], a[148:151], a[52:55], v[188:191]
    ds_read_b128 a[140:143], v232 offset:192
    v_fma_f32 v158, v158, s28, v227
    v_mfma_f32_16x16x32_bf16 v[188:191], a[152:155], a[56:59], v[188:191]
    v_exp_f32 v151, v151
    v_mfma_f32_16x16x32_bf16 v[188:191], a[156:159], a[60:63], v[188:191]
    ds_read_b128 a[76:79], v252 offset:2048
    ds_read_b64_tr_b16 a[160:161], v234 offset:0
    v_mfma_f32_16x16x32_bf16 v[24:27], a[168:171], v[208:211], v[24:27]
    ds_read_b64_tr_b16 a[162:163], v234 offset:256
    v_cvt_pk_bf16_f32 v203, v150, v151
    v_exp_f32 v156, v156
    v_mfma_f32_16x16x32_bf16 v[28:31], a[172:175], v[208:211], v[28:31]
    v_exp_f32 v157, v157
    v_mfma_f32_16x16x32_bf16 v[56:59], a[168:171], v[212:215], v[56:59]
    ds_read_b64_tr_b16 a[164:165], v234 offset:32
    v_fma_f32 v159, v159, s28, v227
    v_mfma_f32_16x16x32_bf16 v[60:63], a[172:175], v[212:215], v[60:63]
    ds_read_b64_tr_b16 a[166:167], v234 offset:288
    v_cvt_pk_bf16_f32 v206, v156, v157
    v_mfma_f32_16x16x32_bf16 v[88:91], a[168:171], v[216:219], v[88:91]
    v_exp_f32 v158, v158
    v_mfma_f32_16x16x32_bf16 v[92:95], a[172:175], v[216:219], v[92:95]
    v_exp_f32 v159, v159
    v_mfma_f32_16x16x32_bf16 v[120:123], a[168:171], v[220:223], v[120:123]
    v_cvt_pk_bf16_f32 v207, v158, v159
    v_mfma_f32_16x16x32_bf16 v[124:127], a[172:175], v[220:223], v[124:127]
    s_waitcnt lgkmcnt(5)
    v_mfma_f32_16x16x32_bf16 v[128:131], a[128:131], a[0:3], 0
    ds_read_b64_tr_b16 a[168:169], v234 offset:64
    ds_read_b64_tr_b16 a[170:171], v234 offset:320
    v_fma_f32 v164, v164, s28, v224
    v_fma_f32 v165, v165, s28, v224
    v_pk_fma_f32 v[160:161], v[160:161], s[64:65], v[224:225] op_sel_hi:[1,1,0]
    v_pk_fma_f32 v[162:163], v[162:163], s[64:65], v[224:225] op_sel_hi:[1,1,0]
    v_pk_fma_f32 v[168:169], v[168:169], s[64:65], v[224:225] op_sel:[0,0,1] op_sel_hi:[1,1,1]
    v_pk_fma_f32 v[170:171], v[170:171], s[64:65], v[224:225] op_sel:[0,0,1] op_sel_hi:[1,1,1]
    v_pk_fma_f32 v[176:177], v[176:177], s[64:65], v[226:227] op_sel_hi:[1,1,0]
    v_pk_fma_f32 v[178:179], v[178:179], s[64:65], v[226:227] op_sel_hi:[1,1,0]
    v_pk_fma_f32 v[184:185], v[184:185], s[64:65], v[226:227] op_sel:[0,0,1] op_sel_hi:[1,1,1]
    v_pk_fma_f32 v[186:187], v[186:187], s[64:65], v[226:227] op_sel:[0,0,1] op_sel_hi:[1,1,1]
    s_nop 0
    v_mfma_f32_16x16x32_bf16 v[128:131], a[132:135], a[4:7], v[128:131]
    v_exp_f32 v160, v160
    v_mfma_f32_16x16x32_bf16 v[128:131], a[136:139], a[8:11], v[128:131]
    s_waitcnt lgkmcnt(6)
    v_exp_f32 v161, v161
    v_mfma_f32_16x16x32_bf16 v[128:131], a[140:143], a[12:15], v[128:131]
    v_exp_f32 v162, v162
    v_mfma_f32_16x16x32_bf16 v[136:139], a[128:131], a[16:19], 0
    s_add_u32 m0, s66, 4294967168
    v_cvt_pk_bf16_f32 v208, v160, v161
    v_fma_f32 v166, v166, s28, v224
    v_mfma_f32_16x16x32_bf16 v[136:139], a[132:135], a[20:23], v[136:139]
    buffer_load_dwordx4 v238, s[12:15], s57 offen offset:128 nt lds
    v_mfma_f32_16x16x32_bf16 v[136:139], a[136:139], a[24:27], v[136:139]
    v_exp_f32 v163, v163
    v_mfma_f32_16x16x32_bf16 v[136:139], a[140:143], a[28:31], v[136:139]
    ds_read_b64_tr_b16 a[172:173], v234 offset:96
    v_cvt_pk_bf16_f32 v209, v162, v163
    v_smfmac_f32_16x16x64_bf16 a[176:179], a[184:187], v[192:199], v251
    ds_read_b128 a[144:147], v232 offset:256
    v_fma_f32 v167, v167, s28, v224
    v_smfmac_f32_16x16x64_bf16 a[180:183], a[184:187], v[200:207], v251
    s_waitcnt lgkmcnt(4)
    ds_read_b64_tr_b16 a[174:175], v234 offset:352
    v_mfma_f32_16x16x32_bf16 v[0:3], a[160:163], v[192:195], v[0:3]
    v_exp_f32 v168, v168
    v_mfma_f32_16x16x32_bf16 v[4:7], a[164:167], v[192:195], v[4:7]
    s_add_u32 m0, s66, 4294966144
    v_exp_f32 v169, v169
    v_mfma_f32_16x16x32_bf16 v[32:35], a[160:163], v[196:199], v[32:35]
    buffer_load_dwordx4 v238, s[12:15], s57 offen offset:2176 nt lds
    v_mfma_f32_16x16x32_bf16 v[36:39], a[164:167], v[196:199], v[36:39]
    ds_read_b128 a[148:151], v232 offset:320
    v_cvt_pk_bf16_f32 v212, v168, v169
    v_mfma_f32_16x16x32_bf16 v[64:67], a[160:163], v[200:203], v[64:67]
    v_exp_f32 v170, v170
    v_mfma_f32_16x16x32_bf16 v[68:71], a[164:167], v[200:203], v[68:71]
    v_exp_f32 v171, v171
    v_mfma_f32_16x16x32_bf16 v[96:99], a[160:163], v[204:207], v[96:99]
    v_fma_f32 v172, v172, s28, v225
    v_cvt_pk_bf16_f32 v213, v170, v171
    v_mfma_f32_16x16x32_bf16 v[100:103], a[164:167], v[204:207], v[100:103]
    v_exp_f32 v176, v176
    v_mfma_f32_16x16x32_bf16 v[144:147], a[128:131], a[32:35], 0
    ds_read_b128 a[152:155], v232 offset:384
    v_fma_f32 v173, v173, s28, v225
    v_mfma_f32_16x16x32_bf16 v[144:147], a[132:135], a[36:39], v[144:147]
    s_add_u32 m0, s66, 2048
    v_exp_f32 v177, v177
    v_mfma_f32_16x16x32_bf16 v[144:147], a[136:139], a[40:43], v[144:147]
    buffer_load_dwordx4 v238, s[16:19], s58 offen offset:0 nt lds
    v_mfma_f32_16x16x32_bf16 v[144:147], a[140:143], a[44:47], v[144:147]
    ds_read_b64_tr_b16 a[160:161], v234 offset:128
    ds_read_b128 a[156:159], v232 offset:448
    v_mfma_f32_16x16x32_bf16 v[152:155], a[128:131], a[48:51], 0
    ds_read_b64_tr_b16 a[162:163], v234 offset:384
    v_cvt_pk_bf16_f32 v216, v176, v177
    v_mfma_f32_16x16x32_bf16 v[152:155], a[132:135], a[52:55], v[152:155]
    v_exp_f32 v178, v178
    v_mfma_f32_16x16x32_bf16 v[152:155], a[136:139], a[56:59], v[152:155]
    v_exp_f32 v179, v179
    v_mfma_f32_16x16x32_bf16 v[152:155], a[140:143], a[60:63], v[152:155]
    s_waitcnt lgkmcnt(5)
    v_fma_f32 v174, v174, s28, v225
    v_cvt_pk_bf16_f32 v217, v178, v179
    v_mfma_f32_16x16x32_bf16 v[8:11], a[168:171], v[192:195], v[8:11]
    v_exp_f32 v184, v184
    v_mfma_f32_16x16x32_bf16 v[12:15], a[172:175], v[192:195], v[12:15]
    s_add_u32 m0, s66, 1024
    ds_read_b64_tr_b16 a[164:165], v234 offset:160
    v_fma_f32 v175, v175, s28, v225
    v_mfma_f32_16x16x32_bf16 v[40:43], a[168:171], v[196:199], v[40:43]
    buffer_load_dwordx4 v238, s[16:19], s58 offen offset:2048 nt lds
    v_mfma_f32_16x16x32_bf16 v[44:47], a[172:175], v[196:199], v[44:47]
    v_exp_f32 v185, v185
    v_mfma_f32_16x16x32_bf16 v[72:75], a[168:171], v[200:203], v[72:75]
    ds_read_b64_tr_b16 a[166:167], v234 offset:416
    v_cvt_pk_bf16_f32 v220, v184, v185
    v_mfma_f32_16x16x32_bf16 v[76:79], a[172:175], v[200:203], v[76:79]
    v_exp_f32 v186, v186
    v_mfma_f32_16x16x32_bf16 v[104:107], a[168:171], v[204:207], v[104:107]
    v_exp_f32 v187, v187
    v_mfma_f32_16x16x32_bf16 v[108:111], a[172:175], v[204:207], v[108:111]
    s_waitcnt lgkmcnt(3)
    v_fma_f32 v180, v180, s28, v226
    v_cvt_pk_bf16_f32 v221, v186, v187
    v_mfma_f32_16x16x32_bf16 v[132:135], a[144:147], a[0:3], 0
    s_add_u32 s40, s30, 114688
    v_exp_f32 v164, v164
    v_mfma_f32_16x16x32_bf16 v[132:135], a[148:151], a[4:7], v[132:135]
    s_add_u32 m0, s60, 101376
    v_exp_f32 v165, v165
    v_mfma_f32_16x16x32_bf16 v[132:135], a[152:155], a[8:11], v[132:135]
    buffer_load_dwordx4 v236, s[4:7], s40 offen offset:0 nt lds
    v_mfma_f32_16x16x32_bf16 v[132:135], a[156:159], a[12:15], v[132:135]
    ds_read_b64_tr_b16 a[168:169], v234 offset:192
    v_fma_f32 v181, v181, s28, v226
    v_mfma_f32_16x16x32_bf16 v[140:143], a[144:147], a[16:19], 0
    ds_read_b64_tr_b16 a[170:171], v234 offset:448
    v_cvt_pk_bf16_f32 v210, v164, v165
    v_mfma_f32_16x16x32_bf16 v[140:143], a[148:151], a[20:23], v[140:143]
    v_exp_f32 v166, v166
    v_mfma_f32_16x16x32_bf16 v[140:143], a[152:155], a[24:27], v[140:143]
    v_exp_f32 v167, v167
    v_mfma_f32_16x16x32_bf16 v[140:143], a[156:159], a[28:31], v[140:143]
    s_waitcnt lgkmcnt(2)
    v_fma_f32 v182, v182, s28, v226
    v_cvt_pk_bf16_f32 v211, v166, v167
    v_mfma_f32_16x16x32_bf16 v[16:19], a[160:163], v[192:195], v[16:19]
    v_exp_f32 v172, v172
    v_mfma_f32_16x16x32_bf16 v[20:23], a[164:167], v[192:195], v[20:23]
    s_add_u32 m0, s60, 102176
    ds_read_b64_tr_b16 a[172:173], v234 offset:224
    v_fma_f32 v183, v183, s28, v226
    v_mfma_f32_16x16x32_bf16 v[48:51], a[160:163], v[196:199], v[48:51]
    buffer_load_dwordx4 v236, s[4:7], s40 offen offset:256 nt lds
    v_mfma_f32_16x16x32_bf16 v[52:55], a[164:167], v[196:199], v[52:55]
    v_exp_f32 v173, v173
    v_mfma_f32_16x16x32_bf16 v[80:83], a[160:163], v[200:203], v[80:83]
    ds_read_b128 a[128:131], v232 offset:512
    ds_read_b64_tr_b16 a[174:175], v234 offset:480
    v_mfma_f32_16x16x32_bf16 v[84:87], a[164:167], v[200:203], v[84:87]
    ds_read_b128 a[132:135], v232 offset:576
    v_cvt_pk_bf16_f32 v214, v172, v173
    v_mfma_f32_16x16x32_bf16 v[112:115], a[160:163], v[204:207], v[112:115]
    v_exp_f32 v174, v174
    v_mfma_f32_16x16x32_bf16 v[116:119], a[164:167], v[204:207], v[116:119]
    v_exp_f32 v175, v175
    v_mfma_f32_16x16x32_bf16 v[148:151], a[144:147], a[32:35], 0
    v_fma_f32 v188, v188, s28, v227
    v_cvt_pk_bf16_f32 v215, v174, v175
    v_mfma_f32_16x16x32_bf16 v[148:151], a[148:151], a[36:39], v[148:151]
    s_add_u32 m0, s60, 102976
    v_exp_f32 v180, v180
    v_mfma_f32_16x16x32_bf16 v[148:151], a[152:155], a[40:43], v[148:151]
    buffer_load_dwordx4 v236, s[4:7], s40 offen offset:512 nt lds
    ds_read_b128 a[136:139], v232 offset:640
    v_mfma_f32_16x16x32_bf16 v[148:151], a[156:159], a[44:47], v[148:151]
    v_exp_f32 v181, v181
    v_mfma_f32_16x16x32_bf16 v[156:159], a[144:147], a[48:51], 0
    ds_read_b128 a[140:143], v232 offset:704
    v_fma_f32 v189, v189, s28, v227
    v_mfma_f32_16x16x32_bf16 v[156:159], a[148:151], a[52:55], v[156:159]
    ds_read_b64_tr_b16 a[160:161], v234 offset:512
    v_cvt_pk_bf16_f32 v218, v180, v181
    v_mfma_f32_16x16x32_bf16 v[156:159], a[152:155], a[56:59], v[156:159]
    v_exp_f32 v182, v182
    v_mfma_f32_16x16x32_bf16 v[156:159], a[156:159], a[60:63], v[156:159]
    s_waitcnt lgkmcnt(4)
    v_exp_f32 v183, v183
    v_mfma_f32_16x16x32_bf16 v[24:27], a[168:171], v[192:195], v[24:27]
    ds_read_b64_tr_b16 a[162:163], v234 offset:768
    v_fma_f32 v190, v190, s28, v227
    v_mfma_f32_16x16x32_bf16 v[28:31], a[172:175], v[192:195], v[28:31]
    s_add_u32 m0, s60, 103776
    v_cvt_pk_bf16_f32 v219, v182, v183
    v_fma_f32 v191, v191, s28, v227
    v_mfma_f32_16x16x32_bf16 v[56:59], a[168:171], v[196:199], v[56:59]
    buffer_load_dwordx4 v236, s[4:7], s40 offen offset:768 nt lds
    v_exp_f32 v188, v188
    v_mfma_f32_16x16x32_bf16 v[60:63], a[172:175], v[196:199], v[60:63]
    v_exp_f32 v189, v189
    v_mfma_f32_16x16x32_bf16 v[88:91], a[168:171], v[200:203], v[88:91]
    ds_read_b64_tr_b16 a[164:165], v234 offset:544
    v_cvt_pk_bf16_f32 v222, v188, v189
    v_mfma_f32_16x16x32_bf16 v[92:95], a[172:175], v[200:203], v[92:95]
    v_exp_f32 v190, v190
    v_mfma_f32_16x16x32_bf16 v[120:123], a[168:171], v[204:207], v[120:123]
    v_exp_f32 v191, v191
    v_mfma_f32_16x16x32_bf16 v[124:127], a[172:175], v[204:207], v[124:127]
    s_waitcnt lgkmcnt(3)
    ds_read_b64_tr_b16 a[166:167], v234 offset:800
    ds_read_b64_tr_b16 a[168:169], v234 offset:576
    v_fma_f32 v132, v132, s28, v224
    v_cvt_pk_bf16_f32 v223, v190, v191
    v_pk_fma_f32 v[128:129], v[128:129], s[64:65], v[224:225] op_sel_hi:[1,1,0]
    v_pk_fma_f32 v[130:131], v[130:131], s[64:65], v[224:225] op_sel_hi:[1,1,0]
    v_pk_fma_f32 v[136:137], v[136:137], s[64:65], v[224:225] op_sel:[0,0,1] op_sel_hi:[1,1,1]
    v_pk_fma_f32 v[138:139], v[138:139], s[64:65], v[224:225] op_sel:[0,0,1] op_sel_hi:[1,1,1]
    v_pk_fma_f32 v[144:145], v[144:145], s[64:65], v[226:227] op_sel_hi:[1,1,0]
    v_pk_fma_f32 v[146:147], v[146:147], s[64:65], v[226:227] op_sel_hi:[1,1,0]
    v_pk_fma_f32 v[152:153], v[152:153], s[64:65], v[226:227] op_sel:[0,0,1] op_sel_hi:[1,1,1]
    v_pk_fma_f32 v[154:155], v[154:155], s[64:65], v[226:227] op_sel:[0,0,1] op_sel_hi:[1,1,1]
    v_fma_f32 v133, v133, s28, v224
    v_mfma_f32_16x16x32_bf16 v[160:163], a[128:131], a[0:3], 0
    s_add_u32 s41, s30, 98304
    v_exp_f32 v128, v128
    v_mfma_f32_16x16x32_bf16 v[160:163], a[132:135], a[4:7], v[160:163]
    s_add_u32 m0, s60, 118272
    v_exp_f32 v129, v129
    v_mfma_f32_16x16x32_bf16 v[160:163], a[136:139], a[8:11], v[160:163]
    buffer_load_dwordx4 v236, s[8:11], s41 offen offset:0 nt lds
    v_mfma_f32_16x16x32_bf16 v[160:163], a[140:143], a[12:15], v[160:163]
    v_cvt_pk_bf16_f32 v192, v128, v129
    v_fma_f32 v134, v134, s28, v224
    v_mfma_f32_16x16x32_bf16 v[168:171], a[128:131], a[16:19], 0
    v_exp_f32 v130, v130
    v_mfma_f32_16x16x32_bf16 v[168:171], a[132:135], a[20:23], v[168:171]
    v_exp_f32 v131, v131
    v_mfma_f32_16x16x32_bf16 v[168:171], a[136:139], a[24:27], v[168:171]
    ds_read_b64_tr_b16 a[170:171], v234 offset:832
    v_cvt_pk_bf16_f32 v193, v130, v131
    v_mfma_f32_16x16x32_bf16 v[168:171], a[140:143], a[28:31], v[168:171]
    v_exp_f32 v136, v136
    v_smfmac_f32_16x16x64_bf16 a[176:179], a[184:187], v[208:215], v251
    ds_read_b64_tr_b16 a[172:173], v234 offset:608
    v_fma_f32 v135, v135, s28, v224
    v_smfmac_f32_16x16x64_bf16 a[180:183], a[184:187], v[216:223], v251
    s_waitcnt lgkmcnt(3)
    ds_read_b128 a[144:147], v232 offset:768
    ds_read_b64_tr_b16 a[174:175], v234 offset:864
    v_mfma_f32_16x16x32_bf16 v[0:3], a[160:163], v[208:211], v[0:3]
    s_add_u32 m0, s60, 119072
    v_exp_f32 v137, v137
    v_mfma_f32_16x16x32_bf16 v[4:7], a[164:167], v[208:211], v[4:7]
    buffer_load_dwordx4 v236, s[8:11], s41 offen offset:256 nt lds
    v_mfma_f32_16x16x32_bf16 v[32:35], a[160:163], v[212:215], v[32:35]
    v_cvt_pk_bf16_f32 v196, v136, v137
    v_fma_f32 v140, v140, s28, v225
    v_mfma_f32_16x16x32_bf16 v[36:39], a[164:167], v[212:215], v[36:39]
    v_exp_f32 v138, v138
    v_mfma_f32_16x16x32_bf16 v[64:67], a[160:163], v[216:219], v[64:67]
    v_exp_f32 v139, v139
    v_mfma_f32_16x16x32_bf16 v[68:71], a[164:167], v[216:219], v[68:71]
    ds_read_b128 a[148:151], v232 offset:832
    v_cvt_pk_bf16_f32 v197, v138, v139
    v_mfma_f32_16x16x32_bf16 v[96:99], a[160:163], v[220:223], v[96:99]
    v_exp_f32 v144, v144
    v_mfma_f32_16x16x32_bf16 v[100:103], a[164:167], v[220:223], v[100:103]
    s_add_u32 m0, s60, 119872
    ds_read_b128 a[152:155], v232 offset:896
    v_fma_f32 v141, v141, s28, v225
    v_mfma_f32_16x16x32_bf16 v[176:179], a[128:131], a[32:35], 0
    buffer_load_dwordx4 v236, s[8:11], s41 offen offset:512 nt lds
    v_mfma_f32_16x16x32_bf16 v[176:179], a[132:135], a[36:39], v[176:179]
    v_exp_f32 v145, v145
    v_mfma_f32_16x16x32_bf16 v[176:179], a[136:139], a[40:43], v[176:179]
    ds_read_b64_tr_b16 a[160:161], v234 offset:640
    v_cvt_pk_bf16_f32 v200, v144, v145
    v_mfma_f32_16x16x32_bf16 v[176:179], a[140:143], a[44:47], v[176:179]
    v_exp_f32 v146, v146
    v_mfma_f32_16x16x32_bf16 v[184:187], a[128:131], a[48:51], 0
    ds_read_b128 a[156:159], v232 offset:960
    v_fma_f32 v142, v142, s28, v225
    v_mfma_f32_16x16x32_bf16 v[184:187], a[132:135], a[52:55], v[184:187]
    v_exp_f32 v147, v147
    v_mfma_f32_16x16x32_bf16 v[184:187], a[136:139], a[56:59], v[184:187]
    ds_read_b64_tr_b16 a[162:163], v234 offset:896
    v_cvt_pk_bf16_f32 v201, v146, v147
    v_mfma_f32_16x16x32_bf16 v[184:187], a[140:143], a[60:63], v[184:187]
    s_waitcnt lgkmcnt(5)
    v_exp_f32 v152, v152
    v_mfma_f32_16x16x32_bf16 v[8:11], a[168:171], v[208:211], v[8:11]
    s_add_u32 m0, s60, 120672
    ds_read_b64_tr_b16 a[164:165], v234 offset:672
    v_fma_f32 v143, v143, s28, v225
    v_mfma_f32_16x16x32_bf16 v[12:15], a[172:175], v[208:211], v[12:15]
    buffer_load_dwordx4 v236, s[8:11], s41 offen offset:768 nt lds
    v_mfma_f32_16x16x32_bf16 v[40:43], a[168:171], v[212:215], v[40:43]
    v_exp_f32 v153, v153
    v_mfma_f32_16x16x32_bf16 v[44:47], a[172:175], v[212:215], v[44:47]
    ds_read_b64_tr_b16 a[166:167], v234 offset:928
    v_cvt_pk_bf16_f32 v204, v152, v153
    v_mfma_f32_16x16x32_bf16 v[72:75], a[168:171], v[216:219], v[72:75]
    v_exp_f32 v154, v154
    v_mfma_f32_16x16x32_bf16 v[76:79], a[172:175], v[216:219], v[76:79]
    v_exp_f32 v155, v155
    v_mfma_f32_16x16x32_bf16 v[104:107], a[168:171], v[220:223], v[104:107]
    v_fma_f32 v148, v148, s28, v226
    v_cvt_pk_bf16_f32 v205, v154, v155
    v_mfma_f32_16x16x32_bf16 v[108:111], a[172:175], v[220:223], v[108:111]
    s_waitcnt lgkmcnt(3)
    v_exp_f32 v132, v132
    v_mfma_f32_16x16x32_bf16 v[164:167], a[144:147], a[0:3], 0
    v_exp_f32 v133, v133
    v_mfma_f32_16x16x32_bf16 v[164:167], a[148:151], a[4:7], v[164:167]
    v_fma_f32 v149, v149, s28, v226
    v_cvt_pk_bf16_f32 v194, v132, v133
    v_mfma_f32_16x16x32_bf16 v[164:167], a[152:155], a[8:11], v[164:167]
    ds_read_b64_tr_b16 a[168:169], v234 offset:704
    v_fma_f32 v150, v150, s28, v226
    v_mfma_f32_16x16x32_bf16 v[164:167], a[156:159], a[12:15], v[164:167]
L_pad3:
    s_cbranch_execz L_pad7
    v_exp_f32 v134, v134
    v_mfma_f32_16x16x32_bf16 v[172:175], a[144:147], a[16:19], 0
    v_exp_f32 v135, v135
    v_mfma_f32_16x16x32_bf16 v[172:175], a[148:151], a[20:23], v[172:175]
    ds_read_b64_tr_b16 a[170:171], v234 offset:960
    v_cvt_pk_bf16_f32 v195, v134, v135
    v_mfma_f32_16x16x32_bf16 v[172:175], a[152:155], a[24:27], v[172:175]
    v_exp_f32 v140, v140
    v_mfma_f32_16x16x32_bf16 v[172:175], a[156:159], a[28:31], v[172:175]
    s_waitcnt lgkmcnt(2)
    ds_read_b64_tr_b16 a[172:173], v234 offset:736
    ds_read_b64_tr_b16 a[174:175], v234 offset:992
    v_mfma_f32_16x16x32_bf16 v[16:19], a[160:163], v[208:211], v[16:19]
    v_exp_f32 v141, v141
    v_mfma_f32_16x16x32_bf16 v[20:23], a[164:167], v[208:211], v[20:23]
    v_fma_f32 v151, v151, s28, v226
    v_cvt_pk_bf16_f32 v198, v140, v141
    v_mfma_f32_16x16x32_bf16 v[48:51], a[160:163], v[212:215], v[48:51]
    v_exp_f32 v142, v142
    v_mfma_f32_16x16x32_bf16 v[52:55], a[164:167], v[212:215], v[52:55]
    v_exp_f32 v143, v143
    v_mfma_f32_16x16x32_bf16 v[80:83], a[160:163], v[216:219], v[80:83]
    v_fma_f32 v156, v156, s28, v227
    v_cvt_pk_bf16_f32 v199, v142, v143
    v_mfma_f32_16x16x32_bf16 v[84:87], a[164:167], v[216:219], v[84:87]
    v_exp_f32 v148, v148
    v_mfma_f32_16x16x32_bf16 v[112:115], a[160:163], v[220:223], v[112:115]
    s_waitcnt vmcnt(23) lgkmcnt(0)
    s_barrier
    ds_read_b128 a[128:131], v232 offset:33792
    ds_read_b128 a[80:83], v237 offset:4096
    v_mfma_f32_16x16x32_bf16 v[116:119], a[164:167], v[220:223], v[116:119]
    v_exp_f32 v149, v149
    v_mfma_f32_16x16x32_bf16 v[180:183], a[144:147], a[32:35], 0
    ds_read_b128 a[132:135], v232 offset:33856
    v_fma_f32 v157, v157, s28, v227
    v_mfma_f32_16x16x32_bf16 v[180:183], a[148:151], a[36:39], v[180:183]
    ds_read_b128 a[84:87], v252 offset:4096
    v_cvt_pk_bf16_f32 v202, v148, v149
    v_mfma_f32_16x16x32_bf16 v[180:183], a[152:155], a[40:43], v[180:183]
    ds_read_b128 a[136:139], v232 offset:33920
    ds_read_b128 a[140:143], v232 offset:33984
    v_mfma_f32_16x16x32_bf16 v[180:183], a[156:159], a[44:47], v[180:183]
    v_exp_f32 v150, v150
    v_mfma_f32_16x16x32_bf16 v[188:191], a[144:147], a[48:51], 0
    v_exp_f32 v151, v151
    v_mfma_f32_16x16x32_bf16 v[188:191], a[148:151], a[52:55], v[188:191]
    ds_read_b64_tr_b16 a[160:161], v234 offset:33792
    v_fma_f32 v158, v158, s28, v227
    v_mfma_f32_16x16x32_bf16 v[188:191], a[152:155], a[56:59], v[188:191]
    ds_read_b64_tr_b16 a[162:163], v234 offset:34048
    v_cvt_pk_bf16_f32 v203, v150, v151
    v_mfma_f32_16x16x32_bf16 v[188:191], a[156:159], a[60:63], v[188:191]
    v_exp_f32 v156, v156
    v_mfma_f32_16x16x32_bf16 v[24:27], a[168:171], v[208:211], v[24:27]
    v_exp_f32 v157, v157
    v_mfma_f32_16x16x32_bf16 v[28:31], a[172:175], v[208:211], v[28:31]
    ds_read_b64_tr_b16 a[164:165], v234 offset:33824
    v_fma_f32 v159, v159, s28, v227
    v_mfma_f32_16x16x32_bf16 v[56:59], a[168:171], v[212:215], v[56:59]
    ds_read_b64_tr_b16 a[166:167], v234 offset:34080
    v_cvt_pk_bf16_f32 v206, v156, v157
    v_mfma_f32_16x16x32_bf16 v[60:63], a[172:175], v[212:215], v[60:63]
    v_exp_f32 v158, v158
    v_mfma_f32_16x16x32_bf16 v[88:91], a[168:171], v[216:219], v[88:91]
    v_exp_f32 v159, v159
    v_mfma_f32_16x16x32_bf16 v[92:95], a[172:175], v[216:219], v[92:95]
    v_cvt_pk_bf16_f32 v207, v158, v159
    v_mfma_f32_16x16x32_bf16 v[120:123], a[168:171], v[220:223], v[120:123]
    v_mfma_f32_16x16x32_bf16 v[124:127], a[172:175], v[220:223], v[124:127]
    s_waitcnt lgkmcnt(4)
    v_mfma_f32_16x16x32_bf16 v[128:131], a[128:131], a[0:3], 0
    ds_read_b64_tr_b16 a[168:169], v234 offset:33856
    ds_read_b64_tr_b16 a[170:171], v234 offset:34112
    v_fma_f32 v164, v164, s28, v224
    v_fma_f32 v165, v165, s28, v224
    v_pk_fma_f32 v[160:161], v[160:161], s[64:65], v[224:225] op_sel_hi:[1,1,0]
    v_pk_fma_f32 v[162:163], v[162:163], s[64:65], v[224:225] op_sel_hi:[1,1,0]
    v_pk_fma_f32 v[168:169], v[168:169], s[64:65], v[224:225] op_sel:[0,0,1] op_sel_hi:[1,1,1]
    v_pk_fma_f32 v[170:171], v[170:171], s[64:65], v[224:225] op_sel:[0,0,1] op_sel_hi:[1,1,1]
    v_pk_fma_f32 v[176:177], v[176:177], s[64:65], v[226:227] op_sel_hi:[1,1,0]
    v_pk_fma_f32 v[178:179], v[178:179], s[64:65], v[226:227] op_sel_hi:[1,1,0]
    v_pk_fma_f32 v[184:185], v[184:185], s[64:65], v[226:227] op_sel:[0,0,1] op_sel_hi:[1,1,1]
    v_pk_fma_f32 v[186:187], v[186:187], s[64:65], v[226:227] op_sel:[0,0,1] op_sel_hi:[1,1,1]
    s_nop 0
    v_mfma_f32_16x16x32_bf16 v[128:131], a[132:135], a[4:7], v[128:131]
    v_exp_f32 v160, v160
    v_mfma_f32_16x16x32_bf16 v[128:131], a[136:139], a[8:11], v[128:131]
    v_exp_f32 v161, v161
    v_mfma_f32_16x16x32_bf16 v[128:131], a[140:143], a[12:15], v[128:131]
    v_exp_f32 v162, v162
    v_mfma_f32_16x16x32_bf16 v[136:139], a[128:131], a[16:19], 0
    s_add_u32 m0, s66, 3968
    v_cvt_pk_bf16_f32 v208, v160, v161
    v_fma_f32 v166, v166, s28, v224
    v_mfma_f32_16x16x32_bf16 v[136:139], a[132:135], a[20:23], v[136:139]
    buffer_load_dwordx4 v238, s[16:19], s58 offen offset:128 nt lds
    v_mfma_f32_16x16x32_bf16 v[136:139], a[136:139], a[24:27], v[136:139]
    v_exp_f32 v163, v163
    v_mfma_f32_16x16x32_bf16 v[136:139], a[140:143], a[28:31], v[136:139]
    ds_read_b64_tr_b16 a[172:173], v234 offset:33888
    v_cvt_pk_bf16_f32 v209, v162, v163
    v_smfmac_f32_16x16x64_bf16 a[176:179], a[184:187], v[192:199], v251
    ds_read_b128 a[144:147], v232 offset:34048
    v_fma_f32 v167, v167, s28, v224
    v_smfmac_f32_16x16x64_bf16 a[180:183], a[184:187], v[200:207], v251
    s_waitcnt lgkmcnt(4)
    ds_read_b64_tr_b16 a[174:175], v234 offset:34144
    v_mfma_f32_16x16x32_bf16 v[0:3], a[160:163], v[192:195], v[0:3]
    v_exp_f32 v168, v168
    v_mfma_f32_16x16x32_bf16 v[4:7], a[164:167], v[192:195], v[4:7]
    v_exp_f32 v169, v169
    v_mfma_f32_16x16x32_bf16 v[32:35], a[160:163], v[196:199], v[32:35]
    buffer_store_dwordx4 a[200:203], v238, s[20:23], s52 offen offset:128 sc0 sc1
    v_mfma_f32_16x16x32_bf16 v[36:39], a[164:167], v[196:199], v[36:39]
    ds_read_b128 a[148:151], v232 offset:34112
    v_cvt_pk_bf16_f32 v212, v168, v169
    v_mfma_f32_16x16x32_bf16 v[64:67], a[160:163], v[200:203], v[64:67]
    v_exp_f32 v170, v170
    v_mfma_f32_16x16x32_bf16 v[68:71], a[164:167], v[200:203], v[68:71]
    v_exp_f32 v171, v171
    v_mfma_f32_16x16x32_bf16 v[96:99], a[160:163], v[204:207], v[96:99]
    v_fma_f32 v172, v172, s28, v225
    v_cvt_pk_bf16_f32 v213, v170, v171
    v_mfma_f32_16x16x32_bf16 v[100:103], a[164:167], v[204:207], v[100:103]
    s_add_u32 m0, s66, 2944
    v_exp_f32 v176, v176
    v_mfma_f32_16x16x32_bf16 v[144:147], a[128:131], a[32:35], 0
    buffer_load_dwordx4 v238, s[16:19], s58 offen offset:2176 nt lds
    v_mfma_f32_16x16x32_bf16 v[144:147], a[132:135], a[36:39], v[144:147]
    ds_read_b128 a[152:155], v232 offset:34176
    v_fma_f32 v173, v173, s28, v225
    v_mfma_f32_16x16x32_bf16 v[144:147], a[136:139], a[40:43], v[144:147]
    v_exp_f32 v177, v177
    v_mfma_f32_16x16x32_bf16 v[144:147], a[140:143], a[44:47], v[144:147]
    ds_read_b64_tr_b16 a[160:161], v234 offset:33920
    ds_read_b128 a[156:159], v232 offset:34240
    v_mfma_f32_16x16x32_bf16 v[152:155], a[128:131], a[48:51], 0
    ds_read_b64_tr_b16 a[162:163], v234 offset:34176
    v_cvt_pk_bf16_f32 v216, v176, v177
    v_mfma_f32_16x16x32_bf16 v[152:155], a[132:135], a[52:55], v[152:155]
    s_add_u32 s40, s31, 0
    v_exp_f32 v178, v178
    v_mfma_f32_16x16x32_bf16 v[152:155], a[136:139], a[56:59], v[152:155]
    s_mov_b32 s6, s42
    v_exp_f32 v179, v179
    v_mfma_f32_16x16x32_bf16 v[152:155], a[140:143], a[60:63], v[152:155]
    s_waitcnt lgkmcnt(5)
    v_fma_f32 v174, v174, s28, v225
    v_cvt_pk_bf16_f32 v217, v178, v179
    v_mfma_f32_16x16x32_bf16 v[8:11], a[168:171], v[192:195], v[8:11]
    s_add_u32 m0, s60, 0
    v_exp_f32 v184, v184
    v_mfma_f32_16x16x32_bf16 v[12:15], a[172:175], v[192:195], v[12:15]
    buffer_load_dwordx4 v236, s[4:7], s40 offen offset:0 nt lds
    v_mfma_f32_16x16x32_bf16 v[40:43], a[168:171], v[196:199], v[40:43]
    ds_read_b64_tr_b16 a[164:165], v234 offset:33952
    v_fma_f32 v175, v175, s28, v225
    v_mfma_f32_16x16x32_bf16 v[44:47], a[172:175], v[196:199], v[44:47]
    v_exp_f32 v185, v185
    v_mfma_f32_16x16x32_bf16 v[72:75], a[168:171], v[200:203], v[72:75]
    ds_read_b64_tr_b16 a[166:167], v234 offset:34208
    v_cvt_pk_bf16_f32 v220, v184, v185
    v_mfma_f32_16x16x32_bf16 v[76:79], a[172:175], v[200:203], v[76:79]
    v_exp_f32 v186, v186
    v_mfma_f32_16x16x32_bf16 v[104:107], a[168:171], v[204:207], v[104:107]
    s_add_u32 m0, s60, 800
    v_exp_f32 v187, v187
    v_mfma_f32_16x16x32_bf16 v[108:111], a[172:175], v[204:207], v[108:111]
    s_waitcnt lgkmcnt(3)
    buffer_load_dwordx4 v236, s[4:7], s40 offen offset:256 nt lds
    v_mfma_f32_16x16x32_bf16 v[132:135], a[144:147], a[0:3], 0
    v_fma_f32 v180, v180, s28, v226
    v_cvt_pk_bf16_f32 v221, v186, v187
    v_mfma_f32_16x16x32_bf16 v[132:135], a[148:151], a[4:7], v[132:135]
    v_exp_f32 v164, v164
    v_mfma_f32_16x16x32_bf16 v[132:135], a[152:155], a[8:11], v[132:135]
    v_exp_f32 v165, v165
    v_mfma_f32_16x16x32_bf16 v[132:135], a[156:159], a[12:15], v[132:135]
    ds_read_b64_tr_b16 a[168:169], v234 offset:33984
    v_fma_f32 v181, v181, s28, v226
    v_mfma_f32_16x16x32_bf16 v[140:143], a[144:147], a[16:19], 0
    ds_read_b64_tr_b16 a[170:171], v234 offset:34240
    v_cvt_pk_bf16_f32 v210, v164, v165
    v_mfma_f32_16x16x32_bf16 v[140:143], a[148:151], a[20:23], v[140:143]
    v_exp_f32 v166, v166
    v_mfma_f32_16x16x32_bf16 v[140:143], a[152:155], a[24:27], v[140:143]
    v_exp_f32 v167, v167
    v_mfma_f32_16x16x32_bf16 v[140:143], a[156:159], a[28:31], v[140:143]
    s_waitcnt lgkmcnt(2)
    v_fma_f32 v182, v182, s28, v226
    v_cvt_pk_bf16_f32 v211, v166, v167
    v_mfma_f32_16x16x32_bf16 v[16:19], a[160:163], v[192:195], v[16:19]
    buffer_store_dwordx4 a[204:207], v238, s[20:23], s52 offen offset:2176 sc0 sc1
    v_mfma_f32_16x16x32_bf16 v[20:23], a[164:167], v[192:195], v[20:23]
    v_exp_f32 v172, v172
    v_mfma_f32_16x16x32_bf16 v[48:51], a[160:163], v[196:199], v[48:51]
    ds_read_b64_tr_b16 a[172:173], v234 offset:34016
    v_fma_f32 v183, v183, s28, v226
    v_mfma_f32_16x16x32_bf16 v[52:55], a[164:167], v[196:199], v[52:55]
    v_exp_f32 v173, v173
    v_mfma_f32_16x16x32_bf16 v[80:83], a[160:163], v[200:203], v[80:83]
    ds_read_b128 a[128:131], v232 offset:34304
    ds_read_b64_tr_b16 a[174:175], v234 offset:34272
    v_mfma_f32_16x16x32_bf16 v[84:87], a[164:167], v[200:203], v[84:87]
    s_add_u32 m0, s60, 1600
    ds_read_b128 a[132:135], v232 offset:34368
    v_cvt_pk_bf16_f32 v214, v172, v173
    v_mfma_f32_16x16x32_bf16 v[112:115], a[160:163], v[204:207], v[112:115]
    buffer_load_dwordx4 v236, s[4:7], s40 offen offset:512 nt lds
    v_exp_f32 v174, v174
    v_mfma_f32_16x16x32_bf16 v[116:119], a[164:167], v[204:207], v[116:119]
    v_exp_f32 v175, v175
    v_mfma_f32_16x16x32_bf16 v[148:151], a[144:147], a[32:35], 0
    v_fma_f32 v188, v188, s28, v227
    v_cvt_pk_bf16_f32 v215, v174, v175
    v_mfma_f32_16x16x32_bf16 v[148:151], a[148:151], a[36:39], v[148:151]
    v_exp_f32 v180, v180
    v_mfma_f32_16x16x32_bf16 v[148:151], a[152:155], a[40:43], v[148:151]
    ds_read_b128 a[136:139], v232 offset:34432
    v_fma_f32 v189, v189, s28, v227
    v_mfma_f32_16x16x32_bf16 v[148:151], a[156:159], a[44:47], v[148:151]
    v_exp_f32 v181, v181
    v_mfma_f32_16x16x32_bf16 v[156:159], a[144:147], a[48:51], 0
    ds_read_b128 a[140:143], v232 offset:34496
    v_cvt_pk_bf16_f32 v218, v180, v181
    v_mfma_f32_16x16x32_bf16 v[156:159], a[148:151], a[52:55], v[156:159]
    s_add_u32 m0, s60, 2400
    v_exp_f32 v182, v182
    v_mfma_f32_16x16x32_bf16 v[156:159], a[152:155], a[56:59], v[156:159]
    buffer_load_dwordx4 v236, s[4:7], s40 offen offset:768 nt lds
    ds_read_b64_tr_b16 a[160:161], v234 offset:34304
    v_mfma_f32_16x16x32_bf16 v[156:159], a[156:159], a[60:63], v[156:159]
    s_waitcnt lgkmcnt(4)
    v_exp_f32 v183, v183
    v_mfma_f32_16x16x32_bf16 v[24:27], a[168:171], v[192:195], v[24:27]
    ds_read_b64_tr_b16 a[162:163], v234 offset:34560
    v_fma_f32 v190, v190, s28, v227
    v_mfma_f32_16x16x32_bf16 v[28:31], a[172:175], v[192:195], v[28:31]
    v_cvt_pk_bf16_f32 v219, v182, v183
    v_fma_f32 v191, v191, s28, v227
    v_mfma_f32_16x16x32_bf16 v[56:59], a[168:171], v[196:199], v[56:59]
    v_exp_f32 v188, v188
    v_mfma_f32_16x16x32_bf16 v[60:63], a[172:175], v[196:199], v[60:63]
    v_exp_f32 v189, v189
    v_mfma_f32_16x16x32_bf16 v[88:91], a[168:171], v[200:203], v[88:91]
    ds_read_b64_tr_b16 a[164:165], v234 offset:34336
    v_cvt_pk_bf16_f32 v222, v188, v189
    v_mfma_f32_16x16x32_bf16 v[92:95], a[172:175], v[200:203], v[92:95]
    v_exp_f32 v190, v190
    v_mfma_f32_16x16x32_bf16 v[120:123], a[168:171], v[204:207], v[120:123]
    buffer_store_dwordx4 a[216:219], v238, s[20:23], s53 offen offset:128 sc0 sc1
    v_mfma_f32_16x16x32_bf16 v[124:127], a[172:175], v[204:207], v[124:127]
    s_waitcnt lgkmcnt(3)
    ds_read_b64_tr_b16 a[166:167], v234 offset:34592
    ds_read_b64_tr_b16 a[168:169], v234 offset:34368
    v_exp_f32 v191, v191
    v_fma_f32 v132, v132, s28, v224
    v_pk_fma_f32 v[128:129], v[128:129], s[64:65], v[224:225] op_sel_hi:[1,1,0]
    v_pk_fma_f32 v[130:131], v[130:131], s[64:65], v[224:225] op_sel_hi:[1,1,0]
    v_pk_fma_f32 v[136:137], v[136:137], s[64:65], v[224:225] op_sel:[0,0,1] op_sel_hi:[1,1,1]
    v_pk_fma_f32 v[138:139], v[138:139], s[64:65], v[224:225] op_sel:[0,0,1] op_sel_hi:[1,1,1]
    v_pk_fma_f32 v[144:145], v[144:145], s[64:65], v[226:227] op_sel_hi:[1,1,0]
    v_pk_fma_f32 v[146:147], v[146:147], s[64:65], v[226:227] op_sel_hi:[1,1,0]
    v_pk_fma_f32 v[152:153], v[152:153], s[64:65], v[226:227] op_sel:[0,0,1] op_sel_hi:[1,1,1]
    v_pk_fma_f32 v[154:155], v[154:155], s[64:65], v[226:227] op_sel:[0,0,1] op_sel_hi:[1,1,1]
    v_fma_f32 v133, v133, s28, v224
    v_mfma_f32_16x16x32_bf16 v[160:163], a[128:131], a[0:3], 0
    v_exp_f32 v128, v128
    v_mfma_f32_16x16x32_bf16 v[160:163], a[132:135], a[4:7], v[160:163]
    v_exp_f32 v129, v129
    v_cvt_pk_bf16_f32 v223, v190, v191
    v_mfma_f32_16x16x32_bf16 v[160:163], a[136:139], a[8:11], v[160:163]
    s_add_u32 s41, s30, 114688
    v_exp_f32 v130, v130
    v_mfma_f32_16x16x32_bf16 v[160:163], a[140:143], a[12:15], v[160:163]
    s_add_u32 m0, s60, 16896
    v_cvt_pk_bf16_f32 v192, v128, v129
    v_fma_f32 v134, v134, s28, v224
    v_mfma_f32_16x16x32_bf16 v[168:171], a[128:131], a[16:19], 0
    buffer_load_dwordx4 v236, s[8:11], s41 offen offset:0 nt lds
    v_mfma_f32_16x16x32_bf16 v[168:171], a[132:135], a[20:23], v[168:171]
    v_exp_f32 v131, v131
    v_mfma_f32_16x16x32_bf16 v[168:171], a[136:139], a[24:27], v[168:171]
    ds_read_b64_tr_b16 a[170:171], v234 offset:34624
    v_cvt_pk_bf16_f32 v193, v130, v131
    v_mfma_f32_16x16x32_bf16 v[168:171], a[140:143], a[28:31], v[168:171]
    v_exp_f32 v136, v136
    v_smfmac_f32_16x16x64_bf16 a[176:179], a[184:187], v[208:215], v251
    ds_read_b64_tr_b16 a[172:173], v234 offset:34400
    v_fma_f32 v135, v135, s28, v224
    v_smfmac_f32_16x16x64_bf16 a[180:183], a[184:187], v[216:223], v251
    s_waitcnt lgkmcnt(3)
    ds_read_b128 a[144:147], v232 offset:34560
    ds_read_b64_tr_b16 a[174:175], v234 offset:34656
    v_mfma_f32_16x16x32_bf16 v[0:3], a[160:163], v[208:211], v[0:3]
    v_exp_f32 v137, v137
    v_mfma_f32_16x16x32_bf16 v[4:7], a[164:167], v[208:211], v[4:7]
    s_add_u32 m0, s60, 17696
    v_cvt_pk_bf16_f32 v196, v136, v137
    v_fma_f32 v140, v140, s28, v225
    v_mfma_f32_16x16x32_bf16 v[32:35], a[160:163], v[212:215], v[32:35]
    buffer_load_dwordx4 v236, s[8:11], s41 offen offset:256 nt lds
    v_mfma_f32_16x16x32_bf16 v[36:39], a[164:167], v[212:215], v[36:39]
    v_exp_f32 v138, v138
    v_mfma_f32_16x16x32_bf16 v[64:67], a[160:163], v[216:219], v[64:67]
    v_exp_f32 v139, v139
    v_mfma_f32_16x16x32_bf16 v[68:71], a[164:167], v[216:219], v[68:71]
    ds_read_b128 a[148:151], v232 offset:34624
    v_cvt_pk_bf16_f32 v197, v138, v139
    v_mfma_f32_16x16x32_bf16 v[96:99], a[160:163], v[220:223], v[96:99]
    v_exp_f32 v144, v144
    v_mfma_f32_16x16x32_bf16 v[100:103], a[164:167], v[220:223], v[100:103]
    ds_read_b128 a[152:155], v232 offset:34688
    v_fma_f32 v141, v141, s28, v225
    v_mfma_f32_16x16x32_bf16 v[176:179], a[128:131], a[32:35], 0
    s_add_u32 m0, s60, 18496
    v_exp_f32 v145, v145
    v_mfma_f32_16x16x32_bf16 v[176:179], a[132:135], a[36:39], v[176:179]
    buffer_load_dwordx4 v236, s[8:11], s41 offen offset:512 nt lds
    v_mfma_f32_16x16x32_bf16 v[176:179], a[136:139], a[40:43], v[176:179]
    ds_read_b64_tr_b16 a[160:161], v234 offset:34432
    v_cvt_pk_bf16_f32 v200, v144, v145
    v_mfma_f32_16x16x32_bf16 v[176:179], a[140:143], a[44:47], v[176:179]
    v_exp_f32 v146, v146
    v_mfma_f32_16x16x32_bf16 v[184:187], a[128:131], a[48:51], 0
    ds_read_b128 a[156:159], v232 offset:34752
    v_fma_f32 v142, v142, s28, v225
    v_mfma_f32_16x16x32_bf16 v[184:187], a[132:135], a[52:55], v[184:187]
    v_exp_f32 v147, v147
    v_mfma_f32_16x16x32_bf16 v[184:187], a[136:139], a[56:59], v[184:187]
    ds_read_b64_tr_b16 a[162:163], v234 offset:34688
    v_cvt_pk_bf16_f32 v201, v146, v147
    v_mfma_f32_16x16x32_bf16 v[184:187], a[140:143], a[60:63], v[184:187]
    s_waitcnt lgkmcnt(5)
    v_exp_f32 v152, v152
    v_mfma_f32_16x16x32_bf16 v[8:11], a[168:171], v[208:211], v[8:11]
    ds_read_b64_tr_b16 a[164:165], v234 offset:34464
    v_fma_f32 v143, v143, s28, v225
    v_mfma_f32_16x16x32_bf16 v[12:15], a[172:175], v[208:211], v[12:15]
    v_exp_f32 v153, v153
    v_mfma_f32_16x16x32_bf16 v[40:43], a[168:171], v[212:215], v[40:43]
    buffer_store_dwordx4 a[220:223], v238, s[20:23], s53 offen offset:2176 sc0 sc1
    v_mfma_f32_16x16x32_bf16 v[44:47], a[172:175], v[212:215], v[44:47]
    ds_read_b64_tr_b16 a[166:167], v234 offset:34720
    v_cvt_pk_bf16_f32 v204, v152, v153
    v_mfma_f32_16x16x32_bf16 v[72:75], a[168:171], v[216:219], v[72:75]
    v_exp_f32 v154, v154
    v_mfma_f32_16x16x32_bf16 v[76:79], a[172:175], v[216:219], v[76:79]
    v_exp_f32 v155, v155
    v_mfma_f32_16x16x32_bf16 v[104:107], a[168:171], v[220:223], v[104:107]
    v_fma_f32 v148, v148, s28, v226
    v_cvt_pk_bf16_f32 v205, v154, v155
    v_mfma_f32_16x16x32_bf16 v[108:111], a[172:175], v[220:223], v[108:111]
    s_waitcnt lgkmcnt(3)
    v_exp_f32 v132, v132
    v_mfma_f32_16x16x32_bf16 v[164:167], a[144:147], a[0:3], 0
    s_add_u32 m0, s60, 19296
    v_exp_f32 v133, v133
    v_mfma_f32_16x16x32_bf16 v[164:167], a[148:151], a[4:7], v[164:167]
    buffer_load_dwordx4 v236, s[8:11], s41 offen offset:768 nt lds
    v_mfma_f32_16x16x32_bf16 v[164:167], a[152:155], a[8:11], v[164:167]
    v_fma_f32 v149, v149, s28, v226
    v_cvt_pk_bf16_f32 v194, v132, v133
    v_mfma_f32_16x16x32_bf16 v[164:167], a[156:159], a[12:15], v[164:167]
    ds_read_b64_tr_b16 a[168:169], v234 offset:34496
    v_fma_f32 v150, v150, s28, v226
    v_mfma_f32_16x16x32_bf16 v[172:175], a[144:147], a[16:19], 0
    v_exp_f32 v134, v134
    v_mfma_f32_16x16x32_bf16 v[172:175], a[148:151], a[20:23], v[172:175]
    v_exp_f32 v135, v135
    v_mfma_f32_16x16x32_bf16 v[172:175], a[152:155], a[24:27], v[172:175]
    ds_read_b64_tr_b16 a[170:171], v234 offset:34752
    v_cvt_pk_bf16_f32 v195, v134, v135
    v_mfma_f32_16x16x32_bf16 v[172:175], a[156:159], a[28:31], v[172:175]
    s_waitcnt lgkmcnt(2)
    v_exp_f32 v140, v140
    v_mfma_f32_16x16x32_bf16 v[16:19], a[160:163], v[208:211], v[16:19]
    ds_read_b64_tr_b16 a[172:173], v234 offset:34528
    ds_read_b64_tr_b16 a[174:175], v234 offset:34784
    v_mfma_f32_16x16x32_bf16 v[20:23], a[164:167], v[208:211], v[20:23]
    v_exp_f32 v141, v141
    v_mfma_f32_16x16x32_bf16 v[48:51], a[160:163], v[212:215], v[48:51]
    v_fma_f32 v151, v151, s28, v226
    v_cvt_pk_bf16_f32 v198, v140, v141
    v_mfma_f32_16x16x32_bf16 v[52:55], a[164:167], v[212:215], v[52:55]
    v_exp_f32 v142, v142
    v_mfma_f32_16x16x32_bf16 v[80:83], a[160:163], v[216:219], v[80:83]
    v_exp_f32 v143, v143
    v_mfma_f32_16x16x32_bf16 v[84:87], a[164:167], v[216:219], v[84:87]
    v_fma_f32 v156, v156, s28, v227
    v_cvt_pk_bf16_f32 v199, v142, v143
    v_mfma_f32_16x16x32_bf16 v[112:115], a[160:163], v[220:223], v[112:115]
    s_waitcnt vmcnt(22) lgkmcnt(0)
    s_barrier
    v_exp_f32 v148, v148
    v_mfma_f32_16x16x32_bf16 v[116:119], a[164:167], v[220:223], v[116:119]
    ds_read_b128 a[128:131], v233 offset:0
    ds_read_b128 a[88:91], v237 offset:0
    v_mfma_f32_16x16x32_bf16 v[180:183], a[144:147], a[32:35], 0
    v_exp_f32 v149, v149
    v_mfma_f32_16x16x32_bf16 v[180:183], a[148:151], a[36:39], v[180:183]
    ds_read_b128 a[132:135], v233 offset:64
    v_fma_f32 v157, v157, s28, v227
    v_mfma_f32_16x16x32_bf16 v[180:183], a[152:155], a[40:43], v[180:183]
    ds_read_b128 a[92:95], v252 offset:0
    v_cvt_pk_bf16_f32 v202, v148, v149
    v_mfma_f32_16x16x32_bf16 v[180:183], a[156:159], a[44:47], v[180:183]
    ds_read_b128 a[136:139], v233 offset:128
    ds_read_b128 a[96:99], v237 offset:2048
    v_mfma_f32_16x16x32_bf16 v[188:191], a[144:147], a[48:51], 0
    v_exp_f32 v150, v150
    v_mfma_f32_16x16x32_bf16 v[188:191], a[148:151], a[52:55], v[188:191]
    ds_read_b128 a[140:143], v233 offset:192
    v_fma_f32 v158, v158, s28, v227
    v_mfma_f32_16x16x32_bf16 v[188:191], a[152:155], a[56:59], v[188:191]
    v_exp_f32 v151, v151
    v_mfma_f32_16x16x32_bf16 v[188:191], a[156:159], a[60:63], v[188:191]
    ds_read_b128 a[100:103], v252 offset:2048
    ds_read_b64_tr_b16 a[160:161], v235 offset:0
    v_mfma_f32_16x16x32_bf16 v[24:27], a[168:171], v[208:211], v[24:27]
    ds_read_b64_tr_b16 a[162:163], v235 offset:256
    v_cvt_pk_bf16_f32 v203, v150, v151
    v_exp_f32 v156, v156
    v_mfma_f32_16x16x32_bf16 v[28:31], a[172:175], v[208:211], v[28:31]
    v_exp_f32 v157, v157
    v_mfma_f32_16x16x32_bf16 v[56:59], a[168:171], v[212:215], v[56:59]
    ds_read_b64_tr_b16 a[164:165], v235 offset:32
    v_fma_f32 v159, v159, s28, v227
    v_mfma_f32_16x16x32_bf16 v[60:63], a[172:175], v[212:215], v[60:63]
    ds_read_b64_tr_b16 a[166:167], v235 offset:288
    v_cvt_pk_bf16_f32 v206, v156, v157
    v_mfma_f32_16x16x32_bf16 v[88:91], a[168:171], v[216:219], v[88:91]
    v_exp_f32 v158, v158
    v_mfma_f32_16x16x32_bf16 v[92:95], a[172:175], v[216:219], v[92:95]
    v_exp_f32 v159, v159
    v_mfma_f32_16x16x32_bf16 v[120:123], a[168:171], v[220:223], v[120:123]
    v_cvt_pk_bf16_f32 v207, v158, v159
    v_mfma_f32_16x16x32_bf16 v[124:127], a[172:175], v[220:223], v[124:127]
    s_waitcnt lgkmcnt(5)
    v_mfma_f32_16x16x32_bf16 v[128:131], a[128:131], a[0:3], 0
    ds_read_b64_tr_b16 a[168:169], v235 offset:64
    ds_read_b64_tr_b16 a[170:171], v235 offset:320
    v_fma_f32 v164, v164, s28, v224
    v_fma_f32 v165, v165, s28, v224
    v_pk_fma_f32 v[160:161], v[160:161], s[64:65], v[224:225] op_sel_hi:[1,1,0]
    v_pk_fma_f32 v[162:163], v[162:163], s[64:65], v[224:225] op_sel_hi:[1,1,0]
    v_pk_fma_f32 v[168:169], v[168:169], s[64:65], v[224:225] op_sel:[0,0,1] op_sel_hi:[1,1,1]
    v_pk_fma_f32 v[170:171], v[170:171], s[64:65], v[224:225] op_sel:[0,0,1] op_sel_hi:[1,1,1]
    v_pk_fma_f32 v[176:177], v[176:177], s[64:65], v[226:227] op_sel_hi:[1,1,0]
    v_pk_fma_f32 v[178:179], v[178:179], s[64:65], v[226:227] op_sel_hi:[1,1,0]
    v_pk_fma_f32 v[184:185], v[184:185], s[64:65], v[226:227] op_sel:[0,0,1] op_sel_hi:[1,1,1]
    v_pk_fma_f32 v[186:187], v[186:187], s[64:65], v[226:227] op_sel:[0,0,1] op_sel_hi:[1,1,1]
    s_nop 0
    v_mfma_f32_16x16x32_bf16 v[128:131], a[132:135], a[4:7], v[128:131]
    v_exp_f32 v160, v160
    v_mfma_f32_16x16x32_bf16 v[128:131], a[136:139], a[8:11], v[128:131]
    s_waitcnt lgkmcnt(6)
    v_exp_f32 v161, v161
    v_mfma_f32_16x16x32_bf16 v[128:131], a[140:143], a[12:15], v[128:131]
    v_exp_f32 v162, v162
    v_mfma_f32_16x16x32_bf16 v[136:139], a[128:131], a[16:19], 0
    s_add_u32 m0, s66, 0
    v_cvt_pk_bf16_f32 v208, v160, v161
    v_fma_f32 v166, v166, s28, v224
    v_mfma_f32_16x16x32_bf16 v[136:139], a[132:135], a[20:23], v[136:139]
    buffer_load_dwordx4 v238, s[16:19], s59 offen offset:0 nt lds
    v_mfma_f32_16x16x32_bf16 v[136:139], a[136:139], a[24:27], v[136:139]
    v_exp_f32 v163, v163
    v_mfma_f32_16x16x32_bf16 v[136:139], a[140:143], a[28:31], v[136:139]
    ds_read_b64_tr_b16 a[172:173], v235 offset:96
    v_cvt_pk_bf16_f32 v209, v162, v163
    v_smfmac_f32_16x16x64_bf16 a[176:179], a[184:187], v[192:199], v251
    ds_read_b128 a[144:147], v233 offset:256
    v_fma_f32 v167, v167, s28, v224
    v_smfmac_f32_16x16x64_bf16 a[180:183], a[184:187], v[200:207], v251
    s_waitcnt lgkmcnt(4)
    ds_read_b64_tr_b16 a[174:175], v235 offset:352
    v_mfma_f32_16x16x32_bf16 v[0:3], a[160:163], v[192:195], v[0:3]
    v_exp_f32 v168, v168
    v_mfma_f32_16x16x32_bf16 v[4:7], a[164:167], v[192:195], v[4:7]
    s_add_u32 m0, s66, 4294966272
    v_exp_f32 v169, v169
    v_mfma_f32_16x16x32_bf16 v[32:35], a[160:163], v[196:199], v[32:35]
    buffer_load_dwordx4 v238, s[16:19], s59 offen offset:2048 nt lds
    v_mfma_f32_16x16x32_bf16 v[36:39], a[164:167], v[196:199], v[36:39]
    ds_read_b128 a[148:151], v233 offset:320
    v_cvt_pk_bf16_f32 v212, v168, v169
    v_mfma_f32_16x16x32_bf16 v[64:67], a[160:163], v[200:203], v[64:67]
    v_exp_f32 v170, v170
    v_mfma_f32_16x16x32_bf16 v[68:71], a[164:167], v[200:203], v[68:71]
    v_exp_f32 v171, v171
    v_mfma_f32_16x16x32_bf16 v[96:99], a[160:163], v[204:207], v[96:99]
    v_fma_f32 v172, v172, s28, v225
    v_cvt_pk_bf16_f32 v213, v170, v171
    v_mfma_f32_16x16x32_bf16 v[100:103], a[164:167], v[204:207], v[100:103]
    v_exp_f32 v176, v176
    v_mfma_f32_16x16x32_bf16 v[144:147], a[128:131], a[32:35], 0
    ds_read_b128 a[152:155], v233 offset:384
    v_fma_f32 v173, v173, s28, v225
    v_mfma_f32_16x16x32_bf16 v[144:147], a[132:135], a[36:39], v[144:147]
    s_add_u32 m0, s66, 1920
    v_exp_f32 v177, v177
    v_mfma_f32_16x16x32_bf16 v[144:147], a[136:139], a[40:43], v[144:147]
    buffer_load_dwordx4 v238, s[16:19], s59 offen offset:128 nt lds
    v_mfma_f32_16x16x32_bf16 v[144:147], a[140:143], a[44:47], v[144:147]
    ds_read_b64_tr_b16 a[160:161], v235 offset:128
    ds_read_b128 a[156:159], v233 offset:448
    v_mfma_f32_16x16x32_bf16 v[152:155], a[128:131], a[48:51], 0
    ds_read_b64_tr_b16 a[162:163], v235 offset:384
    v_cvt_pk_bf16_f32 v216, v176, v177
    v_mfma_f32_16x16x32_bf16 v[152:155], a[132:135], a[52:55], v[152:155]
    v_exp_f32 v178, v178
    v_mfma_f32_16x16x32_bf16 v[152:155], a[136:139], a[56:59], v[152:155]
    v_exp_f32 v179, v179
    v_mfma_f32_16x16x32_bf16 v[152:155], a[140:143], a[60:63], v[152:155]
    s_waitcnt lgkmcnt(5)
    v_fma_f32 v174, v174, s28, v225
    v_cvt_pk_bf16_f32 v217, v178, v179
    v_mfma_f32_16x16x32_bf16 v[8:11], a[168:171], v[192:195], v[8:11]
    v_exp_f32 v184, v184
    v_mfma_f32_16x16x32_bf16 v[12:15], a[172:175], v[192:195], v[12:15]
    s_add_u32 m0, s66, 896
    ds_read_b64_tr_b16 a[164:165], v235 offset:160
    v_fma_f32 v175, v175, s28, v225
    v_mfma_f32_16x16x32_bf16 v[40:43], a[168:171], v[196:199], v[40:43]
    buffer_load_dwordx4 v238, s[16:19], s59 offen offset:2176 nt lds
    v_mfma_f32_16x16x32_bf16 v[44:47], a[172:175], v[196:199], v[44:47]
    v_exp_f32 v185, v185
    v_mfma_f32_16x16x32_bf16 v[72:75], a[168:171], v[200:203], v[72:75]
    ds_read_b64_tr_b16 a[166:167], v235 offset:416
    v_cvt_pk_bf16_f32 v220, v184, v185
    v_mfma_f32_16x16x32_bf16 v[76:79], a[172:175], v[200:203], v[76:79]
    v_exp_f32 v186, v186
    v_mfma_f32_16x16x32_bf16 v[104:107], a[168:171], v[204:207], v[104:107]
    v_exp_f32 v187, v187
    v_mfma_f32_16x16x32_bf16 v[108:111], a[172:175], v[204:207], v[108:111]
    s_waitcnt lgkmcnt(3)
    v_fma_f32 v180, v180, s28, v226
    v_cvt_pk_bf16_f32 v221, v186, v187
    v_mfma_f32_16x16x32_bf16 v[132:135], a[144:147], a[0:3], 0
    s_add_u32 s40, s31, 16384
    v_exp_f32 v164, v164
    v_mfma_f32_16x16x32_bf16 v[132:135], a[148:151], a[4:7], v[132:135]
    s_add_u32 m0, s60, 33792
    v_exp_f32 v165, v165
    v_mfma_f32_16x16x32_bf16 v[132:135], a[152:155], a[8:11], v[132:135]
    buffer_load_dwordx4 v236, s[4:7], s40 offen offset:0 nt lds
    v_mfma_f32_16x16x32_bf16 v[132:135], a[156:159], a[12:15], v[132:135]
    ds_read_b64_tr_b16 a[168:169], v235 offset:192
    v_fma_f32 v181, v181, s28, v226
    v_mfma_f32_16x16x32_bf16 v[140:143], a[144:147], a[16:19], 0
    ds_read_b64_tr_b16 a[170:171], v235 offset:448
    v_cvt_pk_bf16_f32 v210, v164, v165
    v_mfma_f32_16x16x32_bf16 v[140:143], a[148:151], a[20:23], v[140:143]
    v_exp_f32 v166, v166
    v_mfma_f32_16x16x32_bf16 v[140:143], a[152:155], a[24:27], v[140:143]
    v_exp_f32 v167, v167
    v_mfma_f32_16x16x32_bf16 v[140:143], a[156:159], a[28:31], v[140:143]
    s_waitcnt lgkmcnt(2)
    v_fma_f32 v182, v182, s28, v226
    v_cvt_pk_bf16_f32 v211, v166, v167
    v_mfma_f32_16x16x32_bf16 v[16:19], a[160:163], v[192:195], v[16:19]
    v_exp_f32 v172, v172
    v_mfma_f32_16x16x32_bf16 v[20:23], a[164:167], v[192:195], v[20:23]
    s_add_u32 m0, s60, 34592
    ds_read_b64_tr_b16 a[172:173], v235 offset:224
    v_fma_f32 v183, v183, s28, v226
    v_mfma_f32_16x16x32_bf16 v[48:51], a[160:163], v[196:199], v[48:51]
    buffer_load_dwordx4 v236, s[4:7], s40 offen offset:256 nt lds
    v_mfma_f32_16x16x32_bf16 v[52:55], a[164:167], v[196:199], v[52:55]
    v_exp_f32 v173, v173
    v_mfma_f32_16x16x32_bf16 v[80:83], a[160:163], v[200:203], v[80:83]
    ds_read_b128 a[128:131], v233 offset:512
    ds_read_b64_tr_b16 a[174:175], v235 offset:480
    v_mfma_f32_16x16x32_bf16 v[84:87], a[164:167], v[200:203], v[84:87]
L_pad4:
    s_cbranch_execz L_pad8
    ds_read_b128 a[132:135], v233 offset:576
    v_cvt_pk_bf16_f32 v214, v172, v173
    v_mfma_f32_16x16x32_bf16 v[112:115], a[160:163], v[204:207], v[112:115]
    v_exp_f32 v174, v174
    v_mfma_f32_16x16x32_bf16 v[116:119], a[164:167], v[204:207], v[116:119]
    v_exp_f32 v175, v175
    v_mfma_f32_16x16x32_bf16 v[148:151], a[144:147], a[32:35], 0
    v_fma_f32 v188, v188, s28, v227
    v_cvt_pk_bf16_f32 v215, v174, v175
    v_mfma_f32_16x16x32_bf16 v[148:151], a[148:151], a[36:39], v[148:151]
    s_add_u32 m0, s60, 35392
    v_exp_f32 v180, v180
    v_mfma_f32_16x16x32_bf16 v[148:151], a[152:155], a[40:43], v[148:151]
    buffer_load_dwordx4 v236, s[4:7], s40 offen offset:512 nt lds
    ds_read_b128 a[136:139], v233 offset:640
    v_mfma_f32_16x16x32_bf16 v[148:151], a[156:159], a[44:47], v[148:151]
    v_exp_f32 v181, v181
    v_mfma_f32_16x16x32_bf16 v[156:159], a[144:147], a[48:51], 0
    ds_read_b128 a[140:143], v233 offset:704
    v_fma_f32 v189, v189, s28, v227
    v_mfma_f32_16x16x32_bf16 v[156:159], a[148:151], a[52:55], v[156:159]
    ds_read_b64_tr_b16 a[160:161], v235 offset:512
    v_cvt_pk_bf16_f32 v218, v180, v181
    v_mfma_f32_16x16x32_bf16 v[156:159], a[152:155], a[56:59], v[156:159]
    v_exp_f32 v182, v182
    v_mfma_f32_16x16x32_bf16 v[156:159], a[156:159], a[60:63], v[156:159]
    s_waitcnt lgkmcnt(4)
    v_exp_f32 v183, v183
    v_mfma_f32_16x16x32_bf16 v[24:27], a[168:171], v[192:195], v[24:27]
    ds_read_b64_tr_b16 a[162:163], v235 offset:768
    v_fma_f32 v190, v190, s28, v227
    v_mfma_f32_16x16x32_bf16 v[28:31], a[172:175], v[192:195], v[28:31]
    s_add_u32 m0, s60, 36192
    v_cvt_pk_bf16_f32 v219, v182, v183
    v_fma_f32 v191, v191, s28, v227
    v_mfma_f32_16x16x32_bf16 v[56:59], a[168:171], v[196:199], v[56:59]
    buffer_load_dwordx4 v236, s[4:7], s40 offen offset:768 nt lds
    v_exp_f32 v188, v188
    v_mfma_f32_16x16x32_bf16 v[60:63], a[172:175], v[196:199], v[60:63]
    v_exp_f32 v189, v189
    v_mfma_f32_16x16x32_bf16 v[88:91], a[168:171], v[200:203], v[88:91]
    ds_read_b64_tr_b16 a[164:165], v235 offset:544
    v_cvt_pk_bf16_f32 v222, v188, v189
    v_mfma_f32_16x16x32_bf16 v[92:95], a[172:175], v[200:203], v[92:95]
    v_exp_f32 v190, v190
    v_mfma_f32_16x16x32_bf16 v[120:123], a[168:171], v[204:207], v[120:123]
    v_exp_f32 v191, v191
    v_mfma_f32_16x16x32_bf16 v[124:127], a[172:175], v[204:207], v[124:127]
    s_waitcnt lgkmcnt(3)
    ds_read_b64_tr_b16 a[166:167], v235 offset:800
    ds_read_b64_tr_b16 a[168:169], v235 offset:576
    v_fma_f32 v132, v132, s28, v224
    v_cvt_pk_bf16_f32 v223, v190, v191
    v_pk_fma_f32 v[128:129], v[128:129], s[64:65], v[224:225] op_sel_hi:[1,1,0]
    v_pk_fma_f32 v[130:131], v[130:131], s[64:65], v[224:225] op_sel_hi:[1,1,0]
    v_pk_fma_f32 v[136:137], v[136:137], s[64:65], v[224:225] op_sel:[0,0,1] op_sel_hi:[1,1,1]
    v_pk_fma_f32 v[138:139], v[138:139], s[64:65], v[224:225] op_sel:[0,0,1] op_sel_hi:[1,1,1]
    v_pk_fma_f32 v[144:145], v[144:145], s[64:65], v[226:227] op_sel_hi:[1,1,0]
    v_pk_fma_f32 v[146:147], v[146:147], s[64:65], v[226:227] op_sel_hi:[1,1,0]
    v_pk_fma_f32 v[152:153], v[152:153], s[64:65], v[226:227] op_sel:[0,0,1] op_sel_hi:[1,1,1]
    v_pk_fma_f32 v[154:155], v[154:155], s[64:65], v[226:227] op_sel:[0,0,1] op_sel_hi:[1,1,1]
    v_fma_f32 v133, v133, s28, v224
    v_mfma_f32_16x16x32_bf16 v[160:163], a[128:131], a[0:3], 0
    s_add_u32 s41, s31, 0
    v_exp_f32 v128, v128
    v_mfma_f32_16x16x32_bf16 v[160:163], a[132:135], a[4:7], v[160:163]
    s_mov_b32 s10, s42
    v_exp_f32 v129, v129
    v_mfma_f32_16x16x32_bf16 v[160:163], a[136:139], a[8:11], v[160:163]
    s_add_u32 m0, s60, 50688
    v_exp_f32 v130, v130
    v_mfma_f32_16x16x32_bf16 v[160:163], a[140:143], a[12:15], v[160:163]
    buffer_load_dwordx4 v236, s[8:11], s41 offen offset:0 nt lds
    v_mfma_f32_16x16x32_bf16 v[168:171], a[128:131], a[16:19], 0
    v_cvt_pk_bf16_f32 v192, v128, v129
    v_fma_f32 v134, v134, s28, v224
    v_mfma_f32_16x16x32_bf16 v[168:171], a[132:135], a[20:23], v[168:171]
    v_exp_f32 v131, v131
    v_mfma_f32_16x16x32_bf16 v[168:171], a[136:139], a[24:27], v[168:171]
    ds_read_b64_tr_b16 a[170:171], v235 offset:832
    v_cvt_pk_bf16_f32 v193, v130, v131
    v_mfma_f32_16x16x32_bf16 v[168:171], a[140:143], a[28:31], v[168:171]
    v_exp_f32 v136, v136
    v_smfmac_f32_16x16x64_bf16 a[176:179], a[184:187], v[208:215], v251
    ds_read_b64_tr_b16 a[172:173], v235 offset:608
    v_fma_f32 v135, v135, s28, v224
    v_smfmac_f32_16x16x64_bf16 a[180:183], a[184:187], v[216:223], v251
    s_waitcnt lgkmcnt(3)
    ds_read_b128 a[144:147], v233 offset:768
    ds_read_b64_tr_b16 a[174:175], v235 offset:864
    v_mfma_f32_16x16x32_bf16 v[0:3], a[160:163], v[208:211], v[0:3]
    s_add_u32 m0, s60, 51488
    v_exp_f32 v137, v137
    v_mfma_f32_16x16x32_bf16 v[4:7], a[164:167], v[208:211], v[4:7]
    buffer_load_dwordx4 v236, s[8:11], s41 offen offset:256 nt lds
    v_mfma_f32_16x16x32_bf16 v[32:35], a[160:163], v[212:215], v[32:35]
    v_cvt_pk_bf16_f32 v196, v136, v137
    v_fma_f32 v140, v140, s28, v225
    v_mfma_f32_16x16x32_bf16 v[36:39], a[164:167], v[212:215], v[36:39]
    v_exp_f32 v138, v138
    v_mfma_f32_16x16x32_bf16 v[64:67], a[160:163], v[216:219], v[64:67]
    v_exp_f32 v139, v139
    v_mfma_f32_16x16x32_bf16 v[68:71], a[164:167], v[216:219], v[68:71]
    ds_read_b128 a[148:151], v233 offset:832
    v_cvt_pk_bf16_f32 v197, v138, v139
    v_mfma_f32_16x16x32_bf16 v[96:99], a[160:163], v[220:223], v[96:99]
    v_exp_f32 v144, v144
    v_mfma_f32_16x16x32_bf16 v[100:103], a[164:167], v[220:223], v[100:103]
    s_add_u32 m0, s60, 52288
    ds_read_b128 a[152:155], v233 offset:896
    v_fma_f32 v141, v141, s28, v225
    v_mfma_f32_16x16x32_bf16 v[176:179], a[128:131], a[32:35], 0
    buffer_load_dwordx4 v236, s[8:11], s41 offen offset:512 nt lds
    v_mfma_f32_16x16x32_bf16 v[176:179], a[132:135], a[36:39], v[176:179]
    v_exp_f32 v145, v145
    v_mfma_f32_16x16x32_bf16 v[176:179], a[136:139], a[40:43], v[176:179]
    ds_read_b64_tr_b16 a[160:161], v235 offset:640
    v_cvt_pk_bf16_f32 v200, v144, v145
    v_mfma_f32_16x16x32_bf16 v[176:179], a[140:143], a[44:47], v[176:179]
    v_exp_f32 v146, v146
    v_mfma_f32_16x16x32_bf16 v[184:187], a[128:131], a[48:51], 0
    ds_read_b128 a[156:159], v233 offset:960
    v_fma_f32 v142, v142, s28, v225
    v_mfma_f32_16x16x32_bf16 v[184:187], a[132:135], a[52:55], v[184:187]
    v_exp_f32 v147, v147
    v_mfma_f32_16x16x32_bf16 v[184:187], a[136:139], a[56:59], v[184:187]
    ds_read_b64_tr_b16 a[162:163], v235 offset:896
    v_cvt_pk_bf16_f32 v201, v146, v147
    v_mfma_f32_16x16x32_bf16 v[184:187], a[140:143], a[60:63], v[184:187]
    s_waitcnt lgkmcnt(5)
    v_exp_f32 v152, v152
    v_mfma_f32_16x16x32_bf16 v[8:11], a[168:171], v[208:211], v[8:11]
    s_add_u32 m0, s60, 53088
    ds_read_b64_tr_b16 a[164:165], v235 offset:672
    v_fma_f32 v143, v143, s28, v225
    v_mfma_f32_16x16x32_bf16 v[12:15], a[172:175], v[208:211], v[12:15]
    buffer_load_dwordx4 v236, s[8:11], s41 offen offset:768 nt lds
    v_mfma_f32_16x16x32_bf16 v[40:43], a[168:171], v[212:215], v[40:43]
    v_exp_f32 v153, v153
    v_mfma_f32_16x16x32_bf16 v[44:47], a[172:175], v[212:215], v[44:47]
    ds_read_b64_tr_b16 a[166:167], v235 offset:928
    v_cvt_pk_bf16_f32 v204, v152, v153
    v_mfma_f32_16x16x32_bf16 v[72:75], a[168:171], v[216:219], v[72:75]
    v_exp_f32 v154, v154
    v_mfma_f32_16x16x32_bf16 v[76:79], a[172:175], v[216:219], v[76:79]
    v_exp_f32 v155, v155
    v_mfma_f32_16x16x32_bf16 v[104:107], a[168:171], v[220:223], v[104:107]
    v_fma_f32 v148, v148, s28, v226
    v_cvt_pk_bf16_f32 v205, v154, v155
    v_mfma_f32_16x16x32_bf16 v[108:111], a[172:175], v[220:223], v[108:111]
    s_waitcnt lgkmcnt(3)
    v_exp_f32 v132, v132
    v_mfma_f32_16x16x32_bf16 v[164:167], a[144:147], a[0:3], 0
    v_exp_f32 v133, v133
    v_mfma_f32_16x16x32_bf16 v[164:167], a[148:151], a[4:7], v[164:167]
    v_fma_f32 v149, v149, s28, v226
    v_cvt_pk_bf16_f32 v194, v132, v133
    v_mfma_f32_16x16x32_bf16 v[164:167], a[152:155], a[8:11], v[164:167]
    ds_read_b64_tr_b16 a[168:169], v235 offset:704
    v_fma_f32 v150, v150, s28, v226
    v_mfma_f32_16x16x32_bf16 v[164:167], a[156:159], a[12:15], v[164:167]
    v_exp_f32 v134, v134
    v_mfma_f32_16x16x32_bf16 v[172:175], a[144:147], a[16:19], 0
    v_exp_f32 v135, v135
    v_mfma_f32_16x16x32_bf16 v[172:175], a[148:151], a[20:23], v[172:175]
    ds_read_b64_tr_b16 a[170:171], v235 offset:960
    v_cvt_pk_bf16_f32 v195, v134, v135
    v_mfma_f32_16x16x32_bf16 v[172:175], a[152:155], a[24:27], v[172:175]
    v_exp_f32 v140, v140
    v_mfma_f32_16x16x32_bf16 v[172:175], a[156:159], a[28:31], v[172:175]
    s_waitcnt lgkmcnt(2)
    ds_read_b64_tr_b16 a[172:173], v235 offset:736
    ds_read_b64_tr_b16 a[174:175], v235 offset:992
    v_mfma_f32_16x16x32_bf16 v[16:19], a[160:163], v[208:211], v[16:19]
    v_exp_f32 v141, v141
    v_mfma_f32_16x16x32_bf16 v[20:23], a[164:167], v[208:211], v[20:23]
    v_fma_f32 v151, v151, s28, v226
    v_cvt_pk_bf16_f32 v198, v140, v141
    v_mfma_f32_16x16x32_bf16 v[48:51], a[160:163], v[212:215], v[48:51]
    v_exp_f32 v142, v142
    v_mfma_f32_16x16x32_bf16 v[52:55], a[164:167], v[212:215], v[52:55]
    v_exp_f32 v143, v143
    v_mfma_f32_16x16x32_bf16 v[80:83], a[160:163], v[216:219], v[80:83]
    v_fma_f32 v156, v156, s28, v227
    v_cvt_pk_bf16_f32 v199, v142, v143
    v_mfma_f32_16x16x32_bf16 v[84:87], a[164:167], v[216:219], v[84:87]
    v_exp_f32 v148, v148
    v_mfma_f32_16x16x32_bf16 v[112:115], a[160:163], v[220:223], v[112:115]
    s_waitcnt vmcnt(23) lgkmcnt(0)
    s_barrier
    ds_read_b128 a[128:131], v233 offset:33792
    ds_read_b128 a[132:135], v233 offset:33856
    v_mfma_f32_16x16x32_bf16 v[116:119], a[164:167], v[220:223], v[116:119]
    v_exp_f32 v149, v149
    v_mfma_f32_16x16x32_bf16 v[180:183], a[144:147], a[32:35], 0
    v_fma_f32 v157, v157, s28, v227
    v_cvt_pk_bf16_f32 v202, v148, v149
    v_mfma_f32_16x16x32_bf16 v[180:183], a[148:151], a[36:39], v[180:183]
    ds_read_b128 a[136:139], v233 offset:33920
    ds_read_b128 a[140:143], v233 offset:33984
    v_mfma_f32_16x16x32_bf16 v[180:183], a[152:155], a[40:43], v[180:183]
    v_exp_f32 v150, v150
    v_mfma_f32_16x16x32_bf16 v[180:183], a[156:159], a[44:47], v[180:183]
    v_exp_f32 v151, v151
    v_mfma_f32_16x16x32_bf16 v[188:191], a[144:147], a[48:51], 0
    ds_read_b64_tr_b16 a[160:161], v235 offset:33792
    v_fma_f32 v158, v158, s28, v227
    v_mfma_f32_16x16x32_bf16 v[188:191], a[148:151], a[52:55], v[188:191]
    ds_read_b64_tr_b16 a[162:163], v235 offset:34048
    v_cvt_pk_bf16_f32 v203, v150, v151
    v_mfma_f32_16x16x32_bf16 v[188:191], a[152:155], a[56:59], v[188:191]
    v_exp_f32 v156, v156
    v_mfma_f32_16x16x32_bf16 v[188:191], a[156:159], a[60:63], v[188:191]
    v_exp_f32 v157, v157
    v_mfma_f32_16x16x32_bf16 v[24:27], a[168:171], v[208:211], v[24:27]
    ds_read_b64_tr_b16 a[164:165], v235 offset:33824
    v_fma_f32 v159, v159, s28, v227
    v_mfma_f32_16x16x32_bf16 v[28:31], a[172:175], v[208:211], v[28:31]
    ds_read_b64_tr_b16 a[166:167], v235 offset:34080
    v_cvt_pk_bf16_f32 v206, v156, v157
    v_mfma_f32_16x16x32_bf16 v[56:59], a[168:171], v[212:215], v[56:59]
    v_exp_f32 v158, v158
    v_mfma_f32_16x16x32_bf16 v[60:63], a[172:175], v[212:215], v[60:63]
    v_exp_f32 v159, v159
    v_mfma_f32_16x16x32_bf16 v[88:91], a[168:171], v[216:219], v[88:91]
    v_cvt_pk_bf16_f32 v207, v158, v159
    v_mfma_f32_16x16x32_bf16 v[92:95], a[172:175], v[216:219], v[92:95]
    v_mfma_f32_16x16x32_bf16 v[120:123], a[168:171], v[220:223], v[120:123]
    v_mfma_f32_16x16x32_bf16 v[124:127], a[172:175], v[220:223], v[124:127]
    s_waitcnt lgkmcnt(4)
    s_cmp_eq_u32 s46, 2
    s_cbranch_scc1 L_E
    v_mfma_f32_16x16x32_bf16 v[128:131], a[128:131], a[0:3], 0
    ds_read_b64_tr_b16 a[168:169], v235 offset:33856
    ds_read_b64_tr_b16 a[170:171], v235 offset:34112
    v_fma_f32 v164, v164, s28, v224
    v_fma_f32 v165, v165, s28, v224
    v_pk_fma_f32 v[160:161], v[160:161], s[64:65], v[224:225] op_sel_hi:[1,1,0]
    v_pk_fma_f32 v[162:163], v[162:163], s[64:65], v[224:225] op_sel_hi:[1,1,0]
    v_pk_fma_f32 v[168:169], v[168:169], s[64:65], v[224:225] op_sel:[0,0,1] op_sel_hi:[1,1,1]
    v_pk_fma_f32 v[170:171], v[170:171], s[64:65], v[224:225] op_sel:[0,0,1] op_sel_hi:[1,1,1]
    v_pk_fma_f32 v[176:177], v[176:177], s[64:65], v[226:227] op_sel_hi:[1,1,0]
    v_pk_fma_f32 v[178:179], v[178:179], s[64:65], v[226:227] op_sel_hi:[1,1,0]
    v_pk_fma_f32 v[184:185], v[184:185], s[64:65], v[226:227] op_sel:[0,0,1] op_sel_hi:[1,1,1]
    v_pk_fma_f32 v[186:187], v[186:187], s[64:65], v[226:227] op_sel:[0,0,1] op_sel_hi:[1,1,1]
    s_nop 0
    v_mfma_f32_16x16x32_bf16 v[128:131], a[132:135], a[4:7], v[128:131]
    v_exp_f32 v160, v160
    v_mfma_f32_16x16x32_bf16 v[128:131], a[136:139], a[8:11], v[128:131]
    v_exp_f32 v161, v161
    v_mfma_f32_16x16x32_bf16 v[128:131], a[140:143], a[12:15], v[128:131]
    v_exp_f32 v162, v162
    v_mfma_f32_16x16x32_bf16 v[136:139], a[128:131], a[16:19], 0
    s_add_u32 s40, s31, 32768
    v_cvt_pk_bf16_f32 v208, v160, v161
    v_fma_f32 v166, v166, s28, v224
    v_mfma_f32_16x16x32_bf16 v[136:139], a[132:135], a[20:23], v[136:139]
    s_add_u32 m0, s60, 67584
    v_exp_f32 v163, v163
    v_mfma_f32_16x16x32_bf16 v[136:139], a[136:139], a[24:27], v[136:139]
    buffer_load_dwordx4 v236, s[4:7], s40 offen offset:0 nt lds
    v_mfma_f32_16x16x32_bf16 v[136:139], a[140:143], a[28:31], v[136:139]
    ds_read_b64_tr_b16 a[172:173], v235 offset:33888
    v_cvt_pk_bf16_f32 v209, v162, v163
    v_smfmac_f32_16x16x64_bf16 a[176:179], a[184:187], v[192:199], v251
    ds_read_b128 a[144:147], v233 offset:34048
    v_fma_f32 v167, v167, s28, v224
    v_smfmac_f32_16x16x64_bf16 a[180:183], a[184:187], v[200:207], v251
    s_waitcnt lgkmcnt(4)
    ds_read_b64_tr_b16 a[174:175], v235 offset:34144
    v_mfma_f32_16x16x32_bf16 v[0:3], a[160:163], v[192:195], v[0:3]
    v_exp_f32 v168, v168
    v_mfma_f32_16x16x32_bf16 v[4:7], a[164:167], v[192:195], v[4:7]
    v_exp_f32 v169, v169
    v_mfma_f32_16x16x32_bf16 v[32:35], a[160:163], v[196:199], v[32:35]
    buffer_store_dwordx4 a[232:235], v238, s[24:27], s54 offen offset:128 sc0 sc1
    v_mfma_f32_16x16x32_bf16 v[36:39], a[164:167], v[196:199], v[36:39]
    ds_read_b128 a[148:151], v233 offset:34112
    v_cvt_pk_bf16_f32 v212, v168, v169
    v_mfma_f32_16x16x32_bf16 v[64:67], a[160:163], v[200:203], v[64:67]
    v_exp_f32 v170, v170
    v_mfma_f32_16x16x32_bf16 v[68:71], a[164:167], v[200:203], v[68:71]
    v_exp_f32 v171, v171
    v_mfma_f32_16x16x32_bf16 v[96:99], a[160:163], v[204:207], v[96:99]
    v_fma_f32 v172, v172, s28, v225
    v_cvt_pk_bf16_f32 v213, v170, v171
    v_mfma_f32_16x16x32_bf16 v[100:103], a[164:167], v[204:207], v[100:103]
    s_add_u32 m0, s60, 68384
    v_exp_f32 v176, v176
    v_mfma_f32_16x16x32_bf16 v[144:147], a[128:131], a[32:35], 0
    buffer_load_dwordx4 v236, s[4:7], s40 offen offset:256 nt lds
    v_mfma_f32_16x16x32_bf16 v[144:147], a[132:135], a[36:39], v[144:147]
    ds_read_b128 a[152:155], v233 offset:34176
    v_fma_f32 v173, v173, s28, v225
    v_mfma_f32_16x16x32_bf16 v[144:147], a[136:139], a[40:43], v[144:147]
    v_exp_f32 v177, v177
    v_mfma_f32_16x16x32_bf16 v[144:147], a[140:143], a[44:47], v[144:147]
    ds_read_b64_tr_b16 a[160:161], v235 offset:33920
    ds_read_b128 a[156:159], v233 offset:34240
    v_mfma_f32_16x16x32_bf16 v[152:155], a[128:131], a[48:51], 0
    ds_read_b64_tr_b16 a[162:163], v235 offset:34176
    v_cvt_pk_bf16_f32 v216, v176, v177
    v_mfma_f32_16x16x32_bf16 v[152:155], a[132:135], a[52:55], v[152:155]
    v_exp_f32 v178, v178
    v_mfma_f32_16x16x32_bf16 v[152:155], a[136:139], a[56:59], v[152:155]
    v_exp_f32 v179, v179
    v_mfma_f32_16x16x32_bf16 v[152:155], a[140:143], a[60:63], v[152:155]
    s_waitcnt lgkmcnt(5)
    v_fma_f32 v174, v174, s28, v225
    v_cvt_pk_bf16_f32 v217, v178, v179
    v_mfma_f32_16x16x32_bf16 v[8:11], a[168:171], v[192:195], v[8:11]
    s_add_u32 m0, s66, 6144
    v_exp_f32 v184, v184
    v_mfma_f32_16x16x32_bf16 v[12:15], a[172:175], v[192:195], v[12:15]
    buffer_load_dword v234, s[76:79], 0 offen offset:0 lds
    v_mfma_f32_16x16x32_bf16 v[40:43], a[168:171], v[196:199], v[40:43]
    ds_read_b64_tr_b16 a[164:165], v235 offset:33952
    v_fma_f32 v175, v175, s28, v225
    v_mfma_f32_16x16x32_bf16 v[44:47], a[172:175], v[196:199], v[44:47]
    v_exp_f32 v185, v185
    v_mfma_f32_16x16x32_bf16 v[72:75], a[168:171], v[200:203], v[72:75]
    ds_read_b64_tr_b16 a[166:167], v235 offset:34208
    v_cvt_pk_bf16_f32 v220, v184, v185
    v_mfma_f32_16x16x32_bf16 v[76:79], a[172:175], v[200:203], v[76:79]
    v_exp_f32 v186, v186
    v_mfma_f32_16x16x32_bf16 v[104:107], a[168:171], v[204:207], v[104:107]
    s_add_u32 m0, s60, 69184
    v_exp_f32 v187, v187
    v_mfma_f32_16x16x32_bf16 v[108:111], a[172:175], v[204:207], v[108:111]
    s_waitcnt lgkmcnt(3)
    buffer_load_dwordx4 v236, s[4:7], s40 offen offset:512 nt lds
    v_mfma_f32_16x16x32_bf16 v[132:135], a[144:147], a[0:3], 0
    v_fma_f32 v180, v180, s28, v226
    v_cvt_pk_bf16_f32 v221, v186, v187
    v_mfma_f32_16x16x32_bf16 v[132:135], a[148:151], a[4:7], v[132:135]
    v_exp_f32 v164, v164
    v_mfma_f32_16x16x32_bf16 v[132:135], a[152:155], a[8:11], v[132:135]
    v_exp_f32 v165, v165
    v_mfma_f32_16x16x32_bf16 v[132:135], a[156:159], a[12:15], v[132:135]
    ds_read_b64_tr_b16 a[168:169], v235 offset:33984
    v_fma_f32 v181, v181, s28, v226
    v_mfma_f32_16x16x32_bf16 v[140:143], a[144:147], a[16:19], 0
    ds_read_b64_tr_b16 a[170:171], v235 offset:34240
    v_cvt_pk_bf16_f32 v210, v164, v165
    v_mfma_f32_16x16x32_bf16 v[140:143], a[148:151], a[20:23], v[140:143]
    v_exp_f32 v166, v166
    v_mfma_f32_16x16x32_bf16 v[140:143], a[152:155], a[24:27], v[140:143]
    v_exp_f32 v167, v167
    v_mfma_f32_16x16x32_bf16 v[140:143], a[156:159], a[28:31], v[140:143]
    s_waitcnt lgkmcnt(2)
    v_fma_f32 v182, v182, s28, v226
    v_cvt_pk_bf16_f32 v211, v166, v167
    v_mfma_f32_16x16x32_bf16 v[16:19], a[160:163], v[192:195], v[16:19]
    buffer_store_dwordx4 a[236:239], v238, s[24:27], s54 offen offset:2176 sc0 sc1
    v_mfma_f32_16x16x32_bf16 v[20:23], a[164:167], v[192:195], v[20:23]
    v_exp_f32 v172, v172
    v_mfma_f32_16x16x32_bf16 v[48:51], a[160:163], v[196:199], v[48:51]
    ds_read_b64_tr_b16 a[172:173], v235 offset:34016
    v_fma_f32 v183, v183, s28, v226
    v_mfma_f32_16x16x32_bf16 v[52:55], a[164:167], v[196:199], v[52:55]
    v_exp_f32 v173, v173
    v_mfma_f32_16x16x32_bf16 v[80:83], a[160:163], v[200:203], v[80:83]
    ds_read_b128 a[128:131], v233 offset:34304
    ds_read_b64_tr_b16 a[174:175], v235 offset:34272
    v_mfma_f32_16x16x32_bf16 v[84:87], a[164:167], v[200:203], v[84:87]
    s_add_u32 m0, s60, 69984
    ds_read_b128 a[132:135], v233 offset:34368
    v_cvt_pk_bf16_f32 v214, v172, v173
    v_mfma_f32_16x16x32_bf16 v[112:115], a[160:163], v[204:207], v[112:115]
    buffer_load_dwordx4 v236, s[4:7], s40 offen offset:768 nt lds
    v_exp_f32 v174, v174
    v_mfma_f32_16x16x32_bf16 v[116:119], a[164:167], v[204:207], v[116:119]
    v_exp_f32 v175, v175
    v_mfma_f32_16x16x32_bf16 v[148:151], a[144:147], a[32:35], 0
    v_fma_f32 v188, v188, s28, v227
    v_cvt_pk_bf16_f32 v215, v174, v175
    v_mfma_f32_16x16x32_bf16 v[148:151], a[148:151], a[36:39], v[148:151]
    v_exp_f32 v180, v180
    v_mfma_f32_16x16x32_bf16 v[148:151], a[152:155], a[40:43], v[148:151]
    ds_read_b128 a[136:139], v233 offset:34432
    v_fma_f32 v189, v189, s28, v227
    v_mfma_f32_16x16x32_bf16 v[148:151], a[156:159], a[44:47], v[148:151]
    v_exp_f32 v181, v181
    v_mfma_f32_16x16x32_bf16 v[156:159], a[144:147], a[48:51], 0
    s_add_u32 s41, s31, 16384
    ds_read_b128 a[140:143], v233 offset:34496
    v_cvt_pk_bf16_f32 v218, v180, v181
    v_mfma_f32_16x16x32_bf16 v[156:159], a[148:151], a[52:55], v[156:159]
    s_add_u32 m0, s60, 84480
    v_exp_f32 v182, v182
    v_mfma_f32_16x16x32_bf16 v[156:159], a[152:155], a[56:59], v[156:159]
    buffer_load_dwordx4 v236, s[8:11], s41 offen offset:0 nt lds
    ds_read_b64_tr_b16 a[160:161], v235 offset:34304
    v_mfma_f32_16x16x32_bf16 v[156:159], a[156:159], a[60:63], v[156:159]
    s_waitcnt lgkmcnt(4)
    v_exp_f32 v183, v183
    v_mfma_f32_16x16x32_bf16 v[24:27], a[168:171], v[192:195], v[24:27]
    ds_read_b64_tr_b16 a[162:163], v235 offset:34560
    v_fma_f32 v190, v190, s28, v227
    v_mfma_f32_16x16x32_bf16 v[28:31], a[172:175], v[192:195], v[28:31]
    v_cvt_pk_bf16_f32 v219, v182, v183
    v_fma_f32 v191, v191, s28, v227
    v_mfma_f32_16x16x32_bf16 v[56:59], a[168:171], v[196:199], v[56:59]
    v_exp_f32 v188, v188
    v_mfma_f32_16x16x32_bf16 v[60:63], a[172:175], v[196:199], v[60:63]
    v_exp_f32 v189, v189
    v_mfma_f32_16x16x32_bf16 v[88:91], a[168:171], v[200:203], v[88:91]
    ds_read_b64_tr_b16 a[164:165], v235 offset:34336
    v_cvt_pk_bf16_f32 v222, v188, v189
    v_mfma_f32_16x16x32_bf16 v[92:95], a[172:175], v[200:203], v[92:95]
    v_exp_f32 v190, v190
    v_mfma_f32_16x16x32_bf16 v[120:123], a[168:171], v[204:207], v[120:123]
    buffer_store_dwordx4 a[248:251], v238, s[24:27], s55 offen offset:128 sc0 sc1
    v_mfma_f32_16x16x32_bf16 v[124:127], a[172:175], v[204:207], v[124:127]
    s_waitcnt lgkmcnt(3)
    ds_read_b64_tr_b16 a[166:167], v235 offset:34592
    ds_read_b64_tr_b16 a[168:169], v235 offset:34368
    v_exp_f32 v191, v191
    v_fma_f32 v132, v132, s28, v224
    v_pk_fma_f32 v[128:129], v[128:129], s[64:65], v[224:225] op_sel_hi:[1,1,0]
    v_pk_fma_f32 v[130:131], v[130:131], s[64:65], v[224:225] op_sel_hi:[1,1,0]
    v_pk_fma_f32 v[136:137], v[136:137], s[64:65], v[224:225] op_sel:[0,0,1] op_sel_hi:[1,1,1]
    v_pk_fma_f32 v[138:139], v[138:139], s[64:65], v[224:225] op_sel:[0,0,1] op_sel_hi:[1,1,1]
    v_pk_fma_f32 v[144:145], v[144:145], s[64:65], v[226:227] op_sel_hi:[1,1,0]
    v_pk_fma_f32 v[146:147], v[146:147], s[64:65], v[226:227] op_sel_hi:[1,1,0]
    v_pk_fma_f32 v[152:153], v[152:153], s[64:65], v[226:227] op_sel:[0,0,1] op_sel_hi:[1,1,1]
    v_pk_fma_f32 v[154:155], v[154:155], s[64:65], v[226:227] op_sel:[0,0,1] op_sel_hi:[1,1,1]
    v_fma_f32 v133, v133, s28, v224
    v_mfma_f32_16x16x32_bf16 v[160:163], a[128:131], a[0:3], 0
    v_exp_f32 v128, v128
    v_mfma_f32_16x16x32_bf16 v[160:163], a[132:135], a[4:7], v[160:163]
    v_exp_f32 v129, v129
    v_cvt_pk_bf16_f32 v223, v190, v191
    v_mfma_f32_16x16x32_bf16 v[160:163], a[136:139], a[8:11], v[160:163]
    v_exp_f32 v130, v130
    v_mfma_f32_16x16x32_bf16 v[160:163], a[140:143], a[12:15], v[160:163]
    s_add_u32 m0, s60, 85280
    v_cvt_pk_bf16_f32 v192, v128, v129
    v_fma_f32 v134, v134, s28, v224
    v_mfma_f32_16x16x32_bf16 v[168:171], a[128:131], a[16:19], 0
    buffer_load_dwordx4 v236, s[8:11], s41 offen offset:256 nt lds
    v_mfma_f32_16x16x32_bf16 v[168:171], a[132:135], a[20:23], v[168:171]
    v_exp_f32 v131, v131
    v_mfma_f32_16x16x32_bf16 v[168:171], a[136:139], a[24:27], v[168:171]
    ds_read_b64_tr_b16 a[170:171], v235 offset:34624
    v_cvt_pk_bf16_f32 v193, v130, v131
    v_mfma_f32_16x16x32_bf16 v[168:171], a[140:143], a[28:31], v[168:171]
    v_exp_f32 v136, v136
    v_smfmac_f32_16x16x64_bf16 a[176:179], a[184:187], v[208:215], v251
    ds_read_b64_tr_b16 a[172:173], v235 offset:34400
    v_fma_f32 v135, v135, s28, v224
    v_smfmac_f32_16x16x64_bf16 a[180:183], a[184:187], v[216:223], v251
    s_waitcnt lgkmcnt(3)
    ds_read_b128 a[144:147], v233 offset:34560
    ds_read_b64_tr_b16 a[174:175], v235 offset:34656
    v_mfma_f32_16x16x32_bf16 v[0:3], a[160:163], v[208:211], v[0:3]
    v_exp_f32 v137, v137
    v_mfma_f32_16x16x32_bf16 v[4:7], a[164:167], v[208:211], v[4:7]
    s_add_u32 m0, s66, 6016
    v_cvt_pk_bf16_f32 v196, v136, v137
    v_fma_f32 v140, v140, s28, v225
    v_mfma_f32_16x16x32_bf16 v[32:35], a[160:163], v[212:215], v[32:35]
    buffer_load_dword v234, s[76:79], 0 offen offset:128 lds
    v_mfma_f32_16x16x32_bf16 v[36:39], a[164:167], v[212:215], v[36:39]
    v_exp_f32 v138, v138
    v_mfma_f32_16x16x32_bf16 v[64:67], a[160:163], v[216:219], v[64:67]
    v_exp_f32 v139, v139
    v_mfma_f32_16x16x32_bf16 v[68:71], a[164:167], v[216:219], v[68:71]
    ds_read_b128 a[148:151], v233 offset:34624
    v_cvt_pk_bf16_f32 v197, v138, v139
    v_mfma_f32_16x16x32_bf16 v[96:99], a[160:163], v[220:223], v[96:99]
    v_exp_f32 v144, v144
    v_mfma_f32_16x16x32_bf16 v[100:103], a[164:167], v[220:223], v[100:103]
    ds_read_b128 a[152:155], v233 offset:34688
    v_fma_f32 v141, v141, s28, v225
    v_mfma_f32_16x16x32_bf16 v[176:179], a[128:131], a[32:35], 0
    s_add_u32 m0, s60, 86080
    v_exp_f32 v145, v145
    v_mfma_f32_16x16x32_bf16 v[176:179], a[132:135], a[36:39], v[176:179]
    buffer_load_dwordx4 v236, s[8:11], s41 offen offset:512 nt lds
    v_mfma_f32_16x16x32_bf16 v[176:179], a[136:139], a[40:43], v[176:179]
    ds_read_b64_tr_b16 a[160:161], v235 offset:34432
    v_cvt_pk_bf16_f32 v200, v144, v145
    v_mfma_f32_16x16x32_bf16 v[176:179], a[140:143], a[44:47], v[176:179]
    v_exp_f32 v146, v146
    v_mfma_f32_16x16x32_bf16 v[184:187], a[128:131], a[48:51], 0
    ds_read_b128 a[156:159], v233 offset:34752
    v_fma_f32 v142, v142, s28, v225
    v_mfma_f32_16x16x32_bf16 v[184:187], a[132:135], a[52:55], v[184:187]
    v_exp_f32 v147, v147
    v_mfma_f32_16x16x32_bf16 v[184:187], a[136:139], a[56:59], v[184:187]
    ds_read_b64_tr_b16 a[162:163], v235 offset:34688
    v_cvt_pk_bf16_f32 v201, v146, v147
    v_mfma_f32_16x16x32_bf16 v[184:187], a[140:143], a[60:63], v[184:187]
    s_waitcnt lgkmcnt(5)
    v_exp_f32 v152, v152
    v_mfma_f32_16x16x32_bf16 v[8:11], a[168:171], v[208:211], v[8:11]
    ds_read_b64_tr_b16 a[164:165], v235 offset:34464
    v_fma_f32 v143, v143, s28, v225
    v_mfma_f32_16x16x32_bf16 v[12:15], a[172:175], v[208:211], v[12:15]
    v_exp_f32 v153, v153
    v_mfma_f32_16x16x32_bf16 v[40:43], a[168:171], v[212:215], v[40:43]
    buffer_store_dwordx4 a[252:255], v238, s[24:27], s55 offen offset:2176 sc0 sc1
    v_mfma_f32_16x16x32_bf16 v[44:47], a[172:175], v[212:215], v[44:47]
    ds_read_b64_tr_b16 a[166:167], v235 offset:34720
    v_cvt_pk_bf16_f32 v204, v152, v153
    v_mfma_f32_16x16x32_bf16 v[72:75], a[168:171], v[216:219], v[72:75]
    v_exp_f32 v154, v154
    v_mfma_f32_16x16x32_bf16 v[76:79], a[172:175], v[216:219], v[76:79]
    v_exp_f32 v155, v155
    v_mfma_f32_16x16x32_bf16 v[104:107], a[168:171], v[220:223], v[104:107]
    v_fma_f32 v148, v148, s28, v226
    v_cvt_pk_bf16_f32 v205, v154, v155
    v_mfma_f32_16x16x32_bf16 v[108:111], a[172:175], v[220:223], v[108:111]
    s_waitcnt lgkmcnt(3)
    v_exp_f32 v132, v132
    v_mfma_f32_16x16x32_bf16 v[164:167], a[144:147], a[0:3], 0
    s_add_u32 m0, s60, 86880
    v_exp_f32 v133, v133
    v_mfma_f32_16x16x32_bf16 v[164:167], a[148:151], a[4:7], v[164:167]
    buffer_load_dwordx4 v236, s[8:11], s41 offen offset:768 nt lds
    v_mfma_f32_16x16x32_bf16 v[164:167], a[152:155], a[8:11], v[164:167]
    v_fma_f32 v149, v149, s28, v226
    v_cvt_pk_bf16_f32 v194, v132, v133
    v_mfma_f32_16x16x32_bf16 v[164:167], a[156:159], a[12:15], v[164:167]
    ds_read_b64_tr_b16 a[168:169], v235 offset:34496
    v_fma_f32 v150, v150, s28, v226
    v_mfma_f32_16x16x32_bf16 v[172:175], a[144:147], a[16:19], 0
    v_exp_f32 v134, v134
    v_mfma_f32_16x16x32_bf16 v[172:175], a[148:151], a[20:23], v[172:175]
    v_exp_f32 v135, v135
    v_mfma_f32_16x16x32_bf16 v[172:175], a[152:155], a[24:27], v[172:175]
    ds_read_b64_tr_b16 a[170:171], v235 offset:34752
    v_cvt_pk_bf16_f32 v195, v134, v135
    v_mfma_f32_16x16x32_bf16 v[172:175], a[156:159], a[28:31], v[172:175]
    s_waitcnt lgkmcnt(2)
    v_exp_f32 v140, v140
    v_mfma_f32_16x16x32_bf16 v[16:19], a[160:163], v[208:211], v[16:19]
    ds_read_b64_tr_b16 a[172:173], v235 offset:34528
    ds_read_b64_tr_b16 a[174:175], v235 offset:34784
    v_mfma_f32_16x16x32_bf16 v[20:23], a[164:167], v[208:211], v[20:23]
    v_exp_f32 v141, v141
    v_mfma_f32_16x16x32_bf16 v[48:51], a[160:163], v[212:215], v[48:51]
    v_fma_f32 v151, v151, s28, v226
    v_cvt_pk_bf16_f32 v198, v140, v141
    v_mfma_f32_16x16x32_bf16 v[52:55], a[164:167], v[212:215], v[52:55]
    v_exp_f32 v142, v142
    v_mfma_f32_16x16x32_bf16 v[80:83], a[160:163], v[216:219], v[80:83]
    v_exp_f32 v143, v143
    v_mfma_f32_16x16x32_bf16 v[84:87], a[164:167], v[216:219], v[84:87]
    v_fma_f32 v156, v156, s28, v227
    v_cvt_pk_bf16_f32 v199, v142, v143
    v_mfma_f32_16x16x32_bf16 v[112:115], a[160:163], v[220:223], v[112:115]
    s_waitcnt vmcnt(22) lgkmcnt(0)
    s_barrier
    v_exp_f32 v148, v148
    v_mfma_f32_16x16x32_bf16 v[116:119], a[164:167], v[220:223], v[116:119]
    ds_read_b128 a[128:131], v232 offset:0
    ds_read_b128 a[132:135], v232 offset:64
    v_mfma_f32_16x16x32_bf16 v[180:183], a[144:147], a[32:35], 0
    v_exp_f32 v149, v149
    v_mfma_f32_16x16x32_bf16 v[180:183], a[148:151], a[36:39], v[180:183]
    v_fma_f32 v157, v157, s28, v227
    v_cvt_pk_bf16_f32 v202, v148, v149
    v_mfma_f32_16x16x32_bf16 v[180:183], a[152:155], a[40:43], v[180:183]
    ds_read_b128 a[136:139], v232 offset:128
    ds_read_b128 a[40:43], v237 offset:4096
    v_mfma_f32_16x16x32_bf16 v[180:183], a[156:159], a[44:47], v[180:183]
    v_exp_f32 v150, v150
    v_mfma_f32_16x16x32_bf16 v[188:191], a[144:147], a[48:51], 0
    ds_read_b128 a[140:143], v232 offset:192
    ds_read_b128 a[44:47], v252 offset:4096
    v_mfma_f32_16x16x32_bf16 v[188:191], a[148:151], a[52:55], v[188:191]
    v_exp_f32 v151, v151
    v_mfma_f32_16x16x32_bf16 v[188:191], a[152:155], a[56:59], v[188:191]
L_pad5:
    s_cbranch_execz L_pad9
    ds_read_b64_tr_b16 a[160:161], v234 offset:0
    v_fma_f32 v158, v158, s28, v227
    v_mfma_f32_16x16x32_bf16 v[188:191], a[156:159], a[60:63], v[188:191]
    ds_read_b128 a[48:51], v237 offset:0
    v_cvt_pk_bf16_f32 v203, v150, v151
    v_mfma_f32_16x16x32_bf16 v[24:27], a[168:171], v[208:211], v[24:27]
    v_exp_f32 v156, v156
    v_mfma_f32_16x16x32_bf16 v[28:31], a[172:175], v[208:211], v[28:31]
    ds_read_b64_tr_b16 a[162:163], v234 offset:256
    ds_read_b128 a[52:55], v252 offset:0
    v_mfma_f32_16x16x32_bf16 v[56:59], a[168:171], v[212:215], v[56:59]
    v_exp_f32 v157, v157
    v_fma_f32 v159, v159, s28, v227
    v_mfma_f32_16x16x32_bf16 v[60:63], a[172:175], v[212:215], v[60:63]
    ds_read_b64_tr_b16 a[164:165], v234 offset:32
    v_cvt_pk_bf16_f32 v206, v156, v157
    v_mfma_f32_16x16x32_bf16 v[88:91], a[168:171], v[216:219], v[88:91]
    ds_read_b128 a[56:59], v237 offset:2048
    v_exp_f32 v158, v158
    v_mfma_f32_16x16x32_bf16 v[92:95], a[172:175], v[216:219], v[92:95]
    ds_read_b64_tr_b16 a[166:167], v234 offset:288
    ds_read_b128 a[60:63], v252 offset:2048
    v_mfma_f32_16x16x32_bf16 v[120:123], a[168:171], v[220:223], v[120:123]
    v_exp_f32 v159, v159
    v_mfma_f32_16x16x32_bf16 v[124:127], a[172:175], v[220:223], v[124:127]
    s_waitcnt lgkmcnt(9)
    v_cvt_pk_bf16_f32 v207, v158, v159
    v_mfma_f32_16x16x32_bf16 v[128:131], a[128:131], a[64:67], 0
    ds_read_b64_tr_b16 a[168:169], v234 offset:64
    ds_read_b64_tr_b16 a[170:171], v234 offset:320
    v_accvgpr_mov_b32 a0, a64
    v_accvgpr_mov_b32 a1, a65
    v_accvgpr_mov_b32 a2, a66
    v_pk_fma_f32 v[160:161], v[160:161], s[64:65], v[224:225] op_sel_hi:[1,1,0]
    v_pk_fma_f32 v[162:163], v[162:163], s[64:65], v[224:225] op_sel_hi:[1,1,0]
    v_pk_fma_f32 v[168:169], v[168:169], s[64:65], v[224:225] op_sel:[0,0,1] op_sel_hi:[1,1,1]
    v_pk_fma_f32 v[170:171], v[170:171], s[64:65], v[224:225] op_sel:[0,0,1] op_sel_hi:[1,1,1]
    v_pk_fma_f32 v[176:177], v[176:177], s[64:65], v[226:227] op_sel_hi:[1,1,0]
    v_pk_fma_f32 v[178:179], v[178:179], s[64:65], v[226:227] op_sel_hi:[1,1,0]
    v_pk_fma_f32 v[184:185], v[184:185], s[64:65], v[226:227] op_sel:[0,0,1] op_sel_hi:[1,1,1]
    v_pk_fma_f32 v[186:187], v[186:187], s[64:65], v[226:227] op_sel:[0,0,1] op_sel_hi:[1,1,1]
    v_accvgpr_mov_b32 a3, a67
    v_mfma_f32_16x16x32_bf16 v[128:131], a[132:135], a[68:71], v[128:131]
    v_exp_f32 v160, v160
    v_mfma_f32_16x16x32_bf16 v[128:131], a[136:139], a[72:75], v[128:131]
    s_add_u32 s52, s33, 0
    v_exp_f32 v161, v161
    v_mfma_f32_16x16x32_bf16 v[128:131], a[140:143], a[76:79], v[128:131]
    s_add_u32 s53, s33, 4096
    v_exp_f32 v162, v162
    v_mfma_f32_16x16x32_bf16 v[136:139], a[128:131], a[80:83], 0
    s_add_u32 s40, s31, 49152
    v_cvt_pk_bf16_f32 v208, v160, v161
    v_accvgpr_mov_b32 a4, a68
    v_mfma_f32_16x16x32_bf16 v[136:139], a[132:135], a[84:87], v[136:139]
    s_add_u32 m0, s60, 101376
    v_exp_f32 v163, v163
    v_mfma_f32_16x16x32_bf16 v[136:139], a[136:139], a[88:91], v[136:139]
    s_add_u32 s54, s33, 8192
    buffer_load_dwordx4 v236, s[4:7], s40 offen offset:0 nt lds
    v_mfma_f32_16x16x32_bf16 v[136:139], a[140:143], a[92:95], v[136:139]
    s_add_u32 s55, s33, 12288
    v_accvgpr_mov_b32 a5, a69
    v_cvt_pk_bf16_f32 v209, v162, v163
    v_smfmac_f32_16x16x64_bf16 a[176:179], a[184:187], v[192:199], v251
    s_mov_b32 s26, s36
    ds_read_b64_tr_b16 a[172:173], v234 offset:96
    v_accvgpr_mov_b32 a6, a70
    v_smfmac_f32_16x16x64_bf16 a[180:183], a[184:187], v[200:207], v251
    s_waitcnt lgkmcnt(4)
    ds_read_b128 a[144:147], v232 offset:256
    v_accvgpr_mov_b32 a7, a71
    v_mfma_f32_16x16x32_bf16 v[0:3], a[160:163], v[192:195], v[0:3]
    s_mov_b32 s22, 48234496
    v_exp_f32 v168, v168
    v_mfma_f32_16x16x32_bf16 v[4:7], a[164:167], v[192:195], v[4:7]
    s_add_u32 m0, s60, 102176
    v_exp_f32 v169, v169
    v_mfma_f32_16x16x32_bf16 v[32:35], a[160:163], v[196:199], v[32:35]
    s_mov_b32 s33, s34
    buffer_load_dwordx4 v236, s[4:7], s40 offen offset:256 nt lds
    v_mfma_f32_16x16x32_bf16 v[36:39], a[164:167], v[196:199], v[36:39]
    s_mov_b32 s34, s35
    ds_read_b64_tr_b16 a[174:175], v234 offset:352
    v_cvt_pk_bf16_f32 v212, v168, v169
    v_mfma_f32_16x16x32_bf16 v[64:67], a[160:163], v[200:203], v[64:67]
    s_mov_b32 s36, s37
    v_exp_f32 v170, v170
    v_mfma_f32_16x16x32_bf16 v[68:71], a[164:167], v[200:203], v[68:71]
    s_mov_b32 s37, s38
    ds_read_b128 a[148:151], v232 offset:320
    v_accvgpr_mov_b32 a8, a72
    v_mfma_f32_16x16x32_bf16 v[96:99], a[160:163], v[204:207], v[96:99]
    s_add_u32 s56, s34, 0
    v_accvgpr_mov_b32 a9, a73
    v_accvgpr_mov_b32 a10, a74
    v_mfma_f32_16x16x32_bf16 v[100:103], a[164:167], v[204:207], v[100:103]
    s_add_u32 s57, s34, 4096
    v_exp_f32 v171, v171
    v_mfma_f32_16x16x32_bf16 v[144:147], a[128:131], a[96:99], 0
    s_add_u32 s58, s34, 8192
    ds_read_b128 a[152:155], v232 offset:384
    v_cvt_pk_bf16_f32 v213, v170, v171
    v_mfma_f32_16x16x32_bf16 v[144:147], a[132:135], a[100:103], v[144:147]
    s_add_u32 m0, s66, 5888
    v_exp_f32 v176, v176
    v_mfma_f32_16x16x32_bf16 v[144:147], a[136:139], a[40:43], v[144:147]
    s_add_u32 s59, s34, 12288
    buffer_load_dword v234, s[76:79], 0 offen offset:256 lds
    v_mfma_f32_16x16x32_bf16 v[144:147], a[140:143], a[44:47], v[144:147]
    s_mov_b32 s14, s39
    v_accvgpr_mov_b32 a11, a75
    v_max3_f32 v240, v128, v129, v130
    v_mfma_f32_16x16x32_bf16 v[152:155], a[128:131], a[48:51], 0
    s_min_u32 s18, s37, s39
    ds_read_b64_tr_b16 a[160:161], v234 offset:128
    v_exp_f32 v177, v177
    v_max3_f32 v242, v136, v137, v138
    v_accvgpr_mov_b32 a12, a76
    v_mfma_f32_16x16x32_bf16 v[152:155], a[132:135], a[52:55], v[152:155]
    s_min_u32 s42, s42, s39
    ds_read_b128 a[156:159], v232 offset:448
    v_cvt_pk_bf16_f32 v216, v176, v177
    v_mfma_f32_16x16x32_bf16 v[152:155], a[136:139], a[56:59], v[152:155]
    s_mov_b32 s39, 0
    s_waitcnt lgkmcnt(9)
    v_exp_f32 v178, v178
    v_accvgpr_mov_b32 a13, a77
    v_mfma_f32_16x16x32_bf16 v[152:155], a[140:143], a[60:63], v[152:155]
    s_waitcnt lgkmcnt(4)
    ds_read_b64_tr_b16 a[162:163], v234 offset:384
    v_max_f32 v240, v240, v131
    v_accvgpr_mov_b32 a14, a78
    v_mfma_f32_16x16x32_bf16 v[8:11], a[168:171], v[192:195], v[8:11]
    v_max3_f32 v244, v144, v145, v146
    v_max_f32 v242, v242, v139
    v_exp_f32 v179, v179
    v_max_f32 v244, v244, v147
    v_mfma_f32_16x16x32_bf16 v[12:15], a[172:175], v[192:195], v[12:15]
    s_add_u32 m0, s60, 102976
    v_accvgpr_mov_b32 a15, a79
    v_cvt_pk_bf16_f32 v217, v178, v179
    v_mfma_f32_16x16x32_bf16 v[40:43], a[168:171], v[196:199], v[40:43]
    buffer_load_dwordx4 v236, s[4:7], s40 offen offset:512 nt lds
    ds_read_b64_tr_b16 a[164:165], v234 offset:160
    v_exp_f32 v184, v184
    v_mov_b32 v241, v240
    v_mfma_f32_16x16x32_bf16 v[44:47], a[172:175], v[196:199], v[44:47]
    v_accvgpr_mov_b32 a16, a80
    v_mov_b32 v243, v242
    v_mfma_f32_16x16x32_bf16 v[72:75], a[168:171], v[200:203], v[72:75]
    v_max3_f32 v246, v152, v153, v154
    v_max_f32 v246, v246, v155
    v_exp_f32 v185, v185
    v_mov_b32 v245, v244
    v_accvgpr_mov_b32 a17, a81
    v_mfma_f32_16x16x32_bf16 v[76:79], a[172:175], v[200:203], v[76:79]
    ds_read_b64_tr_b16 a[166:167], v234 offset:416
    v_mov_b32 v247, v246
    v_cvt_pk_bf16_f32 v220, v184, v185
    v_exp_f32 v186, v186
    v_pk_fma_f32 v[164:165], v[164:165], s[64:65], v[224:225] op_sel_hi:[1,1,0]
    v_pk_fma_f32 v[166:167], v[166:167], s[64:65], v[224:225] op_sel_hi:[1,1,0]
    v_pk_fma_f32 v[172:173], v[172:173], s[64:65], v[224:225] op_sel:[0,0,1] op_sel_hi:[1,1,1]
    v_pk_fma_f32 v[174:175], v[174:175], s[64:65], v[224:225] op_sel:[0,0,1] op_sel_hi:[1,1,1]
    v_pk_fma_f32 v[180:181], v[180:181], s[64:65], v[226:227] op_sel_hi:[1,1,0]
    v_pk_fma_f32 v[182:183], v[182:183], s[64:65], v[226:227] op_sel_hi:[1,1,0]
    v_pk_fma_f32 v[188:189], v[188:189], s[64:65], v[226:227] op_sel:[0,0,1] op_sel_hi:[1,1,1]
    v_pk_fma_f32 v[190:191], v[190:191], s[64:65], v[226:227] op_sel:[0,0,1] op_sel_hi:[1,1,1]
    v_accvgpr_mov_b32 a18, a82
    v_mfma_f32_16x16x32_bf16 v[104:107], a[168:171], v[204:207], v[104:107]
    v_permlane16_swap_b32 v240, v241
    v_mfma_f32_16x16x32_bf16 v[108:111], a[172:175], v[204:207], v[108:111]
    s_waitcnt lgkmcnt(3)
    v_permlane16_swap_b32 v242, v243
    v_accvgpr_mov_b32 a19, a83
    v_mfma_f32_16x16x32_bf16 v[132:135], a[144:147], a[64:67], 0
    v_exp_f32 v187, v187
    v_permlane16_swap_b32 v244, v245
    v_mfma_f32_16x16x32_bf16 v[132:135], a[148:151], a[68:71], v[132:135]
    s_add_u32 m0, s60, 103776
    v_permlane16_swap_b32 v246, v247
    v_accvgpr_mov_b32 a20, a84
    v_cvt_pk_bf16_f32 v221, v186, v187
    v_max_f32 v240, v240, v241
    v_mfma_f32_16x16x32_bf16 v[132:135], a[152:155], a[72:75], v[132:135]
    buffer_load_dwordx4 v236, s[4:7], s40 offen offset:768 nt lds
    v_exp_f32 v164, v164
    v_max_f32 v242, v242, v243
    v_mfma_f32_16x16x32_bf16 v[132:135], a[156:159], a[76:79], v[132:135]
    v_accvgpr_mov_b32 a21, a85
    v_max_f32 v244, v244, v245
    v_mfma_f32_16x16x32_bf16 v[140:143], a[144:147], a[80:83], 0
    ds_read_b64_tr_b16 a[168:169], v234 offset:192
    v_exp_f32 v165, v165
    v_max_f32 v246, v246, v247
    v_accvgpr_mov_b32 a22, a86
    v_mfma_f32_16x16x32_bf16 v[140:143], a[148:151], a[84:87], v[140:143]
    v_mov_b32 v241, v240
    v_cvt_pk_bf16_f32 v210, v164, v165
    v_mfma_f32_16x16x32_bf16 v[140:143], a[152:155], a[88:91], v[140:143]
    v_exp_f32 v166, v166
    v_accvgpr_mov_b32 a23, a87
    v_mov_b32 v243, v242
    v_mfma_f32_16x16x32_bf16 v[140:143], a[156:159], a[92:95], v[140:143]
    s_waitcnt lgkmcnt(1)
    ds_read_b64_tr_b16 a[170:171], v234 offset:448
    v_mov_b32 v245, v244
    v_accvgpr_mov_b32 a24, a88
    v_mfma_f32_16x16x32_bf16 v[16:19], a[160:163], v[192:195], v[16:19]
    s_add_u32 s41, s31, 32768
    v_exp_f32 v167, v167
    v_mov_b32 v247, v246
    v_mfma_f32_16x16x32_bf16 v[20:23], a[164:167], v[192:195], v[20:23]
    s_add_u32 m0, s60, 118272
    v_permlane32_swap_b32 v240, v241
    v_accvgpr_mov_b32 a25, a89
    v_cvt_pk_bf16_f32 v211, v166, v167
    v_mfma_f32_16x16x32_bf16 v[48:51], a[160:163], v[196:199], v[48:51]
    buffer_load_dwordx4 v236, s[8:11], s41 offen offset:0 nt lds
    ds_read_b64_tr_b16 a[172:173], v234 offset:224
    v_permlane32_swap_b32 v242, v243
    v_exp_f32 v172, v172
    v_permlane32_swap_b32 v244, v245
    v_mfma_f32_16x16x32_bf16 v[52:55], a[164:167], v[196:199], v[52:55]
    ds_read_b128 a[128:131], v232 offset:512
    v_accvgpr_mov_b32 a26, a90
    v_permlane32_swap_b32 v246, v247
    v_mfma_f32_16x16x32_bf16 v[80:83], a[160:163], v[200:203], v[80:83]
    v_exp_f32 v173, v173
    v_accvgpr_mov_b32 a27, a91
    v_max_f32 v240, v240, v241
    v_mfma_f32_16x16x32_bf16 v[84:87], a[164:167], v[200:203], v[84:87]
    ds_read_b64_tr_b16 a[174:175], v234 offset:480
    v_max_f32 v242, v242, v243
    v_cvt_pk_bf16_f32 v214, v172, v173
    v_mfma_f32_16x16x32_bf16 v[112:115], a[160:163], v[204:207], v[112:115]
    v_exp_f32 v174, v174
    v_accvgpr_mov_b32 a28, a92
    v_max_f32 v244, v244, v245
    v_mfma_f32_16x16x32_bf16 v[116:119], a[164:167], v[204:207], v[116:119]
    ds_read_b128 a[132:135], v232 offset:576
    v_max_f32 v246, v246, v247
    v_accvgpr_mov_b32 a29, a93
    v_mfma_f32_16x16x32_bf16 v[148:151], a[144:147], a[96:99], 0
    v_exp_f32 v175, v175
    v_mfma_f32_16x16x32_bf16 v[148:151], a[148:151], a[100:103], v[148:151]
    s_add_u32 m0, s60, 119072
    v_accvgpr_mov_b32 a30, a94
    v_cvt_pk_bf16_f32 v215, v174, v175
    v_mfma_f32_16x16x32_bf16 v[148:151], a[152:155], a[40:43], v[148:151]
    buffer_load_dwordx4 v236, s[8:11], s41 offen offset:256 nt lds
    ds_read_b128 a[136:139], v232 offset:640
    v_exp_f32 v180, v180
    v_mfma_f32_16x16x32_bf16 v[148:151], a[156:159], a[44:47], v[148:151]
    v_accvgpr_mov_b32 a31, a95
    v_accvgpr_mov_b32 a32, a96
    v_mfma_f32_16x16x32_bf16 v[156:159], a[144:147], a[48:51], 0
    v_exp_f32 v181, v181
    v_mfma_f32_16x16x32_bf16 v[156:159], a[148:151], a[52:55], v[156:159]
    ds_read_b128 a[140:143], v232 offset:704
    v_cvt_pk_bf16_f32 v218, v180, v181
    v_mfma_f32_16x16x32_bf16 v[156:159], a[152:155], a[56:59], v[156:159]
    ds_read_b64_tr_b16 a[160:161], v234 offset:512
    v_exp_f32 v182, v182
    v_accvgpr_mov_b32 a33, a97
    v_mfma_f32_16x16x32_bf16 v[156:159], a[156:159], a[60:63], v[156:159]
    s_waitcnt lgkmcnt(4)
    v_accvgpr_mov_b32 a34, a98
    v_accvgpr_mov_b32 a35, a99
    v_mfma_f32_16x16x32_bf16 v[24:27], a[168:171], v[192:195], v[24:27]
    v_exp_f32 v183, v183
    v_mfma_f32_16x16x32_bf16 v[28:31], a[172:175], v[192:195], v[28:31]
    s_add_u32 m0, s66, 5760
    ds_read_b64_tr_b16 a[162:163], v234 offset:768
    v_cvt_pk_bf16_f32 v219, v182, v183
    v_mfma_f32_16x16x32_bf16 v[56:59], a[168:171], v[196:199], v[56:59]
    buffer_load_dword v234, s[76:79], 0 offen offset:384 lds
    v_exp_f32 v188, v188
    v_mfma_f32_16x16x32_bf16 v[60:63], a[172:175], v[196:199], v[60:63]
    ds_read_b64_tr_b16 a[164:165], v234 offset:544
    v_accvgpr_mov_b32 a36, a100
    v_mfma_f32_16x16x32_bf16 v[88:91], a[168:171], v[200:203], v[88:91]
    v_exp_f32 v189, v189
    v_accvgpr_mov_b32 a37, a101
    v_mfma_f32_16x16x32_bf16 v[92:95], a[172:175], v[200:203], v[92:95]
    v_cvt_pk_bf16_f32 v222, v188, v189
    v_accvgpr_mov_b32 a38, a102
    v_mfma_f32_16x16x32_bf16 v[120:123], a[168:171], v[204:207], v[120:123]
    v_exp_f32 v190, v190
    v_mfma_f32_16x16x32_bf16 v[124:127], a[172:175], v[204:207], v[124:127]
    s_waitcnt lgkmcnt(3)
    ds_read_b64_tr_b16 a[166:167], v234 offset:800
    v_accvgpr_mov_b32 a39, a103
    v_mfma_f32_16x16x32_bf16 v[160:163], a[128:131], a[64:67], 0
    v_exp_f32 v191, v191
    v_mfma_f32_16x16x32_bf16 v[160:163], a[132:135], a[68:71], v[160:163]
    s_add_u32 m0, s60, 119872
    v_mul_f32 v224, s51, v240
    v_mul_f32 v225, s51, v242
    v_mul_f32 v226, s51, v244
    v_mul_f32 v227, s51, v246
    v_cvt_pk_bf16_f32 v223, v190, v191
    v_mfma_f32_16x16x32_bf16 v[160:163], a[136:139], a[72:75], v[160:163]
    buffer_load_dwordx4 v236, s[8:11], s41 offen offset:512 nt lds
    ds_read_b64_tr_b16 a[168:169], v234 offset:576
    v_pk_fma_f32 v[128:129], v[128:129], s[64:65], v[224:225] op_sel_hi:[1,1,0]
    v_pk_fma_f32 v[130:131], v[130:131], s[64:65], v[224:225] op_sel_hi:[1,1,0]
    v_pk_fma_f32 v[136:137], v[136:137], s[64:65], v[224:225] op_sel:[0,0,1] op_sel_hi:[1,1,1]
    v_pk_fma_f32 v[138:139], v[138:139], s[64:65], v[224:225] op_sel:[0,0,1] op_sel_hi:[1,1,1]
    v_pk_fma_f32 v[144:145], v[144:145], s[64:65], v[226:227] op_sel_hi:[1,1,0]
    v_pk_fma_f32 v[146:147], v[146:147], s[64:65], v[226:227] op_sel_hi:[1,1,0]
    v_pk_fma_f32 v[152:153], v[152:153], s[64:65], v[226:227] op_sel:[0,0,1] op_sel_hi:[1,1,1]
    v_pk_fma_f32 v[154:155], v[154:155], s[64:65], v[226:227] op_sel:[0,0,1] op_sel_hi:[1,1,1]
    s_nop 0
    v_mfma_f32_16x16x32_bf16 v[160:163], a[140:143], a[76:79], v[160:163]
    v_exp_f32 v128, v128
    v_mfma_f32_16x16x32_bf16 v[168:171], a[128:131], a[80:83], 0
    v_exp_f32 v129, v129
    v_mfma_f32_16x16x32_bf16 v[168:171], a[132:135], a[84:87], v[168:171]
    ds_read_b64_tr_b16 a[170:171], v234 offset:832
    v_cvt_pk_bf16_f32 v192, v128, v129
    v_mfma_f32_16x16x32_bf16 v[168:171], a[136:139], a[88:91], v[168:171]
    v_exp_f32 v130, v130
    v_mfma_f32_16x16x32_bf16 v[168:171], a[140:143], a[92:95], v[168:171]
    v_exp_f32 v131, v131
    v_smfmac_f32_16x16x64_bf16 a[176:179], a[184:187], v[208:215], v251
    ds_read_b64_tr_b16 a[172:173], v234 offset:608
    v_cvt_pk_bf16_f32 v193, v130, v131
    v_smfmac_f32_16x16x64_bf16 a[180:183], a[184:187], v[216:223], v251
    s_waitcnt lgkmcnt(3)
    ds_read_b128 a[144:147], v232 offset:768
    ds_read_b64_tr_b16 a[174:175], v234 offset:864
    v_mfma_f32_16x16x32_bf16 v[0:3], a[160:163], v[208:211], v[0:3]
    s_add_u32 m0, s60, 120672
    v_exp_f32 v136, v136
    v_mfma_f32_16x16x32_bf16 v[4:7], a[164:167], v[208:211], v[4:7]
    buffer_load_dwordx4 v236, s[8:11], s41 offen offset:768 nt lds
    v_mfma_f32_16x16x32_bf16 v[32:35], a[160:163], v[212:215], v[32:35]
    v_exp_f32 v137, v137
    v_mfma_f32_16x16x32_bf16 v[36:39], a[164:167], v[212:215], v[36:39]
    s_mov_b32 s30, s31
    v_accvgpr_read_b32 v228, a176
    v_accvgpr_read_b32 v240, a177
    v_mfma_f32_16x16x32_bf16 v[64:67], a[160:163], v[216:219], v[64:67]
    s_mov_b32 s31, s32
    v_accvgpr_read_b32 v229, a178
    v_cvt_pk_bf16_f32 v196, v136, v137
    v_mfma_f32_16x16x32_bf16 v[68:71], a[164:167], v[216:219], v[68:71]
    v_exp_f32 v138, v138
    v_accvgpr_read_b32 v241, a179
    v_accvgpr_read_b32 v230, a180
    v_mfma_f32_16x16x32_bf16 v[96:99], a[160:163], v[220:223], v[96:99]
    v_accvgpr_read_b32 v242, a181
    v_accvgpr_read_b32 v231, a182
    v_accvgpr_read_b32 v243, a183
    v_add_f32 v228, v228, v240
    v_mfma_f32_16x16x32_bf16 v[100:103], a[164:167], v[220:223], v[100:103]
    ds_read_b128 a[148:151], v232 offset:832
    v_add_f32 v229, v229, v241
    v_exp_f32 v139, v139
    v_add_f32 v230, v230, v242
    v_add_f32 v231, v231, v243
    v_mfma_f32_16x16x32_bf16 v[176:179], a[128:131], a[96:99], 0
    v_add_f32 v239, v228, v229
    v_add_f32 v239, v239, v230
    v_add_f32 v239, v239, v231
    v_cmp_nge_f32 vcc, s61, v239
    v_rcp_f32 v228, v228
    v_rcp_f32 v229, v229
    v_rcp_f32 v230, v230
    v_rcp_f32 v231, v231
    v_mfma_f32_16x16x32_bf16 v[176:179], a[132:135], a[100:103], v[176:179]
    v_cvt_pk_bf16_f32 v197, v138, v139
    v_xor_b32 v244, 64, v248
    v_exp_f32 v144, v144
    v_xor_b32 v245, 64, v249
    v_mfma_f32_16x16x32_bf16 v[176:179], a[136:139], a[40:43], v[176:179]
    s_cmp_lg_u64 vcc, 0
    s_addc_u32 s47, s47, s47
    ds_read_b128 a[152:155], v232 offset:896
    ds_read_b64_tr_b16 a[160:161], v234 offset:640
    v_exp_f32 v145, v145
    v_pk_mul_f32 v[0:1], v[0:1], v[228:229] op_sel_hi:[1,0]
    v_pk_mul_f32 v[2:3], v[2:3], v[228:229] op_sel_hi:[1,0]
    v_pk_mul_f32 v[4:5], v[4:5], v[228:229] op_sel_hi:[1,0]
    v_pk_mul_f32 v[6:7], v[6:7], v[228:229] op_sel_hi:[1,0]
    v_pk_mul_f32 v[32:33], v[32:33], v[228:229] op_sel:[0,1] op_sel_hi:[1,1]
    v_pk_mul_f32 v[34:35], v[34:35], v[228:229] op_sel:[0,1] op_sel_hi:[1,1]
    v_pk_mul_f32 v[36:37], v[36:37], v[228:229] op_sel:[0,1] op_sel_hi:[1,1]
    v_pk_mul_f32 v[38:39], v[38:39], v[228:229] op_sel:[0,1] op_sel_hi:[1,1]
    v_pk_mul_f32 v[64:65], v[64:65], v[230:231] op_sel_hi:[1,0]
    v_pk_mul_f32 v[66:67], v[66:67], v[230:231] op_sel_hi:[1,0]
    v_pk_mul_f32 v[68:69], v[68:69], v[230:231] op_sel_hi:[1,0]
    v_pk_mul_f32 v[70:71], v[70:71], v[230:231] op_sel_hi:[1,0]
    v_pk_mul_f32 v[96:97], v[96:97], v[230:231] op_sel:[0,1] op_sel_hi:[1,1]
    v_pk_mul_f32 v[98:99], v[98:99], v[230:231] op_sel:[0,1] op_sel_hi:[1,1]
    v_pk_mul_f32 v[100:101], v[100:101], v[230:231] op_sel:[0,1] op_sel_hi:[1,1]
    v_pk_mul_f32 v[102:103], v[102:103], v[230:231] op_sel:[0,1] op_sel_hi:[1,1]
    v_exp_f32 v146, v146
    v_mfma_f32_16x16x32_bf16 v[176:179], a[140:143], a[44:47], v[176:179]
    ds_read_b128 a[156:159], v232 offset:960
    v_cvt_pk_bf16_f32 v200, v144, v145
    v_mfma_f32_16x16x32_bf16 v[184:187], a[128:131], a[48:51], 0
    v_cvt_pk_bf16_f32 v0, v0, v1
    v_cvt_pk_bf16_f32 v1, v2, v3
    v_mfma_f32_16x16x32_bf16 v[184:187], a[132:135], a[52:55], v[184:187]
    ds_read_b64_tr_b16 a[162:163], v234 offset:896
    v_cvt_pk_bf16_f32 v2, v4, v5
    v_mfma_f32_16x16x32_bf16 v[184:187], a[136:139], a[56:59], v[184:187]
    v_exp_f32 v147, v147
    v_mfma_f32_16x16x32_bf16 v[184:187], a[140:143], a[60:63], v[184:187]
    s_waitcnt lgkmcnt(5)
    v_cvt_pk_bf16_f32 v3, v6, v7
    v_cvt_pk_bf16_f32 v32, v32, v33
    v_mfma_f32_16x16x32_bf16 v[8:11], a[168:171], v[208:211], v[8:11]
    v_cvt_pk_bf16_f32 v201, v146, v147
    v_cvt_pk_bf16_f32 v33, v34, v35
    v_mfma_f32_16x16x32_bf16 v[12:15], a[172:175], v[208:211], v[12:15]
    v_exp_f32 v152, v152
    v_cvt_pk_bf16_f32 v34, v36, v37
    v_mfma_f32_16x16x32_bf16 v[40:43], a[168:171], v[212:215], v[40:43]
    ds_read_b64_tr_b16 a[164:165], v234 offset:672
    v_cvt_pk_bf16_f32 v35, v38, v39
    v_exp_f32 v153, v153
    v_mfma_f32_16x16x32_bf16 v[44:47], a[172:175], v[212:215], v[44:47]
    v_cvt_pk_bf16_f32 v64, v64, v65
    v_cvt_pk_bf16_f32 v65, v66, v67
    v_mfma_f32_16x16x32_bf16 v[72:75], a[168:171], v[216:219], v[72:75]
    ds_read_b64_tr_b16 a[166:167], v234 offset:928
    v_cvt_pk_bf16_f32 v66, v68, v69
    v_cvt_pk_bf16_f32 v204, v152, v153
    v_exp_f32 v154, v154
    v_pk_fma_f32 v[132:133], v[132:133], s[64:65], v[224:225] op_sel_hi:[1,1,0]
    v_pk_fma_f32 v[134:135], v[134:135], s[64:65], v[224:225] op_sel_hi:[1,1,0]
    v_pk_fma_f32 v[140:141], v[140:141], s[64:65], v[224:225] op_sel:[0,0,1] op_sel_hi:[1,1,1]
    v_pk_fma_f32 v[142:143], v[142:143], s[64:65], v[224:225] op_sel:[0,0,1] op_sel_hi:[1,1,1]
    v_pk_fma_f32 v[148:149], v[148:149], s[64:65], v[226:227] op_sel_hi:[1,1,0]
    v_pk_fma_f32 v[150:151], v[150:151], s[64:65], v[226:227] op_sel_hi:[1,1,0]
    v_pk_fma_f32 v[156:157], v[156:157], s[64:65], v[226:227] op_sel:[0,0,1] op_sel_hi:[1,1,1]
    v_pk_fma_f32 v[158:159], v[158:159], s[64:65], v[226:227] op_sel:[0,0,1] op_sel_hi:[1,1,1]
    v_cvt_pk_bf16_f32 v67, v70, v71
    v_mfma_f32_16x16x32_bf16 v[76:79], a[172:175], v[216:219], v[76:79]
    v_exp_f32 v155, v155
    v_cvt_pk_bf16_f32 v96, v96, v97
    v_mfma_f32_16x16x32_bf16 v[104:107], a[168:171], v[220:223], v[104:107]
    v_cvt_pk_bf16_f32 v97, v98, v99
    v_cvt_pk_bf16_f32 v98, v100, v101
    v_mfma_f32_16x16x32_bf16 v[108:111], a[172:175], v[220:223], v[108:111]
    s_waitcnt lgkmcnt(3)
    v_cvt_pk_bf16_f32 v99, v102, v103
    v_cvt_pk_bf16_f32 v205, v154, v155
    v_mfma_f32_16x16x32_bf16 v[164:167], a[144:147], a[64:67], 0
    ds_write_b64 v248, v[0:1] offset:0
    v_exp_f32 v132, v132
    v_mfma_f32_16x16x32_bf16 v[164:167], a[148:151], a[68:71], v[164:167]
    v_exp_f32 v133, v133
    v_mfma_f32_16x16x32_bf16 v[164:167], a[152:155], a[72:75], v[164:167]
    ds_read_b64_tr_b16 a[168:169], v234 offset:704
    ds_write_b64 v249, v[2:3] offset:0
    v_pk_mul_f32 v[8:9], v[8:9], v[228:229] op_sel_hi:[1,0]
    v_pk_mul_f32 v[10:11], v[10:11], v[228:229] op_sel_hi:[1,0]
    v_pk_mul_f32 v[12:13], v[12:13], v[228:229] op_sel_hi:[1,0]
    v_pk_mul_f32 v[14:15], v[14:15], v[228:229] op_sel_hi:[1,0]
    v_pk_mul_f32 v[40:41], v[40:41], v[228:229] op_sel:[0,1] op_sel_hi:[1,1]
    v_pk_mul_f32 v[42:43], v[42:43], v[228:229] op_sel:[0,1] op_sel_hi:[1,1]
    v_pk_mul_f32 v[44:45], v[44:45], v[228:229] op_sel:[0,1] op_sel_hi:[1,1]
    v_pk_mul_f32 v[46:47], v[46:47], v[228:229] op_sel:[0,1] op_sel_hi:[1,1]
    v_pk_mul_f32 v[72:73], v[72:73], v[230:231] op_sel_hi:[1,0]
    v_pk_mul_f32 v[74:75], v[74:75], v[230:231] op_sel_hi:[1,0]
    v_pk_mul_f32 v[76:77], v[76:77], v[230:231] op_sel_hi:[1,0]
    v_pk_mul_f32 v[78:79], v[78:79], v[230:231] op_sel_hi:[1,0]
    v_pk_mul_f32 v[104:105], v[104:105], v[230:231] op_sel:[0,1] op_sel_hi:[1,1]
    v_pk_mul_f32 v[106:107], v[106:107], v[230:231] op_sel:[0,1] op_sel_hi:[1,1]
    v_pk_mul_f32 v[108:109], v[108:109], v[230:231] op_sel:[0,1] op_sel_hi:[1,1]
    v_pk_mul_f32 v[110:111], v[110:111], v[230:231] op_sel:[0,1] op_sel_hi:[1,1]
    v_cvt_pk_bf16_f32 v194, v132, v133
    v_mfma_f32_16x16x32_bf16 v[164:167], a[156:159], a[76:79], v[164:167]
    v_exp_f32 v134, v134
    v_mfma_f32_16x16x32_bf16 v[172:175], a[144:147], a[80:83], 0
    v_cvt_pk_bf16_f32 v8, v8, v9
    v_cvt_pk_bf16_f32 v9, v10, v11
    v_mfma_f32_16x16x32_bf16 v[172:175], a[148:151], a[84:87], v[172:175]
    ds_write_b64 v244, v[8:9] offset:0
    v_cvt_pk_bf16_f32 v10, v12, v13
    v_mfma_f32_16x16x32_bf16 v[172:175], a[152:155], a[88:91], v[172:175]
    v_exp_f32 v135, v135
    v_cvt_pk_bf16_f32 v11, v14, v15
    v_mfma_f32_16x16x32_bf16 v[172:175], a[156:159], a[92:95], v[172:175]
    s_waitcnt lgkmcnt(4)
    ds_read_b64_tr_b16 a[170:171], v234 offset:960
    v_cvt_pk_bf16_f32 v40, v40, v41
    v_cvt_pk_bf16_f32 v41, v42, v43
    v_mfma_f32_16x16x32_bf16 v[16:19], a[160:163], v[208:211], v[16:19]
    ds_read_b64_tr_b16 a[172:173], v234 offset:736
    ds_read_b64_tr_b16 a[174:175], v234 offset:992
    ds_write_b64 v245, v[10:11] offset:0
    v_cvt_pk_bf16_f32 v42, v44, v45
    v_cvt_pk_bf16_f32 v195, v134, v135
    v_exp_f32 v140, v140
    v_cvt_pk_bf16_f32 v43, v46, v47
    v_mfma_f32_16x16x32_bf16 v[20:23], a[164:167], v[208:211], v[20:23]
    v_cvt_pk_bf16_f32 v72, v72, v73
    v_cvt_pk_bf16_f32 v73, v74, v75
    v_cvt_pk_bf16_f32 v74, v76, v77
    v_mfma_f32_16x16x32_bf16 v[48:51], a[160:163], v[212:215], v[48:51]
    v_cvt_pk_bf16_f32 v75, v78, v79
    v_cvt_pk_bf16_f32 v104, v104, v105
    v_exp_f32 v141, v141
    v_mfma_f32_16x16x32_bf16 v[52:55], a[164:167], v[212:215], v[52:55]
    v_cvt_pk_bf16_f32 v105, v106, v107
    v_cvt_pk_bf16_f32 v106, v108, v109
    v_mfma_f32_16x16x32_bf16 v[80:83], a[160:163], v[216:219], v[80:83]
    v_cvt_pk_bf16_f32 v107, v110, v111
    v_cvt_pk_bf16_f32 v198, v140, v141
    v_exp_f32 v142, v142
    v_mfma_f32_16x16x32_bf16 v[84:87], a[164:167], v[216:219], v[84:87]
    v_exp_f32 v143, v143
    v_mfma_f32_16x16x32_bf16 v[112:115], a[160:163], v[220:223], v[112:115]
    s_waitcnt vmcnt(24) lgkmcnt(0)
    s_barrier
    ds_read_b128 a[192:195], v250 offset:0
    ds_read_b64 a[198:199], v250 offset:1024
    ds_read_b64 a[196:197], v250 offset:1032
    ds_write_b64 v248, v[32:33] offset:2048
    v_cvt_pk_bf16_f32 v199, v142, v143
    v_mfma_f32_16x16x32_bf16 v[116:119], a[164:167], v[220:223], v[116:119]
    v_exp_f32 v148, v148
    v_mfma_f32_16x16x32_bf16 v[180:183], a[144:147], a[96:99], 0
    ds_read_b128 a[128:131], v232 offset:33792
    ds_write_b64 v249, v[34:35] offset:2048
    v_accvgpr_write_b32 a176, 0
    v_mfma_f32_16x16x32_bf16 v[180:183], a[148:151], a[100:103], v[180:183]
    ds_read_b128 a[132:135], v232 offset:33856
    ds_read_b128 a[136:139], v232 offset:33920
    v_mfma_f32_16x16x32_bf16 v[180:183], a[152:155], a[40:43], v[180:183]
    ds_write_b64 v244, v[40:41] offset:2048
    v_accvgpr_write_b32 a177, 0
    v_exp_f32 v149, v149
    v_mfma_f32_16x16x32_bf16 v[180:183], a[156:159], a[44:47], v[180:183]
    ds_read_b128 a[140:143], v232 offset:33984
    v_cvt_pk_bf16_f32 v202, v148, v149
    v_mfma_f32_16x16x32_bf16 v[188:191], a[144:147], a[48:51], 0
    ds_read_b64_tr_b16 a[160:161], v234 offset:33792
    ds_write_b64 v245, v[42:43] offset:2048
    v_pk_mul_f32 v[16:17], v[16:17], v[228:229] op_sel_hi:[1,0]
    v_pk_mul_f32 v[18:19], v[18:19], v[228:229] op_sel_hi:[1,0]
    v_pk_mul_f32 v[20:21], v[20:21], v[228:229] op_sel_hi:[1,0]
    v_pk_mul_f32 v[22:23], v[22:23], v[228:229] op_sel_hi:[1,0]
    v_pk_mul_f32 v[48:49], v[48:49], v[228:229] op_sel:[0,1] op_sel_hi:[1,1]
    v_pk_mul_f32 v[50:51], v[50:51], v[228:229] op_sel:[0,1] op_sel_hi:[1,1]
    v_pk_mul_f32 v[52:53], v[52:53], v[228:229] op_sel:[0,1] op_sel_hi:[1,1]
    v_pk_mul_f32 v[54:55], v[54:55], v[228:229] op_sel:[0,1] op_sel_hi:[1,1]
    v_pk_mul_f32 v[80:81], v[80:81], v[230:231] op_sel_hi:[1,0]
    v_pk_mul_f32 v[82:83], v[82:83], v[230:231] op_sel_hi:[1,0]
    v_pk_mul_f32 v[84:85], v[84:85], v[230:231] op_sel_hi:[1,0]
    v_pk_mul_f32 v[86:87], v[86:87], v[230:231] op_sel_hi:[1,0]
    v_pk_mul_f32 v[112:113], v[112:113], v[230:231] op_sel:[0,1] op_sel_hi:[1,1]
    v_pk_mul_f32 v[114:115], v[114:115], v[230:231] op_sel:[0,1] op_sel_hi:[1,1]
    v_pk_mul_f32 v[116:117], v[116:117], v[230:231] op_sel:[0,1] op_sel_hi:[1,1]
    v_pk_mul_f32 v[118:119], v[118:119], v[230:231] op_sel:[0,1] op_sel_hi:[1,1]
    v_exp_f32 v150, v150
    v_mfma_f32_16x16x32_bf16 v[188:191], a[148:151], a[52:55], v[188:191]
    ds_read_b128 a[208:211], v250 offset:2048
    ds_read_b64 a[214:215], v250 offset:3072
    v_mfma_f32_16x16x32_bf16 v[188:191], a[152:155], a[56:59], v[188:191]
    ds_write_b64 v248, v[64:65] offset:4096
    v_cvt_pk_bf16_f32 v16, v16, v17
    v_exp_f32 v151, v151
    v_mfma_f32_16x16x32_bf16 v[188:191], a[156:159], a[60:63], v[188:191]
    ds_read_b64 a[212:213], v250 offset:3080
    v_cvt_pk_bf16_f32 v203, v150, v151
    v_mfma_f32_16x16x32_bf16 v[24:27], a[168:171], v[208:211], v[24:27]
    ds_write_b64 v249, v[66:67] offset:4096
    v_cvt_pk_bf16_f32 v17, v18, v19
    v_exp_f32 v156, v156
    v_accvgpr_write_b32 a178, 0
    v_cvt_pk_bf16_f32 v18, v20, v21
    v_mfma_f32_16x16x32_bf16 v[28:31], a[172:175], v[208:211], v[28:31]
    ds_read_b64_tr_b16 a[162:163], v234 offset:34048
    v_cvt_pk_bf16_f32 v19, v22, v23
    v_accvgpr_write_b32 a179, 0
    v_cvt_pk_bf16_f32 v48, v48, v49
    v_mfma_f32_16x16x32_bf16 v[56:59], a[168:171], v[212:215], v[56:59]
    ds_write_b64 v244, v[72:73] offset:4096
    v_exp_f32 v157, v157
    v_cvt_pk_bf16_f32 v49, v50, v51
    v_accvgpr_write_b32 a180, 0
    v_mfma_f32_16x16x32_bf16 v[60:63], a[172:175], v[212:215], v[60:63]
    ds_read_b64_tr_b16 a[164:165], v234 offset:33824
    v_cvt_pk_bf16_f32 v50, v52, v53
    v_accvgpr_write_b32 a181, 0
    v_cvt_pk_bf16_f32 v51, v54, v55
    v_mfma_f32_16x16x32_bf16 v[88:91], a[168:171], v[216:219], v[88:91]
    ds_write_b64 v245, v[74:75] offset:4096
    v_cvt_pk_bf16_f32 v206, v156, v157
    v_cvt_pk_bf16_f32 v80, v80, v81
    v_exp_f32 v158, v158
    v_accvgpr_write_b32 a182, 0
    v_cvt_pk_bf16_f32 v81, v82, v83
    v_mfma_f32_16x16x32_bf16 v[92:95], a[172:175], v[216:219], v[92:95]
    ds_read_b64_tr_b16 a[166:167], v234 offset:34080
    v_cvt_pk_bf16_f32 v82, v84, v85
    v_accvgpr_write_b32 a183, 0
    v_cvt_pk_bf16_f32 v83, v86, v87
    v_mfma_f32_16x16x32_bf16 v[120:123], a[168:171], v[220:223], v[120:123]
L_pad6:
    s_cbranch_execz L_walk_ret
    ds_read_b128 a[224:227], v250 offset:4096
    v_exp_f32 v159, v159
    v_cvt_pk_bf16_f32 v112, v112, v113
    v_cvt_pk_bf16_f32 v113, v114, v115
    v_mfma_f32_16x16x32_bf16 v[124:127], a[172:175], v[220:223], v[124:127]
    s_waitcnt lgkmcnt(13)
    ds_read_b64 a[230:231], v250 offset:5120
    ds_read_b64 a[228:229], v250 offset:5128
    v_cvt_pk_bf16_f32 v114, v116, v117
    v_cvt_pk_bf16_f32 v207, v158, v159
    v_cvt_pk_bf16_f32 v115, v118, v119
    v_mfma_f32_16x16x32_bf16 v[128:131], a[128:131], a[0:3], 0
    ds_read_b128 a[144:147], v232 offset:34048
    ds_write_b64 v248, v[96:97] offset:0
    v_pk_fma_f32 v[160:161], v[160:161], s[64:65], v[224:225] op_sel_hi:[1,1,0]
    v_pk_fma_f32 v[162:163], v[162:163], s[64:65], v[224:225] op_sel_hi:[1,1,0]
    v_pk_fma_f32 v[168:169], v[168:169], s[64:65], v[224:225] op_sel:[0,0,1] op_sel_hi:[1,1,1]
    v_pk_fma_f32 v[170:171], v[170:171], s[64:65], v[224:225] op_sel:[0,0,1] op_sel_hi:[1,1,1]
    v_pk_fma_f32 v[176:177], v[176:177], s[64:65], v[226:227] op_sel_hi:[1,1,0]
    v_pk_fma_f32 v[178:179], v[178:179], s[64:65], v[226:227] op_sel_hi:[1,1,0]
    v_pk_fma_f32 v[184:185], v[184:185], s[64:65], v[226:227] op_sel:[0,0,1] op_sel_hi:[1,1,1]
    v_pk_fma_f32 v[186:187], v[186:187], s[64:65], v[226:227] op_sel:[0,0,1] op_sel_hi:[1,1,1]
    s_nop 0
    v_mfma_f32_16x16x32_bf16 v[128:131], a[132:135], a[4:7], v[128:131]
    ds_read_b128 a[148:151], v232 offset:34112
    ds_read_b128 a[152:155], v232 offset:34176
    v_exp_f32 v160, v160
    v_pk_mul_f32 v[24:25], v[24:25], v[228:229] op_sel_hi:[1,0]
    v_pk_mul_f32 v[26:27], v[26:27], v[228:229] op_sel_hi:[1,0]
    v_pk_mul_f32 v[28:29], v[28:29], v[228:229] op_sel_hi:[1,0]
    v_pk_mul_f32 v[30:31], v[30:31], v[228:229] op_sel_hi:[1,0]
    v_pk_mul_f32 v[56:57], v[56:57], v[228:229] op_sel:[0,1] op_sel_hi:[1,1]
    v_pk_mul_f32 v[58:59], v[58:59], v[228:229] op_sel:[0,1] op_sel_hi:[1,1]
    v_pk_mul_f32 v[60:61], v[60:61], v[228:229] op_sel:[0,1] op_sel_hi:[1,1]
    v_pk_mul_f32 v[62:63], v[62:63], v[228:229] op_sel:[0,1] op_sel_hi:[1,1]
    v_pk_mul_f32 v[88:89], v[88:89], v[230:231] op_sel_hi:[1,0]
    v_pk_mul_f32 v[90:91], v[90:91], v[230:231] op_sel_hi:[1,0]
    v_pk_mul_f32 v[92:93], v[92:93], v[230:231] op_sel_hi:[1,0]
    v_pk_mul_f32 v[94:95], v[94:95], v[230:231] op_sel_hi:[1,0]
    v_pk_mul_f32 v[120:121], v[120:121], v[230:231] op_sel:[0,1] op_sel_hi:[1,1]
    v_pk_mul_f32 v[122:123], v[122:123], v[230:231] op_sel:[0,1] op_sel_hi:[1,1]
    v_pk_mul_f32 v[124:125], v[124:125], v[230:231] op_sel:[0,1] op_sel_hi:[1,1]
    v_pk_mul_f32 v[126:127], v[126:127], v[230:231] op_sel:[0,1] op_sel_hi:[1,1]
    v_exp_f32 v161, v161
    v_mfma_f32_16x16x32_bf16 v[128:131], a[136:139], a[8:11], v[128:131]
    v_cvt_pk_bf16_f32 v24, v24, v25
    v_cvt_pk_bf16_f32 v25, v26, v27
    v_mfma_f32_16x16x32_bf16 v[128:131], a[140:143], a[12:15], v[128:131]
    v_cvt_pk_bf16_f32 v26, v28, v29
    v_cvt_pk_bf16_f32 v27, v30, v31
    v_mfma_f32_16x16x32_bf16 v[136:139], a[128:131], a[16:19], 0
    s_add_u32 s40, s30, 65536
    ds_write_b64 v249, v[98:99] offset:0
    v_cvt_pk_bf16_f32 v56, v56, v57
    v_mfma_f32_16x16x32_bf16 v[136:139], a[132:135], a[20:23], v[136:139]
    s_add_u32 m0, s60, 0
    ds_read_b128 a[156:159], v232 offset:34240
    v_cvt_pk_bf16_f32 v57, v58, v59
    v_mfma_f32_16x16x32_bf16 v[136:139], a[136:139], a[24:27], v[136:139]
    buffer_load_dwordx4 v236, s[4:7], s40 offen offset:0 nt lds
    v_mfma_f32_16x16x32_bf16 v[136:139], a[140:143], a[28:31], v[136:139]
    v_cvt_pk_bf16_f32 v58, v60, v61
    v_cvt_pk_bf16_f32 v59, v62, v63
    v_cvt_pk_bf16_f32 v208, v160, v161
    v_mfma_f32_16x16x32_bf16 v[144:147], a[128:131], a[32:35], 0
    ds_write_b64 v244, v[104:105] offset:0
    v_exp_f32 v162, v162
    v_cvt_pk_bf16_f32 v88, v88, v89
    v_cvt_pk_bf16_f32 v89, v90, v91
    v_mfma_f32_16x16x32_bf16 v[144:147], a[132:135], a[36:39], v[144:147]
    v_cvt_pk_bf16_f32 v90, v92, v93
    v_cvt_pk_bf16_f32 v91, v94, v95
    v_mfma_f32_16x16x32_bf16 v[144:147], a[136:139], a[40:43], v[144:147]
    ds_write_b64 v245, v[106:107] offset:0
    v_exp_f32 v163, v163
    v_cvt_pk_bf16_f32 v120, v120, v121
    v_cvt_pk_bf16_f32 v121, v122, v123
    v_mfma_f32_16x16x32_bf16 v[144:147], a[140:143], a[44:47], v[144:147]
    s_add_u32 m0, s60, 800
    v_cvt_pk_bf16_f32 v122, v124, v125
    v_cvt_pk_bf16_f32 v209, v162, v163
    v_cvt_pk_bf16_f32 v123, v126, v127
    v_mfma_f32_16x16x32_bf16 v[152:155], a[128:131], a[48:51], 0
    buffer_load_dwordx4 v236, s[4:7], s40 offen offset:256 nt lds
    ds_read_b128 a[240:243], v250 offset:0
    v_exp_f32 v168, v168
    v_mfma_f32_16x16x32_bf16 v[152:155], a[132:135], a[52:55], v[152:155]
    ds_read_b64 a[246:247], v250 offset:1024
    ds_write_b64 v248, v[16:17] offset:2048
    v_mfma_f32_16x16x32_bf16 v[152:155], a[136:139], a[56:59], v[152:155]
    v_exp_f32 v169, v169
    v_mfma_f32_16x16x32_bf16 v[152:155], a[140:143], a[60:63], v[152:155]
    s_waitcnt lgkmcnt(5)
    ds_read_b64 a[244:245], v250 offset:1032
    ds_write_b64 v249, v[18:19] offset:2048
    v_cvt_pk_bf16_f32 v212, v168, v169
    v_mfma_f32_16x16x32_bf16 v[132:135], a[144:147], a[0:3], 0
    v_exp_f32 v170, v170
    v_mfma_f32_16x16x32_bf16 v[132:135], a[148:151], a[4:7], v[132:135]
    v_exp_f32 v171, v171
    v_mfma_f32_16x16x32_bf16 v[132:135], a[152:155], a[8:11], v[132:135]
    ds_write_b64 v244, v[24:25] offset:2048
    v_cvt_pk_bf16_f32 v213, v170, v171
    v_mfma_f32_16x16x32_bf16 v[132:135], a[156:159], a[12:15], v[132:135]
    s_add_u32 m0, s60, 1600
    v_exp_f32 v176, v176
    v_mfma_f32_16x16x32_bf16 v[140:143], a[144:147], a[16:19], 0
    buffer_load_dwordx4 v236, s[4:7], s40 offen offset:512 nt lds
    v_mfma_f32_16x16x32_bf16 v[140:143], a[148:151], a[20:23], v[140:143]
    ds_write_b64 v245, v[26:27] offset:2048
    v_mfma_f32_16x16x32_bf16 v[140:143], a[152:155], a[24:27], v[140:143]
    ds_read_b128 a[200:203], v250 offset:2048
    ds_read_b64_tr_b16 a[168:169], v234 offset:33856
    v_exp_f32 v177, v177
    v_mfma_f32_16x16x32_bf16 v[140:143], a[156:159], a[28:31], v[140:143]
    ds_write_b64 v248, v[48:49] offset:4096
    v_cvt_pk_bf16_f32 v216, v176, v177
    v_mfma_f32_16x16x32_bf16 v[148:151], a[144:147], a[32:35], 0
    ds_read_b64 a[206:207], v250 offset:3072
    v_exp_f32 v178, v178
    v_mfma_f32_16x16x32_bf16 v[148:151], a[148:151], a[36:39], v[148:151]
    ds_read_b64_tr_b16 a[170:171], v234 offset:34112
    ds_read_b64 a[204:205], v250 offset:3080
    v_mfma_f32_16x16x32_bf16 v[148:151], a[152:155], a[40:43], v[148:151]
    ds_write_b64 v249, v[50:51] offset:4096
    v_exp_f32 v179, v179
    v_mfma_f32_16x16x32_bf16 v[148:151], a[156:159], a[44:47], v[148:151]
    ds_read_b64_tr_b16 a[172:173], v234 offset:33888
    v_cvt_pk_bf16_f32 v217, v178, v179
    v_mfma_f32_16x16x32_bf16 v[156:159], a[144:147], a[48:51], 0
    ds_write_b64 v244, v[56:57] offset:4096
    v_exp_f32 v184, v184
    v_mfma_f32_16x16x32_bf16 v[156:159], a[148:151], a[52:55], v[156:159]
    buffer_store_dwordx4 a[192:195], v238, s[20:23], s52 offen offset:0 sc0 sc1
    v_mfma_f32_16x16x32_bf16 v[156:159], a[152:155], a[56:59], v[156:159]
    v_exp_f32 v185, v185
    v_mfma_f32_16x16x32_bf16 v[156:159], a[156:159], a[60:63], v[156:159]
    ds_read_b64_tr_b16 a[174:175], v234 offset:34144
    ds_write_b64 v245, v[58:59] offset:4096
    v_pk_fma_f32 v[164:165], v[164:165], s[64:65], v[224:225] op_sel_hi:[1,1,0]
    v_pk_fma_f32 v[166:167], v[166:167], s[64:65], v[224:225] op_sel_hi:[1,1,0]
    v_pk_fma_f32 v[172:173], v[172:173], s[64:65], v[224:225] op_sel:[0,0,1] op_sel_hi:[1,1,1]
    v_pk_fma_f32 v[174:175], v[174:175], s[64:65], v[224:225] op_sel:[0,0,1] op_sel_hi:[1,1,1]
    v_pk_fma_f32 v[180:181], v[180:181], s[64:65], v[226:227] op_sel_hi:[1,1,0]
    v_pk_fma_f32 v[182:183], v[182:183], s[64:65], v[226:227] op_sel_hi:[1,1,0]
    v_pk_fma_f32 v[188:189], v[188:189], s[64:65], v[226:227] op_sel:[0,0,1] op_sel_hi:[1,1,1]
    v_pk_fma_f32 v[190:191], v[190:191], s[64:65], v[226:227] op_sel:[0,0,1] op_sel_hi:[1,1,1]
    v_cvt_pk_bf16_f32 v220, v184, v185
    v_smfmac_f32_16x16x64_bf16 a[176:179], a[184:187], v[192:199], v251
    ds_read_b128 a[216:219], v250 offset:4096
    ds_read_b64 a[222:223], v250 offset:5120
    v_exp_f32 v186, v186
    v_smfmac_f32_16x16x64_bf16 a[180:183], a[184:187], v[200:207], v251
    ds_read_b64 a[220:221], v250 offset:5128
    ds_write_b64 v248, v[80:81] offset:0
    v_mfma_f32_16x16x32_bf16 v[0:3], a[160:163], v[192:195], 0
    v_exp_f32 v187, v187
    v_mfma_f32_16x16x32_bf16 v[4:7], a[164:167], v[192:195], 0
    s_add_u32 m0, s60, 2400
    v_exp_f32 v164, v164
    v_cvt_pk_bf16_f32 v221, v186, v187
    v_mfma_f32_16x16x32_bf16 v[32:35], a[160:163], v[196:199], 0
    buffer_load_dwordx4 v236, s[4:7], s40 offen offset:768 nt lds
    ds_write_b64 v249, v[82:83] offset:0
    v_mfma_f32_16x16x32_bf16 v[36:39], a[164:167], v[196:199], 0
    v_exp_f32 v165, v165
    v_mfma_f32_16x16x32_bf16 v[64:67], a[160:163], v[200:203], 0
    ds_write_b64 v244, v[88:89] offset:0
    v_cvt_pk_bf16_f32 v210, v164, v165
    v_mfma_f32_16x16x32_bf16 v[68:71], a[164:167], v[200:203], 0
    v_exp_f32 v166, v166
    v_mfma_f32_16x16x32_bf16 v[96:99], a[160:163], v[204:207], 0
    ds_write_b64 v245, v[90:91] offset:0
    v_mfma_f32_16x16x32_bf16 v[100:103], a[164:167], v[204:207], 0
    s_waitcnt lgkmcnt(8)
    ds_read_b64_tr_b16 a[160:161], v234 offset:33920
    ds_read_b64_tr_b16 a[162:163], v234 offset:34176
    v_mfma_f32_16x16x32_bf16 v[8:11], a[168:171], v[192:195], 0
    ds_read_b128 a[232:235], v250 offset:0
    v_exp_f32 v167, v167
    v_mfma_f32_16x16x32_bf16 v[12:15], a[172:175], v[192:195], 0
    ds_read_b64_tr_b16 a[164:165], v234 offset:33952
    ds_read_b64_tr_b16 a[166:167], v234 offset:34208
    v_cvt_pk_bf16_f32 v211, v166, v167
    v_mfma_f32_16x16x32_bf16 v[40:43], a[168:171], v[196:199], 0
    ds_read_b64 a[238:239], v250 offset:1024
    ds_write_b64 v248, v[112:113] offset:2048
    v_exp_f32 v172, v172
    v_mfma_f32_16x16x32_bf16 v[44:47], a[172:175], v[196:199], 0
    buffer_store_dwordx4 a[196:199], v238, s[20:23], s52 offen offset:2048 sc0 sc1
    v_mfma_f32_16x16x32_bf16 v[72:75], a[168:171], v[200:203], 0
    ds_read_b128 a[128:131], v232 offset:34304
    ds_read_b64 a[236:237], v250 offset:1032
    ds_write_b64 v249, v[114:115] offset:2048
    v_exp_f32 v173, v173
    v_mfma_f32_16x16x32_bf16 v[76:79], a[172:175], v[200:203], 0
    ds_read_b128 a[132:135], v232 offset:34368
    v_cvt_pk_bf16_f32 v214, v172, v173
    v_mfma_f32_16x16x32_bf16 v[104:107], a[168:171], v[204:207], 0
    v_exp_f32 v174, v174
    v_mfma_f32_16x16x32_bf16 v[108:111], a[172:175], v[204:207], 0
    s_waitcnt lgkmcnt(6)
    ds_write_b64 v244, v[120:121] offset:2048
    v_mfma_f32_16x16x32_bf16 v[16:19], a[160:163], v[192:195], 0
    s_add_u32 s41, s30, 49152
    ds_read_b64_tr_b16 a[168:169], v234 offset:33984
    ds_read_b64_tr_b16 a[170:171], v234 offset:34240
    v_exp_f32 v175, v175
    v_mfma_f32_16x16x32_bf16 v[20:23], a[164:167], v[192:195], 0
    s_add_u32 m0, s60, 16896
    ds_read_b64_tr_b16 a[172:173], v234 offset:34016
    ds_read_b64_tr_b16 a[174:175], v234 offset:34272
    ds_write_b64 v245, v[122:123] offset:2048
    v_cvt_pk_bf16_f32 v215, v174, v175
    v_mfma_f32_16x16x32_bf16 v[48:51], a[160:163], v[196:199], 0
    buffer_load_dwordx4 v236, s[8:11], s41 offen offset:0 nt lds
    ds_read_b128 a[136:139], v232 offset:34432
    v_exp_f32 v180, v180
    v_mfma_f32_16x16x32_bf16 v[52:55], a[164:167], v[196:199], 0
    ds_read_b128 a[248:251], v250 offset:2048
    ds_read_b64 a[254:255], v250 offset:3072
    v_mfma_f32_16x16x32_bf16 v[80:83], a[160:163], v[200:203], 0
    v_exp_f32 v181, v181
    v_mfma_f32_16x16x32_bf16 v[84:87], a[164:167], v[200:203], 0
    ds_read_b128 a[140:143], v232 offset:34496
    v_cvt_pk_bf16_f32 v218, v180, v181
    v_mfma_f32_16x16x32_bf16 v[112:115], a[160:163], v[204:207], 0
    ds_read_b64 a[252:253], v250 offset:3080
    v_exp_f32 v182, v182
    v_mfma_f32_16x16x32_bf16 v[116:119], a[164:167], v[204:207], 0
    s_waitcnt lgkmcnt(6)
    ds_read_b64_tr_b16 a[160:161], v234 offset:34304
    ds_read_b64_tr_b16 a[162:163], v234 offset:34560
    v_mfma_f32_16x16x32_bf16 v[24:27], a[168:171], v[192:195], 0
    v_exp_f32 v183, v183
    v_mfma_f32_16x16x32_bf16 v[28:31], a[172:175], v[192:195], 0
    s_add_u32 m0, s60, 17696
    ds_read_b64_tr_b16 a[164:165], v234 offset:34336
    v_cvt_pk_bf16_f32 v219, v182, v183
    v_mfma_f32_16x16x32_bf16 v[56:59], a[168:171], v[196:199], 0
    buffer_load_dwordx4 v236, s[8:11], s41 offen offset:256 nt lds
    v_exp_f32 v188, v188
    v_mfma_f32_16x16x32_bf16 v[60:63], a[172:175], v[196:199], 0
    v_exp_f32 v189, v189
    v_mfma_f32_16x16x32_bf16 v[88:91], a[168:171], v[200:203], 0
    ds_read_b64_tr_b16 a[166:167], v234 offset:34592
    v_cvt_pk_bf16_f32 v222, v188, v189
    v_mfma_f32_16x16x32_bf16 v[92:95], a[172:175], v[200:203], 0
    v_exp_f32 v190, v190
    v_mfma_f32_16x16x32_bf16 v[120:123], a[168:171], v[204:207], 0
    v_exp_f32 v191, v191
    v_mfma_f32_16x16x32_bf16 v[124:127], a[172:175], v[204:207], 0
    s_waitcnt lgkmcnt(5)
    ds_read_b64_tr_b16 a[168:169], v234 offset:34368
    v_fma_f32 v132, v132, s28, v224
    v_cvt_pk_bf16_f32 v223, v190, v191
    v_fma_f32 v133, v133, s28, v224
    v_pk_fma_f32 v[128:129], v[128:129], s[64:65], v[224:225] op_sel_hi:[1,1,0]
    v_pk_fma_f32 v[130:131], v[130:131], s[64:65], v[224:225] op_sel_hi:[1,1,0]
    v_pk_fma_f32 v[136:137], v[136:137], s[64:65], v[224:225] op_sel:[0,0,1] op_sel_hi:[1,1,1]
    v_pk_fma_f32 v[138:139], v[138:139], s[64:65], v[224:225] op_sel:[0,0,1] op_sel_hi:[1,1,1]
    v_pk_fma_f32 v[144:145], v[144:145], s[64:65], v[226:227] op_sel_hi:[1,1,0]
    v_pk_fma_f32 v[146:147], v[146:147], s[64:65], v[226:227] op_sel_hi:[1,1,0]
    v_pk_fma_f32 v[152:153], v[152:153], s[64:65], v[226:227] op_sel:[0,0,1] op_sel_hi:[1,1,1]
    v_pk_fma_f32 v[154:155], v[154:155], s[64:65], v[226:227] op_sel:[0,0,1] op_sel_hi:[1,1,1]
    s_nop 0
    v_mfma_f32_16x16x32_bf16 v[160:163], a[128:131], a[0:3], 0
    v_exp_f32 v128, v128
    v_mfma_f32_16x16x32_bf16 v[160:163], a[132:135], a[4:7], v[160:163]
    v_exp_f32 v129, v129
    v_mfma_f32_16x16x32_bf16 v[160:163], a[136:139], a[8:11], v[160:163]
    buffer_store_dwordx4 a[208:211], v238, s[20:23], s53 offen offset:0 sc0 sc1
    v_mfma_f32_16x16x32_bf16 v[160:163], a[140:143], a[12:15], v[160:163]
    v_cvt_pk_bf16_f32 v192, v128, v129
    v_fma_f32 v134, v134, s28, v224
    v_mfma_f32_16x16x32_bf16 v[168:171], a[128:131], a[16:19], 0
    v_exp_f32 v130, v130
    v_mfma_f32_16x16x32_bf16 v[168:171], a[132:135], a[20:23], v[168:171]
    v_exp_f32 v131, v131
    v_mfma_f32_16x16x32_bf16 v[168:171], a[136:139], a[24:27], v[168:171]
    ds_read_b64_tr_b16 a[170:171], v234 offset:34624
    v_cvt_pk_bf16_f32 v193, v130, v131
    v_mfma_f32_16x16x32_bf16 v[168:171], a[140:143], a[28:31], v[168:171]
    v_exp_f32 v136, v136
    v_smfmac_f32_16x16x64_bf16 a[176:179], a[184:187], v[208:215], v251
    ds_read_b64_tr_b16 a[172:173], v234 offset:34400
    v_fma_f32 v135, v135, s28, v224
    v_smfmac_f32_16x16x64_bf16 a[180:183], a[184:187], v[216:223], v251
    s_waitcnt lgkmcnt(3)
    ds_read_b128 a[144:147], v232 offset:34560
    ds_read_b64_tr_b16 a[174:175], v234 offset:34656
    v_mfma_f32_16x16x32_bf16 v[0:3], a[160:163], v[208:211], v[0:3]
    s_add_u32 m0, s60, 18496
    v_exp_f32 v137, v137
    v_mfma_f32_16x16x32_bf16 v[4:7], a[164:167], v[208:211], v[4:7]
    buffer_load_dwordx4 v236, s[8:11], s41 offen offset:512 nt lds
    v_mfma_f32_16x16x32_bf16 v[32:35], a[160:163], v[212:215], v[32:35]
    v_cvt_pk_bf16_f32 v196, v136, v137
    v_fma_f32 v140, v140, s28, v225
    v_mfma_f32_16x16x32_bf16 v[36:39], a[164:167], v[212:215], v[36:39]
    v_exp_f32 v138, v138
    v_mfma_f32_16x16x32_bf16 v[64:67], a[160:163], v[216:219], v[64:67]
    v_exp_f32 v139, v139
    v_mfma_f32_16x16x32_bf16 v[68:71], a[164:167], v[216:219], v[68:71]
    ds_read_b128 a[148:151], v232 offset:34624
    v_cvt_pk_bf16_f32 v197, v138, v139
    v_mfma_f32_16x16x32_bf16 v[96:99], a[160:163], v[220:223], v[96:99]
    v_exp_f32 v144, v144
    v_mfma_f32_16x16x32_bf16 v[100:103], a[164:167], v[220:223], v[100:103]
    ds_read_b128 a[152:155], v232 offset:34688
    v_fma_f32 v141, v141, s28, v225
    v_mfma_f32_16x16x32_bf16 v[176:179], a[128:131], a[32:35], 0
    v_exp_f32 v145, v145
    v_mfma_f32_16x16x32_bf16 v[176:179], a[132:135], a[36:39], v[176:179]
    buffer_store_dwordx4 a[212:215], v238, s[20:23], s53 offen offset:2048 sc0 sc1
    v_mfma_f32_16x16x32_bf16 v[176:179], a[136:139], a[40:43], v[176:179]
    ds_read_b64_tr_b16 a[160:161], v234 offset:34432
    v_cvt_pk_bf16_f32 v200, v144, v145
    v_mfma_f32_16x16x32_bf16 v[176:179], a[140:143], a[44:47], v[176:179]
    v_exp_f32 v146, v146
    v_mfma_f32_16x16x32_bf16 v[184:187], a[128:131], a[48:51], 0
    ds_read_b128 a[156:159], v232 offset:34752
    v_fma_f32 v142, v142, s28, v225
    v_mfma_f32_16x16x32_bf16 v[184:187], a[132:135], a[52:55], v[184:187]
    v_exp_f32 v147, v147
    v_mfma_f32_16x16x32_bf16 v[184:187], a[136:139], a[56:59], v[184:187]
    ds_read_b64_tr_b16 a[162:163], v234 offset:34688
    v_cvt_pk_bf16_f32 v201, v146, v147
    v_mfma_f32_16x16x32_bf16 v[184:187], a[140:143], a[60:63], v[184:187]
    s_waitcnt lgkmcnt(5)
    v_exp_f32 v152, v152
    v_mfma_f32_16x16x32_bf16 v[8:11], a[168:171], v[208:211], v[8:11]
    s_add_u32 m0, s60, 19296
    ds_read_b64_tr_b16 a[164:165], v234 offset:34464
    v_fma_f32 v143, v143, s28, v225
    v_mfma_f32_16x16x32_bf16 v[12:15], a[172:175], v[208:211], v[12:15]
    buffer_load_dwordx4 v236, s[8:11], s41 offen offset:768 nt lds
    v_mfma_f32_16x16x32_bf16 v[40:43], a[168:171], v[212:215], v[40:43]
    v_exp_f32 v153, v153
    v_mfma_f32_16x16x32_bf16 v[44:47], a[172:175], v[212:215], v[44:47]
    s_mov_b32 s78, 0
    ds_read_b64_tr_b16 a[166:167], v234 offset:34720
    v_cvt_pk_bf16_f32 v204, v152, v153
    v_mfma_f32_16x16x32_bf16 v[72:75], a[168:171], v[216:219], v[72:75]
    v_exp_f32 v154, v154
    v_mfma_f32_16x16x32_bf16 v[76:79], a[172:175], v[216:219], v[76:79]
    v_exp_f32 v155, v155
    v_mfma_f32_16x16x32_bf16 v[104:107], a[168:171], v[220:223], v[104:107]
    v_fma_f32 v148, v148, s28, v226
    v_cvt_pk_bf16_f32 v205, v154, v155
    v_mfma_f32_16x16x32_bf16 v[108:111], a[172:175], v[220:223], v[108:111]
    s_waitcnt lgkmcnt(3)
    v_exp_f32 v132, v132
    v_mfma_f32_16x16x32_bf16 v[164:167], a[144:147], a[0:3], 0
    v_exp_f32 v133, v133
    v_mfma_f32_16x16x32_bf16 v[164:167], a[148:151], a[4:7], v[164:167]
    v_fma_f32 v149, v149, s28, v226
    v_cvt_pk_bf16_f32 v194, v132, v133
    v_mfma_f32_16x16x32_bf16 v[164:167], a[152:155], a[8:11], v[164:167]
    ds_read_b64_tr_b16 a[168:169], v234 offset:34496
    v_fma_f32 v150, v150, s28, v226
    v_mfma_f32_16x16x32_bf16 v[164:167], a[156:159], a[12:15], v[164:167]
    v_exp_f32 v134, v134
    v_mfma_f32_16x16x32_bf16 v[172:175], a[144:147], a[16:19], 0
    v_exp_f32 v135, v135
    v_mfma_f32_16x16x32_bf16 v[172:175], a[148:151], a[20:23], v[172:175]
    ds_read_b64_tr_b16 a[170:171], v234 offset:34752
    v_cvt_pk_bf16_f32 v195, v134, v135
    v_mfma_f32_16x16x32_bf16 v[172:175], a[152:155], a[24:27], v[172:175]
    v_exp_f32 v140, v140
    v_mfma_f32_16x16x32_bf16 v[172:175], a[156:159], a[28:31], v[172:175]
    s_waitcnt lgkmcnt(2)
    ds_read_b64_tr_b16 a[172:173], v234 offset:34528
    ds_read_b64_tr_b16 a[174:175], v234 offset:34784
    v_mfma_f32_16x16x32_bf16 v[16:19], a[160:163], v[208:211], v[16:19]
    v_exp_f32 v141, v141
    v_mfma_f32_16x16x32_bf16 v[20:23], a[164:167], v[208:211], v[20:23]
    v_fma_f32 v151, v151, s28, v226
    v_cvt_pk_bf16_f32 v198, v140, v141
    v_mfma_f32_16x16x32_bf16 v[48:51], a[160:163], v[212:215], v[48:51]
    v_exp_f32 v142, v142
    v_mfma_f32_16x16x32_bf16 v[52:55], a[164:167], v[212:215], v[52:55]
    v_exp_f32 v143, v143
    v_mfma_f32_16x16x32_bf16 v[80:83], a[160:163], v[216:219], v[80:83]
    v_fma_f32 v156, v156, s28, v227
    v_cvt_pk_bf16_f32 v199, v142, v143
    v_mfma_f32_16x16x32_bf16 v[84:87], a[164:167], v[216:219], v[84:87]
    v_exp_f32 v148, v148
    v_mfma_f32_16x16x32_bf16 v[112:115], a[160:163], v[220:223], v[112:115]
    s_waitcnt vmcnt(22) lgkmcnt(0)
    s_barrier
    ds_read_b128 a[128:131], v233 offset:0
    ds_read_b128 a[132:135], v233 offset:64
    v_mfma_f32_16x16x32_bf16 v[116:119], a[164:167], v[220:223], v[116:119]
    v_exp_f32 v149, v149
    v_mfma_f32_16x16x32_bf16 v[180:183], a[144:147], a[32:35], 0
    v_fma_f32 v157, v157, s28, v227
    v_cvt_pk_bf16_f32 v202, v148, v149
    v_mfma_f32_16x16x32_bf16 v[180:183], a[148:151], a[36:39], v[180:183]
    ds_read_b128 a[136:139], v233 offset:128
    ds_read_b128 a[140:143], v233 offset:192
    v_mfma_f32_16x16x32_bf16 v[180:183], a[152:155], a[40:43], v[180:183]
    v_exp_f32 v150, v150
    v_mfma_f32_16x16x32_bf16 v[180:183], a[156:159], a[44:47], v[180:183]
    v_exp_f32 v151, v151
    v_mfma_f32_16x16x32_bf16 v[188:191], a[144:147], a[48:51], 0
    ds_read_b64_tr_b16 a[160:161], v235 offset:0
    v_fma_f32 v158, v158, s28, v227
    v_mfma_f32_16x16x32_bf16 v[188:191], a[148:151], a[52:55], v[188:191]
    ds_read_b64_tr_b16 a[162:163], v235 offset:256
    v_cvt_pk_bf16_f32 v203, v150, v151
    v_mfma_f32_16x16x32_bf16 v[188:191], a[152:155], a[56:59], v[188:191]
    v_exp_f32 v156, v156
    v_mfma_f32_16x16x32_bf16 v[188:191], a[156:159], a[60:63], v[188:191]
    v_exp_f32 v157, v157
    v_mfma_f32_16x16x32_bf16 v[24:27], a[168:171], v[208:211], v[24:27]
    ds_read_b64_tr_b16 a[164:165], v235 offset:32
    v_fma_f32 v159, v159, s28, v227
    v_mfma_f32_16x16x32_bf16 v[28:31], a[172:175], v[208:211], v[28:31]
    ds_read_b64_tr_b16 a[166:167], v235 offset:288
    v_cvt_pk_bf16_f32 v206, v156, v157
    v_mfma_f32_16x16x32_bf16 v[56:59], a[168:171], v[212:215], v[56:59]
    v_exp_f32 v158, v158
    v_mfma_f32_16x16x32_bf16 v[60:63], a[172:175], v[212:215], v[60:63]
    v_exp_f32 v159, v159
    v_mfma_f32_16x16x32_bf16 v[88:91], a[168:171], v[216:219], v[88:91]
    v_cvt_pk_bf16_f32 v207, v158, v159
    v_mfma_f32_16x16x32_bf16 v[92:95], a[172:175], v[216:219], v[92:95]
    v_mfma_f32_16x16x32_bf16 v[120:123], a[168:171], v[220:223], v[120:123]
    v_mfma_f32_16x16x32_bf16 v[124:127], a[172:175], v[220:223], v[124:127]
    s_waitcnt lgkmcnt(4)
    s_add_u32 s46, s46, 1
    s_branch L_B1
L_E:
    v_mfma_f32_16x16x32_bf16 v[128:131], a[128:131], a[0:3], 0
L_pad7:
    s_cbranch_execz L_walk_ret
    ds_read_b128 a[144:147], v233 offset:34048
    ds_read_b128 a[148:151], v233 offset:34112
    v_mfma_f32_16x16x32_bf16 v[128:131], a[132:135], a[4:7], v[128:131]
    ds_read_b128 a[152:155], v233 offset:34176
    ds_read_b128 a[156:159], v233 offset:34240
    v_mfma_f32_16x16x32_bf16 v[128:131], a[136:139], a[8:11], v[128:131]
    buffer_store_dwordx4 a[232:235], v238, s[24:27], s54 offen offset:128 sc0 sc1
    v_fma_f32 v160, v160, s28, v224
    v_mfma_f32_16x16x32_bf16 v[128:131], a[140:143], a[12:15], v[128:131]
    s_waitcnt lgkmcnt(3)
    v_exp_f32 v160, v160
    v_mfma_f32_16x16x32_bf16 v[132:135], a[144:147], a[0:3], 0
    s_waitcnt lgkmcnt(2)
    ds_read_b64_tr_b16 a[168:169], v235 offset:33856
    v_fma_f32 v161, v161, s28, v224
    v_mfma_f32_16x16x32_bf16 v[132:135], a[148:151], a[4:7], v[132:135]
    s_waitcnt lgkmcnt(2)
    ds_read_b64_tr_b16 a[170:171], v235 offset:34112
    v_exp_f32 v161, v161
    v_fma_f32 v162, v162, s28, v224
    v_mfma_f32_16x16x32_bf16 v[132:135], a[152:155], a[8:11], v[132:135]
    s_waitcnt lgkmcnt(2)
    buffer_store_dwordx4 a[236:239], v238, s[24:27], s54 offen offset:2176 sc0 sc1
    ds_read_b64_tr_b16 a[172:173], v235 offset:33888
    v_cvt_pk_bf16_f32 v208, v160, v161
    v_exp_f32 v162, v162
    v_mfma_f32_16x16x32_bf16 v[132:135], a[156:159], a[12:15], v[132:135]
    ds_read_b64_tr_b16 a[174:175], v235 offset:34144
    v_fma_f32 v163, v163, s28, v224
    v_smfmac_f32_16x16x64_bf16 a[176:179], a[184:187], v[192:199], v251
    ds_read_b128 a[64:67], v233 offset:34304
    v_fma_f32 v164, v164, s28, v224
    v_exp_f32 v163, v163
    v_smfmac_f32_16x16x64_bf16 a[180:183], a[184:187], v[200:207], v251
    ds_read_b128 a[68:71], v233 offset:34368
    v_cvt_pk_bf16_f32 v209, v162, v163
    v_mfma_f32_16x16x32_bf16 v[0:3], a[160:163], v[192:195], v[0:3]
    buffer_store_dwordx4 a[248:251], v238, s[24:27], s55 offen offset:128 sc0 sc1
    ds_read_b128 a[72:75], v233 offset:34432
    v_exp_f32 v164, v164
    v_fma_f32 v165, v165, s28, v224
    v_mfma_f32_16x16x32_bf16 v[4:7], a[164:167], v[192:195], v[4:7]
    ds_read_b128 a[76:79], v233 offset:34496
    v_fma_f32 v166, v166, s28, v224
    v_exp_f32 v165, v165
    v_mfma_f32_16x16x32_bf16 v[32:35], a[160:163], v[196:199], v[32:35]
    ds_read_b128 a[80:83], v233 offset:34560
    v_cvt_pk_bf16_f32 v210, v164, v165
    v_mfma_f32_16x16x32_bf16 v[36:39], a[164:167], v[196:199], v[36:39]
    ds_read_b128 a[84:87], v233 offset:34624
    v_exp_f32 v166, v166
    v_fma_f32 v167, v167, s28, v224
    v_mfma_f32_16x16x32_bf16 v[64:67], a[160:163], v[200:203], v[64:67]
    s_waitcnt vmcnt(11)
    s_barrier
    buffer_store_dwordx4 a[252:255], v238, s[24:27], s55 offen offset:2176 sc0 sc1
    ds_read_b128 a[88:91], v233 offset:34688
    v_exp_f32 v167, v167
    v_mfma_f32_16x16x32_bf16 v[68:71], a[164:167], v[200:203], v[68:71]
    s_add_u32 s52, s33, 0
    ds_read_b128 a[92:95], v233 offset:34752
    v_cvt_pk_bf16_f32 v211, v166, v167
    v_mfma_f32_16x16x32_bf16 v[96:99], a[160:163], v[204:207], v[96:99]
    s_add_u32 s53, s33, 4096
    ds_read_b64_tr_b16 a[160:161], v235 offset:33920
    v_fma_f32 v128, v128, s28, v224
    v_mfma_f32_16x16x32_bf16 v[100:103], a[164:167], v[204:207], v[100:103]
    s_add_u32 s54, s33, 8192
    s_waitcnt lgkmcnt(11)
    v_exp_f32 v128, v128
    v_mfma_f32_16x16x32_bf16 v[8:11], a[168:171], v[192:195], v[8:11]
    s_add_u32 s55, s33, 12288
    s_waitcnt lgkmcnt(9)
    ds_read_b64_tr_b16 a[162:163], v235 offset:34176
    v_fma_f32 v129, v129, s28, v224
    v_mfma_f32_16x16x32_bf16 v[12:15], a[172:175], v[192:195], v[12:15]
    s_mov_b32 s26, s36
    v_exp_f32 v129, v129
    v_mfma_f32_16x16x32_bf16 v[40:43], a[168:171], v[196:199], v[40:43]
    s_mov_b32 s22, 48234496
    ds_read_b64_tr_b16 a[164:165], v235 offset:33952
    v_fma_f32 v130, v130, s28, v224
    v_mfma_f32_16x16x32_bf16 v[44:47], a[172:175], v[196:199], v[44:47]
    ds_read_b64_tr_b16 a[166:167], v235 offset:34208
    v_cvt_pk_bf16_f32 v128, v128, v129
    v_mfma_f32_16x16x32_bf16 v[72:75], a[168:171], v[200:203], v[72:75]
    ds_read_b64_tr_b16 a[96:97], v235 offset:34304
    v_and_b32 v246, 48, v250
    v_cmp_eq_u32 vcc, 0, v246
    v_mov_b32 v247, 0x3f803f80
    s_nop 0
    v_cndmask_b32 v246, 0, v247, vcc
    v_exp_f32 v130, v130
    v_mfma_f32_16x16x32_bf16 v[76:79], a[172:175], v[200:203], v[76:79]
    ds_read_b64_tr_b16 a[98:99], v235 offset:34560
    v_fma_f32 v131, v131, s28, v224
    v_mfma_f32_16x16x32_bf16 v[104:107], a[168:171], v[204:207], v[104:107]
    ds_read_b64_tr_b16 a[192:193], v234 offset:0
    v_accvgpr_write_b32 a232, v246
    v_exp_f32 v131, v131
    v_mfma_f32_16x16x32_bf16 v[108:111], a[172:175], v[204:207], v[108:111]
    s_waitcnt lgkmcnt(14)
    v_accvgpr_write_b32 a233, v246
    v_fma_f32 v132, v132, s28, v224
    v_cvt_pk_bf16_f32 v129, v130, v131
    v_mfma_f32_16x16x32_bf16 v[160:163], a[64:67], a[0:3], 0
    s_waitcnt lgkmcnt(13)
    ds_read_b64_tr_b16 a[194:195], v234 offset:256
    v_accvgpr_write_b32 a234, v246
    v_exp_f32 v132, v132
    v_mfma_f32_16x16x32_bf16 v[160:163], a[68:71], a[4:7], v[160:163]
    s_waitcnt lgkmcnt(13)
    ds_read_b64_tr_b16 a[168:169], v235 offset:33984
    ds_read_b64_tr_b16 a[224:225], v234 offset:512
    v_accvgpr_write_b32 a235, v246
    v_fma_f32 v133, v133, s28, v224
    v_mfma_f32_16x16x32_bf16 v[160:163], a[72:75], a[8:11], v[160:163]
    s_waitcnt lgkmcnt(14)
    ds_read_b64_tr_b16 a[170:171], v235 offset:34240
    v_xor_b32 v244, 64, v248
    v_xor_b32 v245, 64, v249
    v_exp_f32 v133, v133
    v_mfma_f32_16x16x32_bf16 v[160:163], a[76:79], a[12:15], v[160:163]
    s_waitcnt lgkmcnt(14)
    ds_read_b64_tr_b16 a[226:227], v234 offset:768
    ds_read_b64_tr_b16 a[172:173], v235 offset:34016
    ds_read_b64_tr_b16 a[174:175], v235 offset:34272
    v_fma_f32 v134, v134, s28, v224
    v_cvt_pk_bf16_f32 v130, v132, v133
    v_mfma_f32_16x16x32_bf16 v[164:167], a[80:83], a[0:3], 0
    s_waitcnt lgkmcnt(15)
    ds_read_b64_tr_b16 a[100:101], v235 offset:34336
    v_fma_f32 v135, v135, s28, v224
    v_exp_f32 v134, v134
    v_mfma_f32_16x16x32_bf16 v[164:167], a[84:87], a[4:7], v[164:167]
L_pad8:
    s_cbranch_execz L_walk_ret
    ds_read_b64_tr_b16 a[102:103], v235 offset:34592
    ds_read_b64_tr_b16 a[196:197], v234 offset:32
    v_mfma_f32_16x16x32_bf16 v[164:167], a[88:91], a[8:11], v[164:167]
    s_waitcnt lgkmcnt(15)
    v_exp_f32 v135, v135
    v_mfma_f32_16x16x32_bf16 v[164:167], a[92:95], a[12:15], v[164:167]
    ds_read_b64_tr_b16 a[198:199], v234 offset:288
    v_cvt_pk_bf16_f32 v131, v134, v135
    v_mfma_f32_16x16x32_bf16 v[16:19], a[160:163], v[192:195], v[16:19]
    s_waitcnt lgkmcnt(14)
    ds_read_b64_tr_b16 a[228:229], v234 offset:544
    v_fma_f32 v160, v160, s28, v224
    v_mfma_f32_16x16x32_bf16 v[20:23], a[164:167], v[192:195], v[20:23]
    ds_read_b64_tr_b16 a[230:231], v234 offset:800
    ds_read_b64_tr_b16 a[104:105], v235 offset:34368
    v_mfma_f32_16x16x32_bf16 v[48:51], a[160:163], v[196:199], v[48:51]
    v_exp_f32 v160, v160
    v_mfma_f32_16x16x32_bf16 v[52:55], a[164:167], v[196:199], v[52:55]
    ds_read_b64_tr_b16 a[106:107], v235 offset:34624
    v_fma_f32 v161, v161, s28, v224
    v_mfma_f32_16x16x32_bf16 v[80:83], a[160:163], v[200:203], v[80:83]
    v_exp_f32 v161, v161
    v_mfma_f32_16x16x32_bf16 v[84:87], a[164:167], v[200:203], v[84:87]
    ds_read_b64_tr_b16 a[200:201], v234 offset:64
    v_cvt_pk_bf16_f32 v160, v160, v161
    v_mfma_f32_16x16x32_bf16 v[112:115], a[160:163], v[204:207], v[112:115]
    ds_read_b64_tr_b16 a[202:203], v234 offset:320
    v_fma_f32 v162, v162, s28, v224
    v_mfma_f32_16x16x32_bf16 v[116:119], a[164:167], v[204:207], v[116:119]
    v_exp_f32 v162, v162
    v_mfma_f32_16x16x32_bf16 v[136:139], a[128:131], a[16:19], 0
    ds_read_b64_tr_b16 a[240:241], v234 offset:576
    v_fma_f32 v163, v163, s28, v224
    v_mfma_f32_16x16x32_bf16 v[136:139], a[132:135], a[20:23], v[136:139]
    ds_read_b64_tr_b16 a[242:243], v234 offset:832
    ds_read_b64_tr_b16 a[108:109], v235 offset:34400
    v_mfma_f32_16x16x32_bf16 v[136:139], a[136:139], a[24:27], v[136:139]
    v_exp_f32 v163, v163
    v_mfma_f32_16x16x32_bf16 v[136:139], a[140:143], a[28:31], v[136:139]
    v_cvt_pk_bf16_f32 v161, v162, v163
    v_fma_f32 v164, v164, s28, v224
    v_mfma_f32_16x16x32_bf16 v[140:143], a[144:147], a[16:19], 0
    v_exp_f32 v164, v164
    v_mfma_f32_16x16x32_bf16 v[140:143], a[148:151], a[20:23], v[140:143]
    ds_read_b64_tr_b16 a[110:111], v235 offset:34656
    v_fma_f32 v165, v165, s28, v224
    v_mfma_f32_16x16x32_bf16 v[140:143], a[152:155], a[24:27], v[140:143]
    ds_read_b64_tr_b16 a[204:205], v234 offset:96
    ds_read_b64_tr_b16 a[206:207], v234 offset:352
    v_mfma_f32_16x16x32_bf16 v[140:143], a[156:159], a[28:31], v[140:143]
    s_waitcnt lgkmcnt(15)
    v_exp_f32 v165, v165
    v_mfma_f32_16x16x32_bf16 v[24:27], a[168:171], v[192:195], v[24:27]
    v_cvt_pk_bf16_f32 v162, v164, v165
    v_fma_f32 v166, v166, s28, v224
    v_mfma_f32_16x16x32_bf16 v[28:31], a[172:175], v[192:195], v[28:31]
    ds_read_b64_tr_b16 a[244:245], v234 offset:608
    v_fma_f32 v168, v168, s28, v225
    v_exp_f32 v166, v166
    v_mfma_f32_16x16x32_bf16 v[56:59], a[168:171], v[196:199], v[56:59]
    ds_read_b64_tr_b16 a[246:247], v234 offset:864
    v_fma_f32 v169, v169, s28, v225
    v_exp_f32 v168, v168
    v_mfma_f32_16x16x32_bf16 v[60:63], a[172:175], v[196:199], v[60:63]
    v_fma_f32 v167, v167, s28, v224
    v_fma_f32 v170, v170, s28, v225
    v_exp_f32 v169, v169
    v_mfma_f32_16x16x32_bf16 v[88:91], a[168:171], v[200:203], v[88:91]
    ds_read_b64_tr_b16 a[112:113], v235 offset:34432
    v_exp_f32 v167, v167
    v_cvt_pk_bf16_f32 v212, v168, v169
    v_mfma_f32_16x16x32_bf16 v[92:95], a[172:175], v[200:203], v[92:95]
    ds_read_b64_tr_b16 a[114:115], v235 offset:34688
    v_exp_f32 v170, v170
    v_fma_f32 v171, v171, s28, v225
    v_cvt_pk_bf16_f32 v163, v166, v167
    v_mfma_f32_16x16x32_bf16 v[120:123], a[168:171], v[204:207], v[120:123]
    ds_read_b64_tr_b16 a[208:209], v234 offset:128
    v_exp_f32 v171, v171
    v_fma_f32 v172, v172, s28, v225
    v_mfma_f32_16x16x32_bf16 v[124:127], a[172:175], v[204:207], v[124:127]
    ds_read_b64_tr_b16 a[210:211], v234 offset:384
    v_cvt_pk_bf16_f32 v213, v170, v171
    v_exp_f32 v172, v172
    v_fma_f32 v173, v173, s28, v225
    v_mfma_f32_16x16x32_bf16 a[176:179], a[232:235], v[208:211], a[176:179]
    ds_read_b64_tr_b16 a[116:117], v235 offset:34464
    v_fma_f32 v174, v174, s28, v225
    v_exp_f32 v173, v173
    v_mfma_f32_16x16x32_bf16 a[176:179], a[232:235], v[128:131], a[176:179]
    ds_read_b64_tr_b16 a[118:119], v235 offset:34720
    v_cvt_pk_bf16_f32 v214, v172, v173
    v_mfma_f32_16x16x32_bf16 a[176:179], a[232:235], v[160:163], a[176:179]
    ds_read_b64_tr_b16 a[212:213], v234 offset:160
    v_exp_f32 v174, v174
    v_fma_f32 v175, v175, s28, v225
    v_mfma_f32_16x16x32_bf16 v[0:3], a[96:99], v[208:211], v[0:3]
    ds_read_b64_tr_b16 a[214:215], v234 offset:416
    v_exp_f32 v175, v175
    v_mfma_f32_16x16x32_bf16 v[0:3], a[192:195], v[128:131], v[0:3]
    ds_read_b64_tr_b16 a[120:121], v235 offset:34496
    v_cvt_pk_bf16_f32 v215, v174, v175
    v_mfma_f32_16x16x32_bf16 v[0:3], a[224:227], v[160:163], v[0:3]
    s_waitcnt lgkmcnt(15)
    ds_read_b64_tr_b16 a[122:123], v235 offset:34752
    v_fma_f32 v136, v136, s28, v225
    v_mfma_f32_16x16x32_bf16 v[4:7], a[100:103], v[208:211], v[4:7]
    ds_read_b64_tr_b16 a[216:217], v234 offset:192
    ds_read_b64_tr_b16 a[218:219], v234 offset:448
    v_exp_f32 v136, v136
    v_mfma_f32_16x16x32_bf16 v[4:7], a[196:199], v[128:131], v[4:7]
    v_accvgpr_read_b32 v228, a176
    v_fma_f32 v137, v137, s28, v225
    v_accvgpr_read_b32 v240, a177
    v_mfma_f32_16x16x32_bf16 v[4:7], a[228:231], v[160:163], v[4:7]
    ds_read_b64_tr_b16 a[124:125], v235 offset:34528
    v_add_f32 v228, v228, v240
    v_mov_b32 v239, v228
    v_exp_f32 v137, v137
    v_mfma_f32_16x16x32_bf16 v[8:11], a[104:107], v[208:211], v[8:11]
    ds_read_b64_tr_b16 a[126:127], v235 offset:34784
    ds_read_b64_tr_b16 a[160:161], v234 offset:640
    v_rcp_f32 v228, v228
    v_cvt_pk_bf16_f32 v136, v136, v137
    v_mfma_f32_16x16x32_bf16 v[8:11], a[200:203], v[128:131], v[8:11]
    ds_read_b64_tr_b16 a[220:221], v234 offset:224
    ds_read_b64_tr_b16 a[162:163], v234 offset:896
    v_fma_f32 v138, v138, s28, v225
    v_mfma_f32_16x16x32_bf16 v[8:11], a[240:243], v[160:163], v[8:11]
    s_waitcnt lgkmcnt(15)
    ds_read_b64_tr_b16 a[222:223], v234 offset:480
    ds_read_b64_tr_b16 a[164:165], v234 offset:672
    v_exp_f32 v138, v138
    v_mfma_f32_16x16x32_bf16 v[12:15], a[108:111], v[208:211], v[12:15]
    ds_read_b64_tr_b16 a[166:167], v234 offset:928
    v_fma_f32 v139, v139, s28, v225
    v_mfma_f32_16x16x32_bf16 v[12:15], a[204:207], v[128:131], v[12:15]
    ds_read_b64_tr_b16 a[168:169], v234 offset:704
    v_exp_f32 v139, v139
    v_mfma_f32_16x16x32_bf16 v[12:15], a[244:247], v[160:163], v[12:15]
    ds_read_b64_tr_b16 a[170:171], v234 offset:960
    v_cvt_pk_bf16_f32 v137, v138, v139
    v_fma_f32 v140, v140, s28, v225
    v_mfma_f32_16x16x32_bf16 v[168:171], a[64:67], a[16:19], 0
    ds_read_b64_tr_b16 a[172:173], v234 offset:736
    ds_read_b64_tr_b16 a[174:175], v234 offset:992
    v_exp_f32 v140, v140
    v_mfma_f32_16x16x32_bf16 v[168:171], a[68:71], a[20:23], v[168:171]
    v_fma_f32 v141, v141, s28, v225
    v_fma_f32 v142, v142, s28, v225
    v_mfma_f32_16x16x32_bf16 v[168:171], a[72:75], a[24:27], v[168:171]
    v_exp_f32 v141, v141
    v_exp_f32 v142, v142
    v_pk_mul_f32 v[0:1], v[0:1], v[228:229] op_sel_hi:[1,0]
    v_pk_mul_f32 v[2:3], v[2:3], v[228:229] op_sel_hi:[1,0]
    v_pk_mul_f32 v[4:5], v[4:5], v[228:229] op_sel_hi:[1,0]
    v_pk_mul_f32 v[6:7], v[6:7], v[228:229] op_sel_hi:[1,0]
    v_pk_mul_f32 v[8:9], v[8:9], v[228:229] op_sel_hi:[1,0]
    v_pk_mul_f32 v[10:11], v[10:11], v[228:229] op_sel_hi:[1,0]
    v_pk_mul_f32 v[12:13], v[12:13], v[228:229] op_sel_hi:[1,0]
    v_pk_mul_f32 v[14:15], v[14:15], v[228:229] op_sel_hi:[1,0]
    v_fma_f32 v143, v143, s28, v225
    v_mfma_f32_16x16x32_bf16 v[168:171], a[76:79], a[28:31], v[168:171]
    v_cvt_pk_bf16_f32 v138, v140, v141
    v_cvt_pk_bf16_f32 v0, v0, v1
    v_mfma_f32_16x16x32_bf16 v[172:175], a[80:83], a[16:19], 0
    v_cvt_pk_bf16_f32 v1, v2, v3
    v_cvt_pk_bf16_f32 v2, v4, v5
    v_mfma_f32_16x16x32_bf16 v[172:175], a[84:87], a[20:23], v[172:175]
    v_cvt_pk_bf16_f32 v3, v6, v7
    v_cvt_pk_bf16_f32 v8, v8, v9
    v_cvt_pk_bf16_f32 v9, v10, v11
    v_cvt_pk_bf16_f32 v10, v12, v13
    v_mfma_f32_16x16x32_bf16 v[172:175], a[88:91], a[24:27], v[172:175]
    ds_write_b64 v248, v[0:1] offset:0
    v_cvt_pk_bf16_f32 v11, v14, v15
    v_mfma_f32_16x16x32_bf16 v[172:175], a[92:95], a[28:31], v[172:175]
    ds_write_b64 v249, v[2:3] offset:0
    v_fma_f32 v168, v168, s28, v225
    v_exp_f32 v143, v143
    v_mfma_f32_16x16x32_bf16 v[16:19], a[112:115], v[208:211], v[16:19]
    s_waitcnt lgkmcnt(15)
    ds_write_b64 v244, v[8:9] offset:0
    v_cvt_pk_bf16_f32 v139, v142, v143
    v_mfma_f32_16x16x32_bf16 v[16:19], a[208:211], v[128:131], v[16:19]
    s_waitcnt lgkmcnt(10)
    ds_write_b64 v245, v[10:11] offset:0
    v_fma_f32 v169, v169, s28, v225
    v_mfma_f32_16x16x32_bf16 v[16:19], a[160:163], v[160:163], v[16:19]
    ds_read_b128 a[248:251], v250 offset:0
    ds_read_b64 a[254:255], v250 offset:1024
    ds_read_b64 a[252:253], v250 offset:1032
    v_mfma_f32_16x16x32_bf16 v[20:23], a[116:119], v[208:211], v[20:23]
    v_exp_f32 v168, v168
    v_mfma_f32_16x16x32_bf16 v[20:23], a[212:215], v[128:131], v[20:23]
    s_waitcnt lgkmcnt(11)
    v_exp_f32 v169, v169
    v_mfma_f32_16x16x32_bf16 v[20:23], a[164:167], v[160:163], v[20:23]
    s_waitcnt lgkmcnt(2)
    buffer_store_dwordx4 a[248:251], v238, s[20:23], s52 offen offset:0 sc0 sc1
    s_waitcnt lgkmcnt(0)
    buffer_store_dwordx4 a[252:255], v238, s[20:23], s52 offen offset:2048 sc0 sc1
    v_mfma_f32_16x16x32_bf16 v[24:27], a[120:123], v[208:211], v[24:27]
    v_fma_f32 v170, v170, s28, v225
    v_cvt_pk_bf16_f32 v168, v168, v169
    v_mfma_f32_16x16x32_bf16 v[24:27], a[216:219], v[128:131], v[24:27]
    v_exp_f32 v170, v170
    v_mfma_f32_16x16x32_bf16 v[24:27], a[168:171], v[160:163], v[24:27]
    v_fma_f32 v171, v171, s28, v225
    v_fma_f32 v172, v172, s28, v225
    v_mfma_f32_16x16x32_bf16 v[28:31], a[124:127], v[208:211], v[28:31]
    v_exp_f32 v171, v171
    v_mfma_f32_16x16x32_bf16 v[28:31], a[220:223], v[128:131], v[28:31]
    v_cvt_pk_bf16_f32 v169, v170, v171
    v_fma_f32 v173, v173, s28, v225
    v_mfma_f32_16x16x32_bf16 v[28:31], a[172:175], v[160:163], v[28:31]
    v_exp_f32 v172, v172
    v_mfma_f32_16x16x32_bf16 v[144:147], a[128:131], a[32:35], 0
    v_exp_f32 v173, v173
    v_mfma_f32_16x16x32_bf16 v[144:147], a[132:135], a[36:39], v[144:147]
    v_fma_f32 v176, v176, s28, v226
    v_fma_f32 v174, v174, s28, v225
    v_mfma_f32_16x16x32_bf16 v[144:147], a[136:139], a[40:43], v[144:147]
    v_exp_f32 v176, v176
    v_cvt_pk_bf16_f32 v170, v172, v173
    v_fma_f32 v177, v177, s28, v226
    v_pk_mul_f32 v[16:17], v[16:17], v[228:229] op_sel_hi:[1,0]
    v_pk_mul_f32 v[18:19], v[18:19], v[228:229] op_sel_hi:[1,0]
    v_pk_mul_f32 v[20:21], v[20:21], v[228:229] op_sel_hi:[1,0]
    v_pk_mul_f32 v[22:23], v[22:23], v[228:229] op_sel_hi:[1,0]
    v_pk_mul_f32 v[24:25], v[24:25], v[228:229] op_sel_hi:[1,0]
    v_pk_mul_f32 v[26:27], v[26:27], v[228:229] op_sel_hi:[1,0]
    v_pk_mul_f32 v[28:29], v[28:29], v[228:229] op_sel_hi:[1,0]
    v_pk_mul_f32 v[30:31], v[30:31], v[228:229] op_sel_hi:[1,0]
    v_exp_f32 v174, v174
    v_mfma_f32_16x16x32_bf16 v[144:147], a[140:143], a[44:47], v[144:147]
    v_exp_f32 v177, v177
    v_mfma_f32_16x16x32_bf16 v[148:151], a[144:147], a[32:35], 0
    v_fma_f32 v178, v178, s28, v226
    v_fma_f32 v175, v175, s28, v225
    v_cvt_pk_bf16_f32 v216, v176, v177
    v_mfma_f32_16x16x32_bf16 v[148:151], a[148:151], a[36:39], v[148:151]
    v_cvt_pk_bf16_f32 v16, v16, v17
    v_cvt_pk_bf16_f32 v17, v18, v19
    v_cvt_pk_bf16_f32 v18, v20, v21
    v_cvt_pk_bf16_f32 v19, v22, v23
    v_exp_f32 v178, v178
    v_cvt_pk_bf16_f32 v24, v24, v25
    v_fma_f32 v179, v179, s28, v226
    v_cvt_pk_bf16_f32 v25, v26, v27
    v_exp_f32 v175, v175
    v_cvt_pk_bf16_f32 v26, v28, v29
    v_mfma_f32_16x16x32_bf16 v[148:151], a[152:155], a[40:43], v[148:151]
    ds_write_b64 v248, v[16:17] offset:2048
    v_cvt_pk_bf16_f32 v27, v30, v31
    v_exp_f32 v179, v179
    v_fma_f32 v180, v180, s28, v226
    v_cvt_pk_bf16_f32 v171, v174, v175
    v_mfma_f32_16x16x32_bf16 v[148:151], a[156:159], a[44:47], v[148:151]
    ds_write_b64 v249, v[18:19] offset:2048
    v_cvt_pk_bf16_f32 v217, v178, v179
    v_exp_f32 v180, v180
    v_fma_f32 v181, v181, s28, v226
    v_mfma_f32_16x16x32_bf16 a[176:179], a[188:191], v[212:215], a[176:179]
    ds_write_b64 v244, v[24:25] offset:2048
    v_fma_f32 v182, v182, s28, v226
    v_exp_f32 v181, v181
    v_mfma_f32_16x16x32_bf16 a[176:179], a[188:191], v[136:139], a[176:179]
    ds_write_b64 v245, v[26:27] offset:2048
    v_cvt_pk_bf16_f32 v218, v180, v181
    v_mfma_f32_16x16x32_bf16 a[176:179], a[188:191], v[168:171], a[176:179]
    ds_read_b128 a[248:251], v250 offset:2048
    ds_read_b64 a[254:255], v250 offset:3072
    ds_read_b64 a[252:253], v250 offset:3080
    v_exp_f32 v182, v182
    v_fma_f32 v183, v183, s28, v226
    v_mfma_f32_16x16x32_bf16 v[32:35], a[96:99], v[212:215], v[32:35]
    v_exp_f32 v183, v183
    v_mfma_f32_16x16x32_bf16 v[32:35], a[192:195], v[136:139], v[32:35]
    v_cvt_pk_bf16_f32 v219, v182, v183
    v_fma_f32 v144, v144, s28, v226
    v_mfma_f32_16x16x32_bf16 v[32:35], a[224:227], v[168:171], v[32:35]
    s_waitcnt lgkmcnt(2)
    buffer_store_dwordx4 a[248:251], v238, s[20:23], s52 offen offset:128 sc0 sc1
    s_waitcnt lgkmcnt(0)
    buffer_store_dwordx4 a[252:255], v238, s[20:23], s52 offen offset:2176 sc0 sc1
    v_mfma_f32_16x16x32_bf16 v[36:39], a[100:103], v[212:215], v[36:39]
    v_exp_f32 v144, v144
    v_mfma_f32_16x16x32_bf16 v[36:39], a[196:199], v[136:139], v[36:39]
    v_accvgpr_read_b32 v229, a178
    v_fma_f32 v145, v145, s28, v226
    v_accvgpr_read_b32 v240, a179
    v_mfma_f32_16x16x32_bf16 v[36:39], a[228:231], v[168:171], v[36:39]
    v_add_f32 v229, v229, v240
    v_add_f32 v239, v239, v229
    v_exp_f32 v145, v145
    v_mfma_f32_16x16x32_bf16 v[40:43], a[104:107], v[212:215], v[40:43]
    v_rcp_f32 v229, v229
    v_cvt_pk_bf16_f32 v144, v144, v145
    v_mfma_f32_16x16x32_bf16 v[40:43], a[200:203], v[136:139], v[40:43]
    v_fma_f32 v146, v146, s28, v226
    v_fma_f32 v147, v147, s28, v226
    v_mfma_f32_16x16x32_bf16 v[40:43], a[240:243], v[168:171], v[40:43]
    v_exp_f32 v146, v146
    v_mfma_f32_16x16x32_bf16 v[44:47], a[108:111], v[212:215], v[44:47]
    v_exp_f32 v147, v147
    v_mfma_f32_16x16x32_bf16 v[44:47], a[204:207], v[136:139], v[44:47]
    v_cvt_pk_bf16_f32 v145, v146, v147
    v_fma_f32 v148, v148, s28, v226
    v_mfma_f32_16x16x32_bf16 v[44:47], a[244:247], v[168:171], v[44:47]
    v_exp_f32 v148, v148
    v_mfma_f32_16x16x32_bf16 v[176:179], a[64:67], a[32:35], 0
    v_fma_f32 v149, v149, s28, v226
    v_fma_f32 v150, v150, s28, v226
    v_mfma_f32_16x16x32_bf16 v[176:179], a[68:71], a[36:39], v[176:179]
    v_exp_f32 v149, v149
    v_mfma_f32_16x16x32_bf16 v[176:179], a[72:75], a[40:43], v[176:179]
    v_cvt_pk_bf16_f32 v146, v148, v149
    v_exp_f32 v150, v150
    v_fma_f32 v151, v151, s28, v226
    v_pk_mul_f32 v[32:33], v[32:33], v[228:229] op_sel:[0,1] op_sel_hi:[1,1]
    v_pk_mul_f32 v[34:35], v[34:35], v[228:229] op_sel:[0,1] op_sel_hi:[1,1]
    v_pk_mul_f32 v[36:37], v[36:37], v[228:229] op_sel:[0,1] op_sel_hi:[1,1]
    v_pk_mul_f32 v[38:39], v[38:39], v[228:229] op_sel:[0,1] op_sel_hi:[1,1]
    v_pk_mul_f32 v[40:41], v[40:41], v[228:229] op_sel:[0,1] op_sel_hi:[1,1]
    v_pk_mul_f32 v[42:43], v[42:43], v[228:229] op_sel:[0,1] op_sel_hi:[1,1]
    v_pk_mul_f32 v[44:45], v[44:45], v[228:229] op_sel:[0,1] op_sel_hi:[1,1]
    v_pk_mul_f32 v[46:47], v[46:47], v[228:229] op_sel:[0,1] op_sel_hi:[1,1]
    v_exp_f32 v151, v151
    v_mfma_f32_16x16x32_bf16 v[176:179], a[76:79], a[44:47], v[176:179]
    v_cvt_pk_bf16_f32 v32, v32, v33
    v_cvt_pk_bf16_f32 v33, v34, v35
    v_mfma_f32_16x16x32_bf16 v[180:183], a[80:83], a[32:35], 0
    v_cvt_pk_bf16_f32 v34, v36, v37
    v_cvt_pk_bf16_f32 v35, v38, v39
    v_mfma_f32_16x16x32_bf16 v[180:183], a[84:87], a[36:39], v[180:183]
    v_cvt_pk_bf16_f32 v40, v40, v41
    v_cvt_pk_bf16_f32 v41, v42, v43
    v_cvt_pk_bf16_f32 v42, v44, v45
    v_mfma_f32_16x16x32_bf16 v[180:183], a[88:91], a[40:43], v[180:183]
    ds_write_b64 v248, v[32:33] offset:4096
    v_cvt_pk_bf16_f32 v43, v46, v47
    v_mfma_f32_16x16x32_bf16 v[180:183], a[92:95], a[44:47], v[180:183]
    ds_write_b64 v249, v[34:35] offset:4096
    v_cvt_pk_bf16_f32 v147, v150, v151
    v_mfma_f32_16x16x32_bf16 v[48:51], a[112:115], v[212:215], v[48:51]
    ds_write_b64 v244, v[40:41] offset:4096
    v_fma_f32 v176, v176, s28, v226
    v_mfma_f32_16x16x32_bf16 v[48:51], a[208:211], v[136:139], v[48:51]
    ds_write_b64 v245, v[42:43] offset:4096
    v_fma_f32 v177, v177, s28, v226
    v_mfma_f32_16x16x32_bf16 v[48:51], a[160:163], v[168:171], v[48:51]
    ds_read_b128 a[248:251], v250 offset:4096
    ds_read_b64 a[254:255], v250 offset:5120
    ds_read_b64 a[252:253], v250 offset:5128
    v_mfma_f32_16x16x32_bf16 v[52:55], a[116:119], v[212:215], v[52:55]
    v_exp_f32 v176, v176
    v_mfma_f32_16x16x32_bf16 v[52:55], a[212:215], v[136:139], v[52:55]
    v_exp_f32 v177, v177
    v_mfma_f32_16x16x32_bf16 v[52:55], a[164:167], v[168:171], v[52:55]
    s_waitcnt lgkmcnt(2)
    buffer_store_dwordx4 a[248:251], v238, s[20:23], s53 offen offset:0 sc0 sc1
    s_waitcnt lgkmcnt(0)
    buffer_store_dwordx4 a[252:255], v238, s[20:23], s53 offen offset:2048 sc0 sc1
    v_mfma_f32_16x16x32_bf16 v[56:59], a[120:123], v[212:215], v[56:59]
    v_fma_f32 v178, v178, s28, v226
    v_cvt_pk_bf16_f32 v176, v176, v177
    v_mfma_f32_16x16x32_bf16 v[56:59], a[216:219], v[136:139], v[56:59]
    v_exp_f32 v178, v178
    v_mfma_f32_16x16x32_bf16 v[56:59], a[168:171], v[168:171], v[56:59]
    v_fma_f32 v179, v179, s28, v226
    v_fma_f32 v180, v180, s28, v226
    v_mfma_f32_16x16x32_bf16 v[60:63], a[124:127], v[212:215], v[60:63]
    v_exp_f32 v179, v179
    v_mfma_f32_16x16x32_bf16 v[60:63], a[220:223], v[136:139], v[60:63]
    v_cvt_pk_bf16_f32 v177, v178, v179
    v_fma_f32 v181, v181, s28, v226
    v_mfma_f32_16x16x32_bf16 v[60:63], a[172:175], v[168:171], v[60:63]
    v_exp_f32 v180, v180
    v_mfma_f32_16x16x32_bf16 v[152:155], a[128:131], a[48:51], 0
    v_exp_f32 v181, v181
    v_mfma_f32_16x16x32_bf16 v[152:155], a[132:135], a[52:55], v[152:155]
    v_fma_f32 v184, v184, s28, v227
    v_fma_f32 v182, v182, s28, v226
    v_mfma_f32_16x16x32_bf16 v[152:155], a[136:139], a[56:59], v[152:155]
    v_exp_f32 v184, v184
    v_cvt_pk_bf16_f32 v178, v180, v181
    v_fma_f32 v185, v185, s28, v227
    v_pk_mul_f32 v[48:49], v[48:49], v[228:229] op_sel:[0,1] op_sel_hi:[1,1]
    v_pk_mul_f32 v[50:51], v[50:51], v[228:229] op_sel:[0,1] op_sel_hi:[1,1]
    v_pk_mul_f32 v[52:53], v[52:53], v[228:229] op_sel:[0,1] op_sel_hi:[1,1]
    v_pk_mul_f32 v[54:55], v[54:55], v[228:229] op_sel:[0,1] op_sel_hi:[1,1]
    v_pk_mul_f32 v[56:57], v[56:57], v[228:229] op_sel:[0,1] op_sel_hi:[1,1]
    v_pk_mul_f32 v[58:59], v[58:59], v[228:229] op_sel:[0,1] op_sel_hi:[1,1]
    v_pk_mul_f32 v[60:61], v[60:61], v[228:229] op_sel:[0,1] op_sel_hi:[1,1]
    v_pk_mul_f32 v[62:63], v[62:63], v[228:229] op_sel:[0,1] op_sel_hi:[1,1]
    v_exp_f32 v182, v182
    v_mfma_f32_16x16x32_bf16 v[152:155], a[140:143], a[60:63], v[152:155]
    v_exp_f32 v185, v185
    v_mfma_f32_16x16x32_bf16 v[156:159], a[144:147], a[48:51], 0
    v_fma_f32 v186, v186, s28, v227
    v_fma_f32 v183, v183, s28, v226
    v_cvt_pk_bf16_f32 v220, v184, v185
    v_mfma_f32_16x16x32_bf16 v[156:159], a[148:151], a[52:55], v[156:159]
    v_cvt_pk_bf16_f32 v48, v48, v49
    v_cvt_pk_bf16_f32 v49, v50, v51
    v_cvt_pk_bf16_f32 v50, v52, v53
    v_cvt_pk_bf16_f32 v51, v54, v55
    v_exp_f32 v186, v186
    v_cvt_pk_bf16_f32 v56, v56, v57
    v_fma_f32 v187, v187, s28, v227
    v_cvt_pk_bf16_f32 v57, v58, v59
    v_exp_f32 v183, v183
    v_cvt_pk_bf16_f32 v58, v60, v61
    v_mfma_f32_16x16x32_bf16 v[156:159], a[152:155], a[56:59], v[156:159]
    ds_write_b64 v248, v[48:49] offset:0
    v_cvt_pk_bf16_f32 v59, v62, v63
    v_exp_f32 v187, v187
    v_fma_f32 v188, v188, s28, v227
    v_cvt_pk_bf16_f32 v179, v182, v183
    v_mfma_f32_16x16x32_bf16 v[156:159], a[156:159], a[60:63], v[156:159]
    ds_write_b64 v249, v[50:51] offset:0
    v_cvt_pk_bf16_f32 v221, v186, v187
    v_exp_f32 v188, v188
    v_fma_f32 v189, v189, s28, v227
    v_mfma_f32_16x16x32_bf16 a[180:183], a[232:235], v[216:219], a[180:183]
    ds_write_b64 v244, v[56:57] offset:0
    v_fma_f32 v190, v190, s28, v227
    v_exp_f32 v189, v189
    v_mfma_f32_16x16x32_bf16 a[180:183], a[232:235], v[144:147], a[180:183]
    ds_write_b64 v245, v[58:59] offset:0
    v_cvt_pk_bf16_f32 v222, v188, v189
    v_mfma_f32_16x16x32_bf16 a[180:183], a[232:235], v[176:179], a[180:183]
    ds_read_b128 a[248:251], v250 offset:0
    ds_read_b64 a[254:255], v250 offset:1024
    ds_read_b64 a[252:253], v250 offset:1032
    v_exp_f32 v190, v190
    v_fma_f32 v191, v191, s28, v227
    v_mfma_f32_16x16x32_bf16 v[64:67], a[96:99], v[216:219], v[64:67]
    v_exp_f32 v191, v191
    v_mfma_f32_16x16x32_bf16 v[64:67], a[192:195], v[144:147], v[64:67]
    v_cvt_pk_bf16_f32 v223, v190, v191
    v_fma_f32 v152, v152, s28, v227
    v_mfma_f32_16x16x32_bf16 v[64:67], a[224:227], v[176:179], v[64:67]
    s_waitcnt lgkmcnt(2)
    buffer_store_dwordx4 a[248:251], v238, s[20:23], s53 offen offset:128 sc0 sc1
    s_waitcnt lgkmcnt(0)
    buffer_store_dwordx4 a[252:255], v238, s[20:23], s53 offen offset:2176 sc0 sc1
    v_mfma_f32_16x16x32_bf16 v[68:71], a[100:103], v[216:219], v[68:71]
    v_exp_f32 v152, v152
    v_mfma_f32_16x16x32_bf16 v[68:71], a[196:199], v[144:147], v[68:71]
    v_accvgpr_read_b32 v230, a180
    v_fma_f32 v153, v153, s28, v227
    v_accvgpr_read_b32 v240, a181
    v_mfma_f32_16x16x32_bf16 v[68:71], a[228:231], v[176:179], v[68:71]
    v_add_f32 v230, v230, v240
    v_add_f32 v239, v239, v230
    v_exp_f32 v153, v153
    v_mfma_f32_16x16x32_bf16 v[72:75], a[104:107], v[216:219], v[72:75]
    v_rcp_f32 v230, v230
    v_cvt_pk_bf16_f32 v152, v152, v153
    v_mfma_f32_16x16x32_bf16 v[72:75], a[200:203], v[144:147], v[72:75]
    v_fma_f32 v154, v154, s28, v227
    v_fma_f32 v155, v155, s28, v227
    v_mfma_f32_16x16x32_bf16 v[72:75], a[240:243], v[176:179], v[72:75]
    v_exp_f32 v154, v154
    v_mfma_f32_16x16x32_bf16 v[76:79], a[108:111], v[216:219], v[76:79]
    v_exp_f32 v155, v155
    v_mfma_f32_16x16x32_bf16 v[76:79], a[204:207], v[144:147], v[76:79]
    v_cvt_pk_bf16_f32 v153, v154, v155
    v_fma_f32 v156, v156, s28, v227
    v_mfma_f32_16x16x32_bf16 v[76:79], a[244:247], v[176:179], v[76:79]
    v_exp_f32 v156, v156
    v_mfma_f32_16x16x32_bf16 v[184:187], a[64:67], a[48:51], 0
    v_fma_f32 v157, v157, s28, v227
    v_fma_f32 v158, v158, s28, v227
    v_mfma_f32_16x16x32_bf16 v[184:187], a[68:71], a[52:55], v[184:187]
    v_exp_f32 v157, v157
    v_mfma_f32_16x16x32_bf16 v[184:187], a[72:75], a[56:59], v[184:187]
    v_cvt_pk_bf16_f32 v154, v156, v157
    v_exp_f32 v158, v158
    v_fma_f32 v159, v159, s28, v227
    v_pk_mul_f32 v[64:65], v[64:65], v[230:231] op_sel_hi:[1,0]
    v_pk_mul_f32 v[66:67], v[66:67], v[230:231] op_sel_hi:[1,0]
    v_pk_mul_f32 v[68:69], v[68:69], v[230:231] op_sel_hi:[1,0]
    v_pk_mul_f32 v[70:71], v[70:71], v[230:231] op_sel_hi:[1,0]
    v_pk_mul_f32 v[72:73], v[72:73], v[230:231] op_sel_hi:[1,0]
    v_pk_mul_f32 v[74:75], v[74:75], v[230:231] op_sel_hi:[1,0]
    v_pk_mul_f32 v[76:77], v[76:77], v[230:231] op_sel_hi:[1,0]
    v_pk_mul_f32 v[78:79], v[78:79], v[230:231] op_sel_hi:[1,0]
    v_exp_f32 v159, v159
    v_mfma_f32_16x16x32_bf16 v[184:187], a[76:79], a[60:63], v[184:187]
    v_cvt_pk_bf16_f32 v64, v64, v65
    v_cvt_pk_bf16_f32 v65, v66, v67
    v_mfma_f32_16x16x32_bf16 v[188:191], a[80:83], a[48:51], 0
    v_cvt_pk_bf16_f32 v66, v68, v69
    v_cvt_pk_bf16_f32 v67, v70, v71
    v_mfma_f32_16x16x32_bf16 v[188:191], a[84:87], a[52:55], v[188:191]
    v_cvt_pk_bf16_f32 v72, v72, v73
    v_cvt_pk_bf16_f32 v73, v74, v75
    v_cvt_pk_bf16_f32 v74, v76, v77
    v_mfma_f32_16x16x32_bf16 v[188:191], a[88:91], a[56:59], v[188:191]
    ds_write_b64 v248, v[64:65] offset:2048
    v_cvt_pk_bf16_f32 v75, v78, v79
    v_mfma_f32_16x16x32_bf16 v[188:191], a[92:95], a[60:63], v[188:191]
    ds_write_b64 v249, v[66:67] offset:2048
    v_cvt_pk_bf16_f32 v155, v158, v159
    v_mfma_f32_16x16x32_bf16 v[80:83], a[112:115], v[216:219], v[80:83]
    ds_write_b64 v244, v[72:73] offset:2048
    v_fma_f32 v184, v184, s28, v227
    v_mfma_f32_16x16x32_bf16 v[80:83], a[208:211], v[144:147], v[80:83]
    ds_write_b64 v245, v[74:75] offset:2048
    v_fma_f32 v185, v185, s28, v227
    v_mfma_f32_16x16x32_bf16 v[80:83], a[160:163], v[176:179], v[80:83]
    ds_read_b128 a[248:251], v250 offset:2048
    ds_read_b64 a[254:255], v250 offset:3072
    ds_read_b64 a[252:253], v250 offset:3080
    v_mfma_f32_16x16x32_bf16 v[84:87], a[116:119], v[216:219], v[84:87]
    v_exp_f32 v184, v184
    v_mfma_f32_16x16x32_bf16 v[84:87], a[212:215], v[144:147], v[84:87]
    v_exp_f32 v185, v185
    v_fma_f32 v186, v186, s28, v227
    v_mfma_f32_16x16x32_bf16 v[84:87], a[164:167], v[176:179], v[84:87]
    s_waitcnt lgkmcnt(2)
    buffer_store_dwordx4 a[248:251], v238, s[24:27], s54 offen offset:0 sc0 sc1
    s_waitcnt lgkmcnt(0)
    buffer_store_dwordx4 a[252:255], v238, s[24:27], s54 offen offset:2048 sc0 sc1
    v_exp_f32 v186, v186
    v_fma_f32 v187, v187, s28, v227
    v_cvt_pk_bf16_f32 v184, v184, v185
    v_mfma_f32_16x16x32_bf16 v[88:91], a[120:123], v[216:219], v[88:91]
    v_exp_f32 v187, v187
    v_fma_f32 v188, v188, s28, v227
    v_mfma_f32_16x16x32_bf16 v[88:91], a[216:219], v[144:147], v[88:91]
    v_exp_f32 v188, v188
    v_fma_f32 v189, v189, s28, v227
    v_cvt_pk_bf16_f32 v185, v186, v187
    v_mfma_f32_16x16x32_bf16 v[88:91], a[168:171], v[176:179], v[88:91]
    v_exp_f32 v189, v189
    v_fma_f32 v190, v190, s28, v227
    v_mfma_f32_16x16x32_bf16 v[92:95], a[124:127], v[216:219], v[92:95]
    v_exp_f32 v190, v190
    v_fma_f32 v191, v191, s28, v227
    v_cvt_pk_bf16_f32 v186, v188, v189
    v_mfma_f32_16x16x32_bf16 v[92:95], a[220:223], v[144:147], v[92:95]
    v_exp_f32 v191, v191
    v_mfma_f32_16x16x32_bf16 v[92:95], a[172:175], v[176:179], v[92:95]
    v_cvt_pk_bf16_f32 v187, v190, v191
    v_mfma_f32_16x16x32_bf16 a[180:183], a[188:191], v[220:223], a[180:183]
    v_mfma_f32_16x16x32_bf16 a[180:183], a[188:191], v[152:155], a[180:183]
    v_mfma_f32_16x16x32_bf16 a[180:183], a[188:191], v[184:187], a[180:183]
    v_pk_mul_f32 v[80:81], v[80:81], v[230:231] op_sel_hi:[1,0]
    v_pk_mul_f32 v[82:83], v[82:83], v[230:231] op_sel_hi:[1,0]
    v_pk_mul_f32 v[84:85], v[84:85], v[230:231] op_sel_hi:[1,0]
    v_pk_mul_f32 v[86:87], v[86:87], v[230:231] op_sel_hi:[1,0]
    v_pk_mul_f32 v[88:89], v[88:89], v[230:231] op_sel_hi:[1,0]
    v_pk_mul_f32 v[90:91], v[90:91], v[230:231] op_sel_hi:[1,0]
    v_pk_mul_f32 v[92:93], v[92:93], v[230:231] op_sel_hi:[1,0]
    v_pk_mul_f32 v[94:95], v[94:95], v[230:231] op_sel_hi:[1,0]
    s_nop 0
    v_mfma_f32_16x16x32_bf16 v[96:99], a[96:99], v[220:223], v[96:99]
    v_cvt_pk_bf16_f32 v80, v80, v81
    v_cvt_pk_bf16_f32 v81, v82, v83
    v_mfma_f32_16x16x32_bf16 v[96:99], a[192:195], v[152:155], v[96:99]
    v_cvt_pk_bf16_f32 v82, v84, v85
    v_cvt_pk_bf16_f32 v83, v86, v87
    v_mfma_f32_16x16x32_bf16 v[96:99], a[224:227], v[184:187], v[96:99]
L_pad9:
    s_cbranch_execz L_walk_ret
    v_cvt_pk_bf16_f32 v88, v88, v89
    v_cvt_pk_bf16_f32 v89, v90, v91
    v_cvt_pk_bf16_f32 v90, v92, v93
    v_mfma_f32_16x16x32_bf16 v[100:103], a[100:103], v[220:223], v[100:103]
    ds_write_b64 v248, v[80:81] offset:4096
    v_cvt_pk_bf16_f32 v91, v94, v95
    v_mfma_f32_16x16x32_bf16 v[100:103], a[196:199], v[152:155], v[100:103]
    ds_write_b64 v249, v[82:83] offset:4096
    v_accvgpr_read_b32 v231, a182
    v_accvgpr_read_b32 v240, a183
    v_mfma_f32_16x16x32_bf16 v[100:103], a[228:231], v[184:187], v[100:103]
    ds_write_b64 v244, v[88:89] offset:4096
    v_add_f32 v231, v231, v240
    v_add_f32 v239, v239, v231
    v_mfma_f32_16x16x32_bf16 v[104:107], a[104:107], v[220:223], v[104:107]
    ds_write_b64 v245, v[90:91] offset:4096
    v_cmp_nge_f32 vcc, s61, v239
    v_rcp_f32 v231, v231
    v_mfma_f32_16x16x32_bf16 v[104:107], a[200:203], v[152:155], v[104:107]
    ds_read_b128 a[248:251], v250 offset:4096
    ds_read_b64 a[254:255], v250 offset:5120
    ds_read_b64 a[252:253], v250 offset:5128
    v_mul_f32 v96, v96, v231
    v_mul_f32 v97, v97, v231
    v_mul_f32 v98, v98, v231
    v_mul_f32 v99, v99, v231
    v_cvt_pk_bf16_f32 v96, v96, v97
    v_cvt_pk_bf16_f32 v97, v98, v99
    v_mfma_f32_16x16x32_bf16 v[104:107], a[240:243], v[184:187], v[104:107]
    ds_write_b64 v248, v[96:97] offset:0
    v_mul_f32 v100, v100, v231
    v_mfma_f32_16x16x32_bf16 v[108:111], a[108:111], v[220:223], v[108:111]
    s_cmp_lg_u64 vcc, 0
    s_addc_u32 s47, s47, s47
    v_mul_f32 v101, v101, v231
    v_mul_f32 v102, v102, v231
    v_mfma_f32_16x16x32_bf16 v[108:111], a[204:207], v[152:155], v[108:111]
    s_waitcnt lgkmcnt(3)
    buffer_store_dwordx4 a[248:251], v238, s[24:27], s54 offen offset:128 sc0 sc1
    s_waitcnt lgkmcnt(1)
    buffer_store_dwordx4 a[252:255], v238, s[24:27], s54 offen offset:2176 sc0 sc1
    v_mul_f32 v103, v103, v231
    v_cvt_pk_bf16_f32 v98, v100, v101
    v_cvt_pk_bf16_f32 v99, v102, v103
    v_mfma_f32_16x16x32_bf16 v[108:111], a[244:247], v[184:187], v[108:111]
    ds_write_b64 v249, v[98:99] offset:0
    v_mul_f32 v104, v104, v231
    v_mfma_f32_16x16x32_bf16 v[112:115], a[112:115], v[220:223], v[112:115]
    v_mul_f32 v105, v105, v231
    v_mul_f32 v106, v106, v231
    v_mfma_f32_16x16x32_bf16 v[112:115], a[208:211], v[152:155], v[112:115]
    v_mul_f32 v107, v107, v231
    v_cvt_pk_bf16_f32 v104, v104, v105
    v_cvt_pk_bf16_f32 v105, v106, v107
    v_mfma_f32_16x16x32_bf16 v[112:115], a[160:163], v[184:187], v[112:115]
    ds_write_b64 v244, v[104:105] offset:0
    v_mul_f32 v108, v108, v231
    v_mfma_f32_16x16x32_bf16 v[116:119], a[116:119], v[220:223], v[116:119]
    v_mul_f32 v109, v109, v231
    v_mul_f32 v110, v110, v231
    v_mfma_f32_16x16x32_bf16 v[116:119], a[212:215], v[152:155], v[116:119]
    v_mul_f32 v111, v111, v231
    v_cvt_pk_bf16_f32 v106, v108, v109
    v_cvt_pk_bf16_f32 v107, v110, v111
    v_mfma_f32_16x16x32_bf16 v[116:119], a[164:167], v[184:187], v[116:119]
    ds_write_b64 v245, v[106:107] offset:0
    v_mul_f32 v112, v112, v231
    v_mfma_f32_16x16x32_bf16 v[120:123], a[120:123], v[220:223], v[120:123]
    ds_read_b128 a[248:251], v250 offset:0
    ds_read_b64 a[254:255], v250 offset:1024
    ds_read_b64 a[252:253], v250 offset:1032
    v_mfma_f32_16x16x32_bf16 v[120:123], a[216:219], v[152:155], v[120:123]
    v_mul_f32 v113, v113, v231
    v_mul_f32 v114, v114, v231
    v_mul_f32 v115, v115, v231
    v_cvt_pk_bf16_f32 v112, v112, v113
    v_cvt_pk_bf16_f32 v113, v114, v115
    v_mfma_f32_16x16x32_bf16 v[120:123], a[168:171], v[184:187], v[120:123]
    ds_write_b64 v248, v[112:113] offset:2048
    v_mul_f32 v116, v116, v231
    v_mfma_f32_16x16x32_bf16 v[124:127], a[124:127], v[220:223], v[124:127]
    s_waitcnt lgkmcnt(3)
    buffer_store_dwordx4 a[248:251], v238, s[24:27], s55 offen offset:0 sc0 sc1
    s_waitcnt lgkmcnt(1)
    buffer_store_dwordx4 a[252:255], v238, s[24:27], s55 offen offset:2048 sc0 sc1
    v_mfma_f32_16x16x32_bf16 v[124:127], a[220:223], v[152:155], v[124:127]
    v_mul_f32 v117, v117, v231
    v_mul_f32 v118, v118, v231
    v_mul_f32 v119, v119, v231
    v_cvt_pk_bf16_f32 v114, v116, v117
    v_cvt_pk_bf16_f32 v115, v118, v119
    v_mfma_f32_16x16x32_bf16 v[124:127], a[172:175], v[184:187], v[124:127]
    ds_write_b64 v249, v[114:115] offset:2048
    v_mul_f32 v120, v120, v231
    v_mul_f32 v121, v121, v231
    v_mul_f32 v122, v122, v231
    v_mul_f32 v123, v123, v231
    v_cvt_pk_bf16_f32 v120, v120, v121
    v_cvt_pk_bf16_f32 v121, v122, v123
    s_nop 0
    v_mul_f32 v124, v124, v231
    v_mul_f32 v125, v125, v231
    v_mul_f32 v126, v126, v231
    v_mul_f32 v127, v127, v231
    v_cvt_pk_bf16_f32 v122, v124, v125
    v_cvt_pk_bf16_f32 v123, v126, v127
    ds_write_b64 v244, v[120:121] offset:2048
    ds_write_b64 v245, v[122:123] offset:2048
    ds_read_b128 a[248:251], v250 offset:2048
    ds_read_b64 a[254:255], v250 offset:3072
    ds_read_b64 a[252:253], v250 offset:3080
    s_waitcnt lgkmcnt(2)
    buffer_store_dwordx4 a[248:251], v238, s[24:27], s55 offen offset:128 sc0 sc1
    s_waitcnt lgkmcnt(0)
    buffer_store_dwordx4 a[252:255], v238, s[24:27], s55 offen offset:2176 sc0 sc1
L_slow_entry:
    s_cmp_eq_u32 s47, 0
    s_cbranch_scc1 L_end
    s_waitcnt vmcnt(0) lgkmcnt(0)
    s_barrier
    s_mov_b32 s46, 0
    v_mbcnt_lo_u32_b32 v240, -1, 0
    v_mbcnt_hi_u32_b32 v240, -1, v240
    v_and_b32 v241, 15, v240
    v_lshrrev_b32 v240, 4, v240
    v_lshlrev_b32 v241, 8, v241
    v_lshl_add_u32 v237, v240, 4, v241
    s_lshl_b32 s44, s29, 10
    v_subrev_u32 v252, s44, v236
    s_mul_i32 s44, s29, 33792
    v_add_u32 v233, s44, v232
    v_add_u32 v235, s44, v234
L_slow_item:
    s_bitcmp1_b32 s47, 2
    s_cbranch_scc0 L_slow_next
    s_and_b32 s83, s84, 0xfffe0000
    s_mov_b32 s80, s87
    s_mov_b32 s81, s90
    s_add_u32 s56, s80, 0
    s_add_u32 s52, s80, 0
    s_add_u32 s57, s80, 4096
    s_add_u32 s53, s80, 4096
    s_add_u32 s58, s80, 8192
    s_add_u32 s54, s80, 8192
    s_add_u32 s59, s80, 12288
    s_add_u32 s55, s80, 12288
    s_mov_b32 s18, s81
    s_mov_b32 s26, s81
    s_mov_b32 s14, 48234496
    s_mov_b32 s6, 33554432
    s_mov_b32 s10, 33554432
    buffer_load_dwordx4 a[0:3], v237, s[12:15], s56 offen offset:0 nt
    buffer_load_dwordx4 a[4:7], v237, s[12:15], s56 offen offset:64 nt
    buffer_load_dwordx4 a[8:11], v237, s[12:15], s56 offen offset:128 nt
    buffer_load_dwordx4 a[12:15], v237, s[12:15], s56 offen offset:192 nt
    buffer_load_dwordx4 a[16:19], v237, s[12:15], s57 offen offset:0 nt
    buffer_load_dwordx4 a[20:23], v237, s[12:15], s57 offen offset:64 nt
    buffer_load_dwordx4 a[24:27], v237, s[12:15], s57 offen offset:128 nt
    buffer_load_dwordx4 a[28:31], v237, s[12:15], s57 offen offset:192 nt
    buffer_load_dwordx4 a[32:35], v237, s[16:19], s58 offen offset:0 nt
    buffer_load_dwordx4 a[36:39], v237, s[16:19], s58 offen offset:64 nt
    buffer_load_dwordx4 a[40:43], v237, s[16:19], s58 offen offset:128 nt
    buffer_load_dwordx4 a[44:47], v237, s[16:19], s58 offen offset:192 nt
    buffer_load_dwordx4 a[48:51], v237, s[16:19], s59 offen offset:0 nt
    buffer_load_dwordx4 a[52:55], v237, s[16:19], s59 offen offset:64 nt
    buffer_load_dwordx4 a[56:59], v237, s[16:19], s59 offen offset:128 nt
    buffer_load_dwordx4 a[60:63], v237, s[16:19], s59 offen offset:192 nt
    v_mov_b32 v0, 0
    v_mov_b32 v1, 0
    v_mov_b32 v2, 0
    v_mov_b32 v3, 0
    v_mov_b32 v4, 0
    v_mov_b32 v5, 0
    v_mov_b32 v6, 0
    v_mov_b32 v7, 0
    v_mov_b32 v8, 0
    v_mov_b32 v9, 0
    v_mov_b32 v10, 0
    v_mov_b32 v11, 0
    v_mov_b32 v12, 0
    v_mov_b32 v13, 0
    v_mov_b32 v14, 0
    v_mov_b32 v15, 0
    v_mov_b32 v16, 0
    v_mov_b32 v17, 0
    v_mov_b32 v18, 0
    v_mov_b32 v19, 0
    v_mov_b32 v20, 0
    v_mov_b32 v21, 0
    v_mov_b32 v22, 0
    v_mov_b32 v23, 0
    v_mov_b32 v24, 0
    v_mov_b32 v25, 0
    v_mov_b32 v26, 0
    v_mov_b32 v27, 0
    v_mov_b32 v28, 0
    v_mov_b32 v29, 0
    v_mov_b32 v30, 0
    v_mov_b32 v31, 0
    v_mov_b32 v32, 0
    v_mov_b32 v33, 0
    v_mov_b32 v34, 0
    v_mov_b32 v35, 0
    v_mov_b32 v36, 0
    v_mov_b32 v37, 0
    v_mov_b32 v38, 0
    v_mov_b32 v39, 0
    v_mov_b32 v40, 0
    v_mov_b32 v41, 0
    v_mov_b32 v42, 0
    v_mov_b32 v43, 0
    v_mov_b32 v44, 0
    v_mov_b32 v45, 0
    v_mov_b32 v46, 0
    v_mov_b32 v47, 0
    v_mov_b32 v48, 0
    v_mov_b32 v49, 0
    v_mov_b32 v50, 0
    v_mov_b32 v51, 0
    v_mov_b32 v52, 0
    v_mov_b32 v53, 0
    v_mov_b32 v54, 0
    v_mov_b32 v55, 0
    v_mov_b32 v56, 0
    v_mov_b32 v57, 0
    v_mov_b32 v58, 0
    v_mov_b32 v59, 0
    v_mov_b32 v60, 0
    v_mov_b32 v61, 0
    v_mov_b32 v62, 0
    v_mov_b32 v63, 0
    v_mov_b32 v64, 0
    v_mov_b32 v65, 0
    v_mov_b32 v66, 0
    v_mov_b32 v67, 0
    v_mov_b32 v68, 0
    v_mov_b32 v69, 0
    v_mov_b32 v70, 0
    v_mov_b32 v71, 0
    v_mov_b32 v72, 0
    v_mov_b32 v73, 0
    v_mov_b32 v74, 0
    v_mov_b32 v75, 0
    v_mov_b32 v76, 0
    v_mov_b32 v77, 0
    v_mov_b32 v78, 0
    v_mov_b32 v79, 0
    v_mov_b32 v80, 0
    v_mov_b32 v81, 0
    v_mov_b32 v82, 0
    v_mov_b32 v83, 0
    v_mov_b32 v84, 0
    v_mov_b32 v85, 0
    v_mov_b32 v86, 0
    v_mov_b32 v87, 0
    v_mov_b32 v88, 0
    v_mov_b32 v89, 0
    v_mov_b32 v90, 0
    v_mov_b32 v91, 0
    v_mov_b32 v92, 0
    v_mov_b32 v93, 0
    v_mov_b32 v94, 0
    v_mov_b32 v95, 0
    v_mov_b32 v96, 0
    v_mov_b32 v97, 0
    v_mov_b32 v98, 0
    v_mov_b32 v99, 0
    v_mov_b32 v100, 0
    v_mov_b32 v101, 0
    v_mov_b32 v102, 0
    v_mov_b32 v103, 0
    v_mov_b32 v104, 0
    v_mov_b32 v105, 0
    v_mov_b32 v106, 0
    v_mov_b32 v107, 0
    v_mov_b32 v108, 0
    v_mov_b32 v109, 0
    v_mov_b32 v110, 0
    v_mov_b32 v111, 0
    v_mov_b32 v112, 0
    v_mov_b32 v113, 0
    v_mov_b32 v114, 0
    v_mov_b32 v115, 0
    v_mov_b32 v116, 0
    v_mov_b32 v117, 0
    v_mov_b32 v118, 0
    v_mov_b32 v119, 0
    v_mov_b32 v120, 0
    v_mov_b32 v121, 0
    v_mov_b32 v122, 0
    v_mov_b32 v123, 0
    v_mov_b32 v124, 0
    v_mov_b32 v125, 0
    v_mov_b32 v126, 0
    v_mov_b32 v127, 0
    v_mov_b32 v224, 0xff800000
    v_mov_b32 v228, 0
    v_mov_b32 v225, 0xff800000
    v_mov_b32 v229, 0
    v_mov_b32 v226, 0xff800000
    v_mov_b32 v230, 0
    v_mov_b32 v227, 0xff800000
    v_mov_b32 v231, 0
    s_mov_b32 s45, 0
L_slow_stage:
    s_add_u32 m0, s44, 0
    s_nop 0
    buffer_load_dwordx4 v252, s[4:7], s83 offen offset:0 lds
    s_add_u32 m0, s44, 800
    s_nop 0
    buffer_load_dwordx4 v252, s[4:7], s83 offen offset:256 lds
    s_add_u32 m0, s44, 1600
    s_nop 0
    buffer_load_dwordx4 v252, s[4:7], s83 offen offset:512 lds
    s_add_u32 m0, s44, 2400
    s_nop 0
    buffer_load_dwordx4 v252, s[4:7], s83 offen offset:768 lds
    s_add_u32 m0, s44, 3200
    s_nop 0
    buffer_load_dwordx4 v252, s[4:7], s83 offen offset:1024 lds
    s_add_u32 m0, s44, 4000
    s_nop 0
    buffer_load_dwordx4 v252, s[4:7], s83 offen offset:1280 lds
    s_add_u32 m0, s44, 4800
    s_nop 0
    buffer_load_dwordx4 v252, s[4:7], s83 offen offset:1536 lds
    s_add_u32 m0, s44, 5600
    s_nop 0
    buffer_load_dwordx4 v252, s[4:7], s83 offen offset:1792 lds
    s_add_u32 m0, s44, 6400
    s_nop 0
    buffer_load_dwordx4 v252, s[4:7], s83 offen offset:2048 lds
    s_add_u32 m0, s44, 7200
    s_nop 0
    buffer_load_dwordx4 v252, s[4:7], s83 offen offset:2304 lds
    s_add_u32 m0, s44, 8000
    s_nop 0
    buffer_load_dwordx4 v252, s[4:7], s83 offen offset:2560 lds
    s_add_u32 m0, s44, 8800
    s_nop 0
    buffer_load_dwordx4 v252, s[4:7], s83 offen offset:2816 lds
    s_add_u32 m0, s44, 9600
    s_nop 0
    buffer_load_dwordx4 v252, s[4:7], s83 offen offset:3072 lds
    s_add_u32 m0, s44, 10400
    s_nop 0
    buffer_load_dwordx4 v252, s[4:7], s83 offen offset:3328 lds
    s_add_u32 m0, s44, 11200
    s_nop 0
    buffer_load_dwordx4 v252, s[4:7], s83 offen offset:3584 lds
    s_add_u32 m0, s44, 12000
    s_nop 0
    buffer_load_dwordx4 v252, s[4:7], s83 offen offset:3840 lds
    s_add_u32 m0, s44, 16896
    s_nop 0
    buffer_load_dwordx4 v252, s[8:11], s83 offen offset:0 lds
    s_add_u32 m0, s44, 17696
    s_nop 0
    buffer_load_dwordx4 v252, s[8:11], s83 offen offset:256 lds
    s_add_u32 m0, s44, 18496
    s_nop 0
    buffer_load_dwordx4 v252, s[8:11], s83 offen offset:512 lds
    s_add_u32 m0, s44, 19296
    s_nop 0
    buffer_load_dwordx4 v252, s[8:11], s83 offen offset:768 lds
    s_add_u32 m0, s44, 20096
    s_nop 0
    buffer_load_dwordx4 v252, s[8:11], s83 offen offset:1024 lds
    s_add_u32 m0, s44, 20896
    s_nop 0
    buffer_load_dwordx4 v252, s[8:11], s83 offen offset:1280 lds
    s_add_u32 m0, s44, 21696
    s_nop 0
    buffer_load_dwordx4 v252, s[8:11], s83 offen offset:1536 lds
    s_add_u32 m0, s44, 22496
    s_nop 0
    buffer_load_dwordx4 v252, s[8:11], s83 offen offset:1792 lds
    s_add_u32 m0, s44, 23296
    s_nop 0
    buffer_load_dwordx4 v252, s[8:11], s83 offen offset:2048 lds
    s_add_u32 m0, s44, 24096
    s_nop 0
    buffer_load_dwordx4 v252, s[8:11], s83 offen offset:2304 lds
    s_add_u32 m0, s44, 24896
    s_nop 0
    buffer_load_dwordx4 v252, s[8:11], s83 offen offset:2560 lds
    s_add_u32 m0, s44, 25696
    s_nop 0
    buffer_load_dwordx4 v252, s[8:11], s83 offen offset:2816 lds
    s_add_u32 m0, s44, 26496
    s_nop 0
    buffer_load_dwordx4 v252, s[8:11], s83 offen offset:3072 lds
    s_add_u32 m0, s44, 27296
    s_nop 0
    buffer_load_dwordx4 v252, s[8:11], s83 offen offset:3328 lds
    s_add_u32 m0, s44, 28096
    s_nop 0
    buffer_load_dwordx4 v252, s[8:11], s83 offen offset:3584 lds
    s_add_u32 m0, s44, 28896
    s_nop 0
    buffer_load_dwordx4 v252, s[8:11], s83 offen offset:3840 lds
    s_waitcnt vmcnt(0)
    ds_read_b128 a[128:131], v233 offset:0
    ds_read_b128 a[132:135], v233 offset:64
    ds_read_b128 a[136:139], v233 offset:128
    ds_read_b128 a[140:143], v233 offset:192
    ds_read_b128 a[144:147], v233 offset:256
    ds_read_b128 a[148:151], v233 offset:320
    ds_read_b128 a[152:155], v233 offset:384
    ds_read_b128 a[156:159], v233 offset:448
    s_waitcnt lgkmcnt(7)
    v_mfma_f32_16x16x32_bf16 v[128:131], a[128:131], a[0:3], 0
    s_waitcnt lgkmcnt(6)
    v_mfma_f32_16x16x32_bf16 v[128:131], a[132:135], a[4:7], v[128:131]
    s_waitcnt lgkmcnt(5)
    v_mfma_f32_16x16x32_bf16 v[128:131], a[136:139], a[8:11], v[128:131]
    s_waitcnt lgkmcnt(4)
    v_mfma_f32_16x16x32_bf16 v[128:131], a[140:143], a[12:15], v[128:131]
    v_mfma_f32_16x16x32_bf16 v[136:139], a[128:131], a[16:19], 0
    v_mfma_f32_16x16x32_bf16 v[136:139], a[132:135], a[20:23], v[136:139]
    v_mfma_f32_16x16x32_bf16 v[136:139], a[136:139], a[24:27], v[136:139]
    v_mfma_f32_16x16x32_bf16 v[136:139], a[140:143], a[28:31], v[136:139]
    v_mfma_f32_16x16x32_bf16 v[144:147], a[128:131], a[32:35], 0
    v_mfma_f32_16x16x32_bf16 v[144:147], a[132:135], a[36:39], v[144:147]
    v_mfma_f32_16x16x32_bf16 v[144:147], a[136:139], a[40:43], v[144:147]
    v_mfma_f32_16x16x32_bf16 v[144:147], a[140:143], a[44:47], v[144:147]
    v_mfma_f32_16x16x32_bf16 v[152:155], a[128:131], a[48:51], 0
    v_mfma_f32_16x16x32_bf16 v[152:155], a[132:135], a[52:55], v[152:155]
    v_mfma_f32_16x16x32_bf16 v[152:155], a[136:139], a[56:59], v[152:155]
    v_mfma_f32_16x16x32_bf16 v[152:155], a[140:143], a[60:63], v[152:155]
    s_waitcnt lgkmcnt(3)
    v_mfma_f32_16x16x32_bf16 v[132:135], a[144:147], a[0:3], 0
    s_waitcnt lgkmcnt(2)
    v_mfma_f32_16x16x32_bf16 v[132:135], a[148:151], a[4:7], v[132:135]
    s_waitcnt lgkmcnt(1)
    v_mfma_f32_16x16x32_bf16 v[132:135], a[152:155], a[8:11], v[132:135]
    s_waitcnt lgkmcnt(0)
    v_mfma_f32_16x16x32_bf16 v[132:135], a[156:159], a[12:15], v[132:135]
    v_mfma_f32_16x16x32_bf16 v[140:143], a[144:147], a[16:19], 0
    v_mfma_f32_16x16x32_bf16 v[140:143], a[148:151], a[20:23], v[140:143]
    v_mfma_f32_16x16x32_bf16 v[140:143], a[152:155], a[24:27], v[140:143]
    v_mfma_f32_16x16x32_bf16 v[140:143], a[156:159], a[28:31], v[140:143]
    v_mfma_f32_16x16x32_bf16 v[148:151], a[144:147], a[32:35], 0
    v_mfma_f32_16x16x32_bf16 v[148:151], a[148:151], a[36:39], v[148:151]
    v_mfma_f32_16x16x32_bf16 v[148:151], a[152:155], a[40:43], v[148:151]
    v_mfma_f32_16x16x32_bf16 v[148:151], a[156:159], a[44:47], v[148:151]
    v_mfma_f32_16x16x32_bf16 v[156:159], a[144:147], a[48:51], 0
    v_mfma_f32_16x16x32_bf16 v[156:159], a[148:151], a[52:55], v[156:159]
    v_mfma_f32_16x16x32_bf16 v[156:159], a[152:155], a[56:59], v[156:159]
    v_mfma_f32_16x16x32_bf16 v[156:159], a[156:159], a[60:63], v[156:159]
    v_max3_f32 v240, v128, v129, v130
    v_max3_f32 v240, v240, v131, v132
    v_max3_f32 v240, v240, v133, v134
    v_max3_f32 v240, v240, v135, v224
    v_mov_b32 v241, v240
    s_nop 1
    v_permlane16_swap_b32 v240, v241
    v_max_f32 v240, v240, v241
    v_mov_b32 v241, v240
    s_nop 1
    v_permlane32_swap_b32 v240, v241
    v_max_f32 v240, v240, v241
    v_sub_f32 v242, v224, v240
    v_mul_f32 v242, s28, v242
    v_exp_f32 v242, v242
    v_mov_b32 v224, v240
    v_mul_f32 v243, s51, v240
    v_mul_f32 v228, v228, v242
    v_mul_f32 v0, v0, v242
    v_mul_f32 v1, v1, v242
    v_mul_f32 v2, v2, v242
    v_mul_f32 v3, v3, v242
    v_mul_f32 v4, v4, v242
    v_mul_f32 v5, v5, v242
    v_mul_f32 v6, v6, v242
    v_mul_f32 v7, v7, v242
    v_mul_f32 v8, v8, v242
    v_mul_f32 v9, v9, v242
    v_mul_f32 v10, v10, v242
    v_mul_f32 v11, v11, v242
    v_mul_f32 v12, v12, v242
    v_mul_f32 v13, v13, v242
    v_mul_f32 v14, v14, v242
    v_mul_f32 v15, v15, v242
    v_mul_f32 v16, v16, v242
    v_mul_f32 v17, v17, v242
    v_mul_f32 v18, v18, v242
    v_mul_f32 v19, v19, v242
    v_mul_f32 v20, v20, v242
    v_mul_f32 v21, v21, v242
    v_mul_f32 v22, v22, v242
    v_mul_f32 v23, v23, v242
    v_mul_f32 v24, v24, v242
    v_mul_f32 v25, v25, v242
    v_mul_f32 v26, v26, v242
    v_mul_f32 v27, v27, v242
    v_mul_f32 v28, v28, v242
    v_mul_f32 v29, v29, v242
    v_mul_f32 v30, v30, v242
    v_mul_f32 v31, v31, v242
    v_fma_f32 v128, v128, s28, v243
    v_fma_f32 v129, v129, s28, v243
    v_fma_f32 v130, v130, s28, v243
    v_fma_f32 v131, v131, s28, v243
    v_fma_f32 v132, v132, s28, v243
    v_fma_f32 v133, v133, s28, v243
    v_fma_f32 v134, v134, s28, v243
    v_fma_f32 v135, v135, s28, v243
    v_exp_f32 v128, v128
    v_exp_f32 v129, v129
    v_exp_f32 v130, v130
    v_exp_f32 v131, v131
    v_exp_f32 v132, v132
    v_exp_f32 v133, v133
    v_exp_f32 v134, v134
    v_exp_f32 v135, v135
    v_add_f32 v228, v228, v128
    v_add_f32 v228, v228, v129
    v_add_f32 v228, v228, v130
    v_add_f32 v228, v228, v131
    v_add_f32 v228, v228, v132
    v_add_f32 v228, v228, v133
    v_add_f32 v228, v228, v134
    v_add_f32 v228, v228, v135
    v_cvt_pk_bf16_f32 v192, v128, v129
    v_cvt_pk_bf16_f32 v193, v130, v131
    v_cvt_pk_bf16_f32 v194, v132, v133
    v_cvt_pk_bf16_f32 v195, v134, v135
    v_max3_f32 v240, v136, v137, v138
    v_max3_f32 v240, v240, v139, v140
    v_max3_f32 v240, v240, v141, v142
    v_max3_f32 v240, v240, v143, v225
    v_mov_b32 v241, v240
    s_nop 1
    v_permlane16_swap_b32 v240, v241
    v_max_f32 v240, v240, v241
    v_mov_b32 v241, v240
    s_nop 1
    v_permlane32_swap_b32 v240, v241
    v_max_f32 v240, v240, v241
    v_sub_f32 v242, v225, v240
    v_mul_f32 v242, s28, v242
    v_exp_f32 v242, v242
    v_mov_b32 v225, v240
    v_mul_f32 v243, s51, v240
    v_mul_f32 v229, v229, v242
    v_mul_f32 v32, v32, v242
    v_mul_f32 v33, v33, v242
    v_mul_f32 v34, v34, v242
    v_mul_f32 v35, v35, v242
    v_mul_f32 v36, v36, v242
    v_mul_f32 v37, v37, v242
    v_mul_f32 v38, v38, v242
    v_mul_f32 v39, v39, v242
    v_mul_f32 v40, v40, v242
    v_mul_f32 v41, v41, v242
    v_mul_f32 v42, v42, v242
    v_mul_f32 v43, v43, v242
    v_mul_f32 v44, v44, v242
    v_mul_f32 v45, v45, v242
    v_mul_f32 v46, v46, v242
    v_mul_f32 v47, v47, v242
    v_mul_f32 v48, v48, v242
    v_mul_f32 v49, v49, v242
    v_mul_f32 v50, v50, v242
    v_mul_f32 v51, v51, v242
    v_mul_f32 v52, v52, v242
    v_mul_f32 v53, v53, v242
    v_mul_f32 v54, v54, v242
    v_mul_f32 v55, v55, v242
    v_mul_f32 v56, v56, v242
    v_mul_f32 v57, v57, v242
    v_mul_f32 v58, v58, v242
    v_mul_f32 v59, v59, v242
    v_mul_f32 v60, v60, v242
    v_mul_f32 v61, v61, v242
    v_mul_f32 v62, v62, v242
    v_mul_f32 v63, v63, v242
    v_fma_f32 v136, v136, s28, v243
    v_fma_f32 v137, v137, s28, v243
    v_fma_f32 v138, v138, s28, v243
    v_fma_f32 v139, v139, s28, v243
    v_fma_f32 v140, v140, s28, v243
    v_fma_f32 v141, v141, s28, v243
    v_fma_f32 v142, v142, s28, v243
    v_fma_f32 v143, v143, s28, v243
    v_exp_f32 v136, v136
    v_exp_f32 v137, v137
    v_exp_f32 v138, v138
    v_exp_f32 v139, v139
    v_exp_f32 v140, v140
    v_exp_f32 v141, v141
    v_exp_f32 v142, v142
    v_exp_f32 v143, v143
    v_add_f32 v229, v229, v136
    v_add_f32 v229, v229, v137
    v_add_f32 v229, v229, v138
    v_add_f32 v229, v229, v139
    v_add_f32 v229, v229, v140
    v_add_f32 v229, v229, v141
    v_add_f32 v229, v229, v142
    v_add_f32 v229, v229, v143
    v_cvt_pk_bf16_f32 v196, v136, v137
    v_cvt_pk_bf16_f32 v197, v138, v139
    v_cvt_pk_bf16_f32 v198, v140, v141
    v_cvt_pk_bf16_f32 v199, v142, v143
    v_max3_f32 v240, v144, v145, v146
    v_max3_f32 v240, v240, v147, v148
    v_max3_f32 v240, v240, v149, v150
    v_max3_f32 v240, v240, v151, v226
    v_mov_b32 v241, v240
    s_nop 1
    v_permlane16_swap_b32 v240, v241
    v_max_f32 v240, v240, v241
    v_mov_b32 v241, v240
    s_nop 1
    v_permlane32_swap_b32 v240, v241
    v_max_f32 v240, v240, v241
    v_sub_f32 v242, v226, v240
    v_mul_f32 v242, s28, v242
    v_exp_f32 v242, v242
    v_mov_b32 v226, v240
    v_mul_f32 v243, s51, v240
    v_mul_f32 v230, v230, v242
    v_mul_f32 v64, v64, v242
    v_mul_f32 v65, v65, v242
    v_mul_f32 v66, v66, v242
    v_mul_f32 v67, v67, v242
    v_mul_f32 v68, v68, v242
    v_mul_f32 v69, v69, v242
    v_mul_f32 v70, v70, v242
    v_mul_f32 v71, v71, v242
    v_mul_f32 v72, v72, v242
    v_mul_f32 v73, v73, v242
    v_mul_f32 v74, v74, v242
    v_mul_f32 v75, v75, v242
    v_mul_f32 v76, v76, v242
    v_mul_f32 v77, v77, v242
    v_mul_f32 v78, v78, v242
    v_mul_f32 v79, v79, v242
    v_mul_f32 v80, v80, v242
    v_mul_f32 v81, v81, v242
    v_mul_f32 v82, v82, v242
    v_mul_f32 v83, v83, v242
    v_mul_f32 v84, v84, v242
    v_mul_f32 v85, v85, v242
    v_mul_f32 v86, v86, v242
    v_mul_f32 v87, v87, v242
    v_mul_f32 v88, v88, v242
    v_mul_f32 v89, v89, v242
    v_mul_f32 v90, v90, v242
    v_mul_f32 v91, v91, v242
    v_mul_f32 v92, v92, v242
    v_mul_f32 v93, v93, v242
    v_mul_f32 v94, v94, v242
    v_mul_f32 v95, v95, v242
    v_fma_f32 v144, v144, s28, v243
    v_fma_f32 v145, v145, s28, v243
    v_fma_f32 v146, v146, s28, v243
    v_fma_f32 v147, v147, s28, v243
    v_fma_f32 v148, v148, s28, v243
    v_fma_f32 v149, v149, s28, v243
    v_fma_f32 v150, v150, s28, v243
    v_fma_f32 v151, v151, s28, v243
    v_exp_f32 v144, v144
    v_exp_f32 v145, v145
    v_exp_f32 v146, v146
    v_exp_f32 v147, v147
    v_exp_f32 v148, v148
    v_exp_f32 v149, v149
    v_exp_f32 v150, v150
    v_exp_f32 v151, v151
    v_add_f32 v230, v230, v144
    v_add_f32 v230, v230, v145
    v_add_f32 v230, v230, v146
    v_add_f32 v230, v230, v147
    v_add_f32 v230, v230, v148
    v_add_f32 v230, v230, v149
    v_add_f32 v230, v230, v150
    v_add_f32 v230, v230, v151
    v_cvt_pk_bf16_f32 v200, v144, v145
    v_cvt_pk_bf16_f32 v201, v146, v147
    v_cvt_pk_bf16_f32 v202, v148, v149
    v_cvt_pk_bf16_f32 v203, v150, v151
    v_max3_f32 v240, v152, v153, v154
    v_max3_f32 v240, v240, v155, v156
    v_max3_f32 v240, v240, v157, v158
    v_max3_f32 v240, v240, v159, v227
    v_mov_b32 v241, v240
    s_nop 1
    v_permlane16_swap_b32 v240, v241
    v_max_f32 v240, v240, v241
    v_mov_b32 v241, v240
    s_nop 1
    v_permlane32_swap_b32 v240, v241
    v_max_f32 v240, v240, v241
    v_sub_f32 v242, v227, v240
    v_mul_f32 v242, s28, v242
    v_exp_f32 v242, v242
    v_mov_b32 v227, v240
    v_mul_f32 v243, s51, v240
    v_mul_f32 v231, v231, v242
    v_mul_f32 v96, v96, v242
    v_mul_f32 v97, v97, v242
    v_mul_f32 v98, v98, v242
    v_mul_f32 v99, v99, v242
    v_mul_f32 v100, v100, v242
    v_mul_f32 v101, v101, v242
    v_mul_f32 v102, v102, v242
    v_mul_f32 v103, v103, v242
    v_mul_f32 v104, v104, v242
    v_mul_f32 v105, v105, v242
    v_mul_f32 v106, v106, v242
    v_mul_f32 v107, v107, v242
    v_mul_f32 v108, v108, v242
    v_mul_f32 v109, v109, v242
    v_mul_f32 v110, v110, v242
    v_mul_f32 v111, v111, v242
    v_mul_f32 v112, v112, v242
    v_mul_f32 v113, v113, v242
    v_mul_f32 v114, v114, v242
    v_mul_f32 v115, v115, v242
    v_mul_f32 v116, v116, v242
    v_mul_f32 v117, v117, v242
    v_mul_f32 v118, v118, v242
    v_mul_f32 v119, v119, v242
    v_mul_f32 v120, v120, v242
    v_mul_f32 v121, v121, v242
    v_mul_f32 v122, v122, v242
    v_mul_f32 v123, v123, v242
    v_mul_f32 v124, v124, v242
    v_mul_f32 v125, v125, v242
    v_mul_f32 v126, v126, v242
    v_mul_f32 v127, v127, v242
    v_fma_f32 v152, v152, s28, v243
    v_fma_f32 v153, v153, s28, v243
    v_fma_f32 v154, v154, s28, v243
    v_fma_f32 v155, v155, s28, v243
    v_fma_f32 v156, v156, s28, v243
    v_fma_f32 v157, v157, s28, v243
    v_fma_f32 v158, v158, s28, v243
    v_fma_f32 v159, v159, s28, v243
    v_exp_f32 v152, v152
    v_exp_f32 v153, v153
    v_exp_f32 v154, v154
    v_exp_f32 v155, v155
    v_exp_f32 v156, v156
    v_exp_f32 v157, v157
    v_exp_f32 v158, v158
    v_exp_f32 v159, v159
    v_add_f32 v231, v231, v152
    v_add_f32 v231, v231, v153
    v_add_f32 v231, v231, v154
    v_add_f32 v231, v231, v155
    v_add_f32 v231, v231, v156
    v_add_f32 v231, v231, v157
    v_add_f32 v231, v231, v158
    v_add_f32 v231, v231, v159
    v_cvt_pk_bf16_f32 v204, v152, v153
    v_cvt_pk_bf16_f32 v205, v154, v155
    v_cvt_pk_bf16_f32 v206, v156, v157
    v_cvt_pk_bf16_f32 v207, v158, v159
    ds_read_b64_tr_b16 a[160:161], v235 offset:0
    ds_read_b64_tr_b16 a[162:163], v235 offset:256
    ds_read_b64_tr_b16 a[164:165], v235 offset:32
    ds_read_b64_tr_b16 a[166:167], v235 offset:288
    s_waitcnt lgkmcnt(2)
    v_mfma_f32_16x16x32_bf16 v[0:3], a[160:163], v[192:195], v[0:3]
    s_waitcnt lgkmcnt(0)
    v_mfma_f32_16x16x32_bf16 v[4:7], a[164:167], v[192:195], v[4:7]
    v_mfma_f32_16x16x32_bf16 v[32:35], a[160:163], v[196:199], v[32:35]
    v_mfma_f32_16x16x32_bf16 v[36:39], a[164:167], v[196:199], v[36:39]
    v_mfma_f32_16x16x32_bf16 v[64:67], a[160:163], v[200:203], v[64:67]
    v_mfma_f32_16x16x32_bf16 v[68:71], a[164:167], v[200:203], v[68:71]
    v_mfma_f32_16x16x32_bf16 v[96:99], a[160:163], v[204:207], v[96:99]
    v_mfma_f32_16x16x32_bf16 v[100:103], a[164:167], v[204:207], v[100:103]
    ds_read_b64_tr_b16 a[168:169], v235 offset:64
    ds_read_b64_tr_b16 a[170:171], v235 offset:320
    ds_read_b64_tr_b16 a[172:173], v235 offset:96
    ds_read_b64_tr_b16 a[174:175], v235 offset:352
    s_waitcnt lgkmcnt(2)
    v_mfma_f32_16x16x32_bf16 v[8:11], a[168:171], v[192:195], v[8:11]
    s_waitcnt lgkmcnt(0)
    v_mfma_f32_16x16x32_bf16 v[12:15], a[172:175], v[192:195], v[12:15]
    v_mfma_f32_16x16x32_bf16 v[40:43], a[168:171], v[196:199], v[40:43]
    v_mfma_f32_16x16x32_bf16 v[44:47], a[172:175], v[196:199], v[44:47]
    v_mfma_f32_16x16x32_bf16 v[72:75], a[168:171], v[200:203], v[72:75]
    v_mfma_f32_16x16x32_bf16 v[76:79], a[172:175], v[200:203], v[76:79]
    v_mfma_f32_16x16x32_bf16 v[104:107], a[168:171], v[204:207], v[104:107]
    v_mfma_f32_16x16x32_bf16 v[108:111], a[172:175], v[204:207], v[108:111]
    ds_read_b64_tr_b16 a[160:161], v235 offset:128
    ds_read_b64_tr_b16 a[162:163], v235 offset:384
    ds_read_b64_tr_b16 a[164:165], v235 offset:160
    ds_read_b64_tr_b16 a[166:167], v235 offset:416
    s_waitcnt lgkmcnt(2)
    v_mfma_f32_16x16x32_bf16 v[16:19], a[160:163], v[192:195], v[16:19]
    s_waitcnt lgkmcnt(0)
    v_mfma_f32_16x16x32_bf16 v[20:23], a[164:167], v[192:195], v[20:23]
    v_mfma_f32_16x16x32_bf16 v[48:51], a[160:163], v[196:199], v[48:51]
    v_mfma_f32_16x16x32_bf16 v[52:55], a[164:167], v[196:199], v[52:55]
    v_mfma_f32_16x16x32_bf16 v[80:83], a[160:163], v[200:203], v[80:83]
    v_mfma_f32_16x16x32_bf16 v[84:87], a[164:167], v[200:203], v[84:87]
    v_mfma_f32_16x16x32_bf16 v[112:115], a[160:163], v[204:207], v[112:115]
    v_mfma_f32_16x16x32_bf16 v[116:119], a[164:167], v[204:207], v[116:119]
    ds_read_b64_tr_b16 a[168:169], v235 offset:192
    ds_read_b64_tr_b16 a[170:171], v235 offset:448
    ds_read_b64_tr_b16 a[172:173], v235 offset:224
    ds_read_b64_tr_b16 a[174:175], v235 offset:480
    s_waitcnt lgkmcnt(2)
    v_mfma_f32_16x16x32_bf16 v[24:27], a[168:171], v[192:195], v[24:27]
    s_waitcnt lgkmcnt(0)
    v_mfma_f32_16x16x32_bf16 v[28:31], a[172:175], v[192:195], v[28:31]
    v_mfma_f32_16x16x32_bf16 v[56:59], a[168:171], v[196:199], v[56:59]
    v_mfma_f32_16x16x32_bf16 v[60:63], a[172:175], v[196:199], v[60:63]
    v_mfma_f32_16x16x32_bf16 v[88:91], a[168:171], v[200:203], v[88:91]
    v_mfma_f32_16x16x32_bf16 v[92:95], a[172:175], v[200:203], v[92:95]
    v_mfma_f32_16x16x32_bf16 v[120:123], a[168:171], v[204:207], v[120:123]
    v_mfma_f32_16x16x32_bf16 v[124:127], a[172:175], v[204:207], v[124:127]
    ds_read_b128 a[128:131], v233 offset:512
    ds_read_b128 a[132:135], v233 offset:576
    ds_read_b128 a[136:139], v233 offset:640
    ds_read_b128 a[140:143], v233 offset:704
    ds_read_b128 a[144:147], v233 offset:768
    ds_read_b128 a[148:151], v233 offset:832
    ds_read_b128 a[152:155], v233 offset:896
    ds_read_b128 a[156:159], v233 offset:960
    s_waitcnt lgkmcnt(7)
    v_mfma_f32_16x16x32_bf16 v[128:131], a[128:131], a[0:3], 0
    s_waitcnt lgkmcnt(6)
    v_mfma_f32_16x16x32_bf16 v[128:131], a[132:135], a[4:7], v[128:131]
    s_waitcnt lgkmcnt(5)
    v_mfma_f32_16x16x32_bf16 v[128:131], a[136:139], a[8:11], v[128:131]
    s_waitcnt lgkmcnt(4)
    v_mfma_f32_16x16x32_bf16 v[128:131], a[140:143], a[12:15], v[128:131]
    v_mfma_f32_16x16x32_bf16 v[136:139], a[128:131], a[16:19], 0
    v_mfma_f32_16x16x32_bf16 v[136:139], a[132:135], a[20:23], v[136:139]
    v_mfma_f32_16x16x32_bf16 v[136:139], a[136:139], a[24:27], v[136:139]
    v_mfma_f32_16x16x32_bf16 v[136:139], a[140:143], a[28:31], v[136:139]
    v_mfma_f32_16x16x32_bf16 v[144:147], a[128:131], a[32:35], 0
    v_mfma_f32_16x16x32_bf16 v[144:147], a[132:135], a[36:39], v[144:147]
    v_mfma_f32_16x16x32_bf16 v[144:147], a[136:139], a[40:43], v[144:147]
    v_mfma_f32_16x16x32_bf16 v[144:147], a[140:143], a[44:47], v[144:147]
    v_mfma_f32_16x16x32_bf16 v[152:155], a[128:131], a[48:51], 0
    v_mfma_f32_16x16x32_bf16 v[152:155], a[132:135], a[52:55], v[152:155]
    v_mfma_f32_16x16x32_bf16 v[152:155], a[136:139], a[56:59], v[152:155]
    v_mfma_f32_16x16x32_bf16 v[152:155], a[140:143], a[60:63], v[152:155]
    s_waitcnt lgkmcnt(3)
    v_mfma_f32_16x16x32_bf16 v[132:135], a[144:147], a[0:3], 0
    s_waitcnt lgkmcnt(2)
    v_mfma_f32_16x16x32_bf16 v[132:135], a[148:151], a[4:7], v[132:135]
    s_waitcnt lgkmcnt(1)
    v_mfma_f32_16x16x32_bf16 v[132:135], a[152:155], a[8:11], v[132:135]
    s_waitcnt lgkmcnt(0)
    v_mfma_f32_16x16x32_bf16 v[132:135], a[156:159], a[12:15], v[132:135]
    v_mfma_f32_16x16x32_bf16 v[140:143], a[144:147], a[16:19], 0
    v_mfma_f32_16x16x32_bf16 v[140:143], a[148:151], a[20:23], v[140:143]
    v_mfma_f32_16x16x32_bf16 v[140:143], a[152:155], a[24:27], v[140:143]
    v_mfma_f32_16x16x32_bf16 v[140:143], a[156:159], a[28:31], v[140:143]
    v_mfma_f32_16x16x32_bf16 v[148:151], a[144:147], a[32:35], 0
    v_mfma_f32_16x16x32_bf16 v[148:151], a[148:151], a[36:39], v[148:151]
    v_mfma_f32_16x16x32_bf16 v[148:151], a[152:155], a[40:43], v[148:151]
    v_mfma_f32_16x16x32_bf16 v[148:151], a[156:159], a[44:47], v[148:151]
    v_mfma_f32_16x16x32_bf16 v[156:159], a[144:147], a[48:51], 0
    v_mfma_f32_16x16x32_bf16 v[156:159], a[148:151], a[52:55], v[156:159]
    v_mfma_f32_16x16x32_bf16 v[156:159], a[152:155], a[56:59], v[156:159]
    v_mfma_f32_16x16x32_bf16 v[156:159], a[156:159], a[60:63], v[156:159]
    v_max3_f32 v240, v128, v129, v130
    v_max3_f32 v240, v240, v131, v132
    v_max3_f32 v240, v240, v133, v134
    v_max3_f32 v240, v240, v135, v224
    v_mov_b32 v241, v240
    s_nop 1
    v_permlane16_swap_b32 v240, v241
    v_max_f32 v240, v240, v241
    v_mov_b32 v241, v240
    s_nop 1
    v_permlane32_swap_b32 v240, v241
    v_max_f32 v240, v240, v241
    v_sub_f32 v242, v224, v240
    v_mul_f32 v242, s28, v242
    v_exp_f32 v242, v242
    v_mov_b32 v224, v240
    v_mul_f32 v243, s51, v240
    v_mul_f32 v228, v228, v242
    v_mul_f32 v0, v0, v242
    v_mul_f32 v1, v1, v242
    v_mul_f32 v2, v2, v242
    v_mul_f32 v3, v3, v242
    v_mul_f32 v4, v4, v242
    v_mul_f32 v5, v5, v242
    v_mul_f32 v6, v6, v242
    v_mul_f32 v7, v7, v242
    v_mul_f32 v8, v8, v242
    v_mul_f32 v9, v9, v242
    v_mul_f32 v10, v10, v242
    v_mul_f32 v11, v11, v242
    v_mul_f32 v12, v12, v242
    v_mul_f32 v13, v13, v242
    v_mul_f32 v14, v14, v242
    v_mul_f32 v15, v15, v242
    v_mul_f32 v16, v16, v242
    v_mul_f32 v17, v17, v242
    v_mul_f32 v18, v18, v242
    v_mul_f32 v19, v19, v242
    v_mul_f32 v20, v20, v242
    v_mul_f32 v21, v21, v242
    v_mul_f32 v22, v22, v242
    v_mul_f32 v23, v23, v242
    v_mul_f32 v24, v24, v242
    v_mul_f32 v25, v25, v242
    v_mul_f32 v26, v26, v242
    v_mul_f32 v27, v27, v242
    v_mul_f32 v28, v28, v242
    v_mul_f32 v29, v29, v242
    v_mul_f32 v30, v30, v242
    v_mul_f32 v31, v31, v242
    v_fma_f32 v128, v128, s28, v243
    v_fma_f32 v129, v129, s28, v243
    v_fma_f32 v130, v130, s28, v243
    v_fma_f32 v131, v131, s28, v243
    v_fma_f32 v132, v132, s28, v243
    v_fma_f32 v133, v133, s28, v243
    v_fma_f32 v134, v134, s28, v243
    v_fma_f32 v135, v135, s28, v243
    v_exp_f32 v128, v128
    v_exp_f32 v129, v129
    v_exp_f32 v130, v130
    v_exp_f32 v131, v131
    v_exp_f32 v132, v132
    v_exp_f32 v133, v133
    v_exp_f32 v134, v134
    v_exp_f32 v135, v135
    v_add_f32 v228, v228, v128
    v_add_f32 v228, v228, v129
    v_add_f32 v228, v228, v130
    v_add_f32 v228, v228, v131
    v_add_f32 v228, v228, v132
    v_add_f32 v228, v228, v133
    v_add_f32 v228, v228, v134
    v_add_f32 v228, v228, v135
    v_cvt_pk_bf16_f32 v192, v128, v129
    v_cvt_pk_bf16_f32 v193, v130, v131
    v_cvt_pk_bf16_f32 v194, v132, v133
    v_cvt_pk_bf16_f32 v195, v134, v135
    v_max3_f32 v240, v136, v137, v138
    v_max3_f32 v240, v240, v139, v140
    v_max3_f32 v240, v240, v141, v142
    v_max3_f32 v240, v240, v143, v225
    v_mov_b32 v241, v240
    s_nop 1
    v_permlane16_swap_b32 v240, v241
    v_max_f32 v240, v240, v241
    v_mov_b32 v241, v240
    s_nop 1
    v_permlane32_swap_b32 v240, v241
    v_max_f32 v240, v240, v241
    v_sub_f32 v242, v225, v240
    v_mul_f32 v242, s28, v242
    v_exp_f32 v242, v242
    v_mov_b32 v225, v240
    v_mul_f32 v243, s51, v240
    v_mul_f32 v229, v229, v242
    v_mul_f32 v32, v32, v242
    v_mul_f32 v33, v33, v242
    v_mul_f32 v34, v34, v242
    v_mul_f32 v35, v35, v242
    v_mul_f32 v36, v36, v242
    v_mul_f32 v37, v37, v242
    v_mul_f32 v38, v38, v242
    v_mul_f32 v39, v39, v242
    v_mul_f32 v40, v40, v242
    v_mul_f32 v41, v41, v242
    v_mul_f32 v42, v42, v242
    v_mul_f32 v43, v43, v242
    v_mul_f32 v44, v44, v242
    v_mul_f32 v45, v45, v242
    v_mul_f32 v46, v46, v242
    v_mul_f32 v47, v47, v242
    v_mul_f32 v48, v48, v242
    v_mul_f32 v49, v49, v242
    v_mul_f32 v50, v50, v242
    v_mul_f32 v51, v51, v242
    v_mul_f32 v52, v52, v242
    v_mul_f32 v53, v53, v242
    v_mul_f32 v54, v54, v242
    v_mul_f32 v55, v55, v242
    v_mul_f32 v56, v56, v242
    v_mul_f32 v57, v57, v242
    v_mul_f32 v58, v58, v242
    v_mul_f32 v59, v59, v242
    v_mul_f32 v60, v60, v242
    v_mul_f32 v61, v61, v242
    v_mul_f32 v62, v62, v242
    v_mul_f32 v63, v63, v242
    v_fma_f32 v136, v136, s28, v243
    v_fma_f32 v137, v137, s28, v243
    v_fma_f32 v138, v138, s28, v243
    v_fma_f32 v139, v139, s28, v243
    v_fma_f32 v140, v140, s28, v243
    v_fma_f32 v141, v141, s28, v243
    v_fma_f32 v142, v142, s28, v243
    v_fma_f32 v143, v143, s28, v243
    v_exp_f32 v136, v136
    v_exp_f32 v137, v137
    v_exp_f32 v138, v138
    v_exp_f32 v139, v139
    v_exp_f32 v140, v140
    v_exp_f32 v141, v141
    v_exp_f32 v142, v142
    v_exp_f32 v143, v143
    v_add_f32 v229, v229, v136
    v_add_f32 v229, v229, v137
    v_add_f32 v229, v229, v138
    v_add_f32 v229, v229, v139
    v_add_f32 v229, v229, v140
    v_add_f32 v229, v229, v141
    v_add_f32 v229, v229, v142
    v_add_f32 v229, v229, v143
    v_cvt_pk_bf16_f32 v196, v136, v137
    v_cvt_pk_bf16_f32 v197, v138, v139
    v_cvt_pk_bf16_f32 v198, v140, v141
    v_cvt_pk_bf16_f32 v199, v142, v143
    v_max3_f32 v240, v144, v145, v146
    v_max3_f32 v240, v240, v147, v148
    v_max3_f32 v240, v240, v149, v150
    v_max3_f32 v240, v240, v151, v226
    v_mov_b32 v241, v240
    s_nop 1
    v_permlane16_swap_b32 v240, v241
    v_max_f32 v240, v240, v241
    v_mov_b32 v241, v240
    s_nop 1
    v_permlane32_swap_b32 v240, v241
    v_max_f32 v240, v240, v241
    v_sub_f32 v242, v226, v240
    v_mul_f32 v242, s28, v242
    v_exp_f32 v242, v242
    v_mov_b32 v226, v240
    v_mul_f32 v243, s51, v240
    v_mul_f32 v230, v230, v242
    v_mul_f32 v64, v64, v242
    v_mul_f32 v65, v65, v242
    v_mul_f32 v66, v66, v242
    v_mul_f32 v67, v67, v242
    v_mul_f32 v68, v68, v242
    v_mul_f32 v69, v69, v242
    v_mul_f32 v70, v70, v242
    v_mul_f32 v71, v71, v242
    v_mul_f32 v72, v72, v242
    v_mul_f32 v73, v73, v242
    v_mul_f32 v74, v74, v242
    v_mul_f32 v75, v75, v242
    v_mul_f32 v76, v76, v242
    v_mul_f32 v77, v77, v242
    v_mul_f32 v78, v78, v242
    v_mul_f32 v79, v79, v242
    v_mul_f32 v80, v80, v242
    v_mul_f32 v81, v81, v242
    v_mul_f32 v82, v82, v242
    v_mul_f32 v83, v83, v242
    v_mul_f32 v84, v84, v242
    v_mul_f32 v85, v85, v242
    v_mul_f32 v86, v86, v242
    v_mul_f32 v87, v87, v242
    v_mul_f32 v88, v88, v242
    v_mul_f32 v89, v89, v242
    v_mul_f32 v90, v90, v242
    v_mul_f32 v91, v91, v242
    v_mul_f32 v92, v92, v242
    v_mul_f32 v93, v93, v242
    v_mul_f32 v94, v94, v242
    v_mul_f32 v95, v95, v242
    v_fma_f32 v144, v144, s28, v243
    v_fma_f32 v145, v145, s28, v243
    v_fma_f32 v146, v146, s28, v243
    v_fma_f32 v147, v147, s28, v243
    v_fma_f32 v148, v148, s28, v243
    v_fma_f32 v149, v149, s28, v243
    v_fma_f32 v150, v150, s28, v243
    v_fma_f32 v151, v151, s28, v243
    v_exp_f32 v144, v144
    v_exp_f32 v145, v145
    v_exp_f32 v146, v146
    v_exp_f32 v147, v147
    v_exp_f32 v148, v148
    v_exp_f32 v149, v149
    v_exp_f32 v150, v150
    v_exp_f32 v151, v151
    v_add_f32 v230, v230, v144
    v_add_f32 v230, v230, v145
    v_add_f32 v230, v230, v146
    v_add_f32 v230, v230, v147
    v_add_f32 v230, v230, v148
    v_add_f32 v230, v230, v149
    v_add_f32 v230, v230, v150
    v_add_f32 v230, v230, v151
    v_cvt_pk_bf16_f32 v200, v144, v145
    v_cvt_pk_bf16_f32 v201, v146, v147
    v_cvt_pk_bf16_f32 v202, v148, v149
    v_cvt_pk_bf16_f32 v203, v150, v151
    v_max3_f32 v240, v152, v153, v154
    v_max3_f32 v240, v240, v155, v156
    v_max3_f32 v240, v240, v157, v158
    v_max3_f32 v240, v240, v159, v227
    v_mov_b32 v241, v240
    s_nop 1
    v_permlane16_swap_b32 v240, v241
    v_max_f32 v240, v240, v241
    v_mov_b32 v241, v240
    s_nop 1
    v_permlane32_swap_b32 v240, v241
    v_max_f32 v240, v240, v241
    v_sub_f32 v242, v227, v240
    v_mul_f32 v242, s28, v242
    v_exp_f32 v242, v242
    v_mov_b32 v227, v240
    v_mul_f32 v243, s51, v240
    v_mul_f32 v231, v231, v242
    v_mul_f32 v96, v96, v242
    v_mul_f32 v97, v97, v242
    v_mul_f32 v98, v98, v242
    v_mul_f32 v99, v99, v242
    v_mul_f32 v100, v100, v242
    v_mul_f32 v101, v101, v242
    v_mul_f32 v102, v102, v242
    v_mul_f32 v103, v103, v242
    v_mul_f32 v104, v104, v242
    v_mul_f32 v105, v105, v242
    v_mul_f32 v106, v106, v242
    v_mul_f32 v107, v107, v242
    v_mul_f32 v108, v108, v242
    v_mul_f32 v109, v109, v242
    v_mul_f32 v110, v110, v242
    v_mul_f32 v111, v111, v242
    v_mul_f32 v112, v112, v242
    v_mul_f32 v113, v113, v242
    v_mul_f32 v114, v114, v242
    v_mul_f32 v115, v115, v242
    v_mul_f32 v116, v116, v242
    v_mul_f32 v117, v117, v242
    v_mul_f32 v118, v118, v242
    v_mul_f32 v119, v119, v242
    v_mul_f32 v120, v120, v242
    v_mul_f32 v121, v121, v242
    v_mul_f32 v122, v122, v242
    v_mul_f32 v123, v123, v242
    v_mul_f32 v124, v124, v242
    v_mul_f32 v125, v125, v242
    v_mul_f32 v126, v126, v242
    v_mul_f32 v127, v127, v242
    v_fma_f32 v152, v152, s28, v243
    v_fma_f32 v153, v153, s28, v243
    v_fma_f32 v154, v154, s28, v243
    v_fma_f32 v155, v155, s28, v243
    v_fma_f32 v156, v156, s28, v243
    v_fma_f32 v157, v157, s28, v243
    v_fma_f32 v158, v158, s28, v243
    v_fma_f32 v159, v159, s28, v243
    v_exp_f32 v152, v152
    v_exp_f32 v153, v153
    v_exp_f32 v154, v154
    v_exp_f32 v155, v155
    v_exp_f32 v156, v156
    v_exp_f32 v157, v157
    v_exp_f32 v158, v158
    v_exp_f32 v159, v159
    v_add_f32 v231, v231, v152
    v_add_f32 v231, v231, v153
    v_add_f32 v231, v231, v154
    v_add_f32 v231, v231, v155
    v_add_f32 v231, v231, v156
    v_add_f32 v231, v231, v157
    v_add_f32 v231, v231, v158
    v_add_f32 v231, v231, v159
    v_cvt_pk_bf16_f32 v204, v152, v153
    v_cvt_pk_bf16_f32 v205, v154, v155
    v_cvt_pk_bf16_f32 v206, v156, v157
    v_cvt_pk_bf16_f32 v207, v158, v159
    ds_read_b64_tr_b16 a[160:161], v235 offset:512
    ds_read_b64_tr_b16 a[162:163], v235 offset:768
    ds_read_b64_tr_b16 a[164:165], v235 offset:544
    ds_read_b64_tr_b16 a[166:167], v235 offset:800
    s_waitcnt lgkmcnt(2)
    v_mfma_f32_16x16x32_bf16 v[0:3], a[160:163], v[192:195], v[0:3]
    s_waitcnt lgkmcnt(0)
    v_mfma_f32_16x16x32_bf16 v[4:7], a[164:167], v[192:195], v[4:7]
    v_mfma_f32_16x16x32_bf16 v[32:35], a[160:163], v[196:199], v[32:35]
    v_mfma_f32_16x16x32_bf16 v[36:39], a[164:167], v[196:199], v[36:39]
    v_mfma_f32_16x16x32_bf16 v[64:67], a[160:163], v[200:203], v[64:67]
    v_mfma_f32_16x16x32_bf16 v[68:71], a[164:167], v[200:203], v[68:71]
    v_mfma_f32_16x16x32_bf16 v[96:99], a[160:163], v[204:207], v[96:99]
    v_mfma_f32_16x16x32_bf16 v[100:103], a[164:167], v[204:207], v[100:103]
    ds_read_b64_tr_b16 a[168:169], v235 offset:576
    ds_read_b64_tr_b16 a[170:171], v235 offset:832
    ds_read_b64_tr_b16 a[172:173], v235 offset:608
    ds_read_b64_tr_b16 a[174:175], v235 offset:864
    s_waitcnt lgkmcnt(2)
    v_mfma_f32_16x16x32_bf16 v[8:11], a[168:171], v[192:195], v[8:11]
    s_waitcnt lgkmcnt(0)
    v_mfma_f32_16x16x32_bf16 v[12:15], a[172:175], v[192:195], v[12:15]
    v_mfma_f32_16x16x32_bf16 v[40:43], a[168:171], v[196:199], v[40:43]
    v_mfma_f32_16x16x32_bf16 v[44:47], a[172:175], v[196:199], v[44:47]
    v_mfma_f32_16x16x32_bf16 v[72:75], a[168:171], v[200:203], v[72:75]
    v_mfma_f32_16x16x32_bf16 v[76:79], a[172:175], v[200:203], v[76:79]
    v_mfma_f32_16x16x32_bf16 v[104:107], a[168:171], v[204:207], v[104:107]
    v_mfma_f32_16x16x32_bf16 v[108:111], a[172:175], v[204:207], v[108:111]
    ds_read_b64_tr_b16 a[160:161], v235 offset:640
    ds_read_b64_tr_b16 a[162:163], v235 offset:896
    ds_read_b64_tr_b16 a[164:165], v235 offset:672
    ds_read_b64_tr_b16 a[166:167], v235 offset:928
    s_waitcnt lgkmcnt(2)
    v_mfma_f32_16x16x32_bf16 v[16:19], a[160:163], v[192:195], v[16:19]
    s_waitcnt lgkmcnt(0)
    v_mfma_f32_16x16x32_bf16 v[20:23], a[164:167], v[192:195], v[20:23]
    v_mfma_f32_16x16x32_bf16 v[48:51], a[160:163], v[196:199], v[48:51]
    v_mfma_f32_16x16x32_bf16 v[52:55], a[164:167], v[196:199], v[52:55]
    v_mfma_f32_16x16x32_bf16 v[80:83], a[160:163], v[200:203], v[80:83]
    v_mfma_f32_16x16x32_bf16 v[84:87], a[164:167], v[200:203], v[84:87]
    v_mfma_f32_16x16x32_bf16 v[112:115], a[160:163], v[204:207], v[112:115]
    v_mfma_f32_16x16x32_bf16 v[116:119], a[164:167], v[204:207], v[116:119]
    ds_read_b64_tr_b16 a[168:169], v235 offset:704
    ds_read_b64_tr_b16 a[170:171], v235 offset:960
    ds_read_b64_tr_b16 a[172:173], v235 offset:736
    ds_read_b64_tr_b16 a[174:175], v235 offset:992
    s_waitcnt lgkmcnt(2)
    v_mfma_f32_16x16x32_bf16 v[24:27], a[168:171], v[192:195], v[24:27]
    s_waitcnt lgkmcnt(0)
    v_mfma_f32_16x16x32_bf16 v[28:31], a[172:175], v[192:195], v[28:31]
    v_mfma_f32_16x16x32_bf16 v[56:59], a[168:171], v[196:199], v[56:59]
    v_mfma_f32_16x16x32_bf16 v[60:63], a[172:175], v[196:199], v[60:63]
    v_mfma_f32_16x16x32_bf16 v[88:91], a[168:171], v[200:203], v[88:91]
    v_mfma_f32_16x16x32_bf16 v[92:95], a[172:175], v[200:203], v[92:95]
    v_mfma_f32_16x16x32_bf16 v[120:123], a[168:171], v[204:207], v[120:123]
    v_mfma_f32_16x16x32_bf16 v[124:127], a[172:175], v[204:207], v[124:127]
    s_waitcnt lgkmcnt(0)
    s_add_u32 s83, s83, 16384
    s_add_u32 s45, s45, 1
    s_cmp_lt_u32 s45, 8
    s_nop 7
    s_nop 7
    s_cbranch_scc1 L_slow_stage
    v_mov_b32 v241, v228
    s_nop 1
    v_permlane16_swap_b32 v228, v241
    v_add_f32 v228, v228, v241
    v_mov_b32 v241, v228
    s_nop 1
    v_permlane32_swap_b32 v228, v241
    v_add_f32 v228, v228, v241
    v_rcp_f32 v228, v228
    v_mov_b32 v241, v229
    s_nop 1
    v_permlane16_swap_b32 v229, v241
    v_add_f32 v229, v229, v241
    v_mov_b32 v241, v229
    s_nop 1
    v_permlane32_swap_b32 v229, v241
    v_add_f32 v229, v229, v241
    v_rcp_f32 v229, v229
    v_mov_b32 v241, v230
    s_nop 1
    v_permlane16_swap_b32 v230, v241
    v_add_f32 v230, v230, v241
    v_mov_b32 v241, v230
    s_nop 1
    v_permlane32_swap_b32 v230, v241
    v_add_f32 v230, v230, v241
    v_rcp_f32 v230, v230
    v_mov_b32 v241, v231
    s_nop 1
    v_permlane16_swap_b32 v231, v241
    v_add_f32 v231, v231, v241
    v_mov_b32 v241, v231
    s_nop 1
    v_permlane32_swap_b32 v231, v241
    v_add_f32 v231, v231, v241
    v_rcp_f32 v231, v231
    v_xor_b32 v244, 64, v248
    v_xor_b32 v245, 64, v249
    v_pk_mul_f32 v[0:1], v[0:1], v[228:229] op_sel_hi:[1,0]
    v_pk_mul_f32 v[2:3], v[2:3], v[228:229] op_sel_hi:[1,0]
    v_pk_mul_f32 v[4:5], v[4:5], v[228:229] op_sel_hi:[1,0]
    v_pk_mul_f32 v[6:7], v[6:7], v[228:229] op_sel_hi:[1,0]
    v_cvt_pk_bf16_f32 v0, v0, v1
    v_cvt_pk_bf16_f32 v1, v2, v3
    v_cvt_pk_bf16_f32 v2, v4, v5
    v_cvt_pk_bf16_f32 v3, v6, v7
    v_pk_mul_f32 v[8:9], v[8:9], v[228:229] op_sel_hi:[1,0]
    v_pk_mul_f32 v[10:11], v[10:11], v[228:229] op_sel_hi:[1,0]
    v_pk_mul_f32 v[12:13], v[12:13], v[228:229] op_sel_hi:[1,0]
    v_pk_mul_f32 v[14:15], v[14:15], v[228:229] op_sel_hi:[1,0]
    v_cvt_pk_bf16_f32 v8, v8, v9
    v_cvt_pk_bf16_f32 v9, v10, v11
    v_cvt_pk_bf16_f32 v10, v12, v13
    v_cvt_pk_bf16_f32 v11, v14, v15
    v_pk_mul_f32 v[16:17], v[16:17], v[228:229] op_sel_hi:[1,0]
    v_pk_mul_f32 v[18:19], v[18:19], v[228:229] op_sel_hi:[1,0]
    v_pk_mul_f32 v[20:21], v[20:21], v[228:229] op_sel_hi:[1,0]
    v_pk_mul_f32 v[22:23], v[22:23], v[228:229] op_sel_hi:[1,0]
    v_cvt_pk_bf16_f32 v16, v16, v17
    v_cvt_pk_bf16_f32 v17, v18, v19
    v_cvt_pk_bf16_f32 v18, v20, v21
    v_cvt_pk_bf16_f32 v19, v22, v23
    v_pk_mul_f32 v[24:25], v[24:25], v[228:229] op_sel_hi:[1,0]
    v_pk_mul_f32 v[26:27], v[26:27], v[228:229] op_sel_hi:[1,0]
    v_pk_mul_f32 v[28:29], v[28:29], v[228:229] op_sel_hi:[1,0]
    v_pk_mul_f32 v[30:31], v[30:31], v[228:229] op_sel_hi:[1,0]
    v_cvt_pk_bf16_f32 v24, v24, v25
    v_cvt_pk_bf16_f32 v25, v26, v27
    v_cvt_pk_bf16_f32 v26, v28, v29
    v_cvt_pk_bf16_f32 v27, v30, v31
    ds_write_b64 v248, v[0:1] offset:0
    ds_write_b64 v249, v[2:3] offset:0
    ds_write_b64 v244, v[8:9] offset:0
    ds_write_b64 v245, v[10:11] offset:0
    ds_read_b128 a[192:195], v250 offset:0
    ds_read_b64 a[198:199], v250 offset:1024
    ds_read_b64 a[196:197], v250 offset:1032
    s_waitcnt lgkmcnt(2)
    buffer_store_dwordx4 a[192:195], v238, s[20:23], s52 offen offset:0
    s_waitcnt lgkmcnt(0)
    buffer_store_dwordx4 a[196:199], v238, s[20:23], s52 offen offset:2048
    ds_write_b64 v248, v[16:17] offset:2048
    ds_write_b64 v249, v[18:19] offset:2048
    ds_write_b64 v244, v[24:25] offset:2048
    ds_write_b64 v245, v[26:27] offset:2048
    ds_read_b128 a[200:203], v250 offset:2048
    ds_read_b64 a[206:207], v250 offset:3072
    ds_read_b64 a[204:205], v250 offset:3080
    s_waitcnt lgkmcnt(2)
    buffer_store_dwordx4 a[200:203], v238, s[20:23], s52 offen offset:128
    s_waitcnt lgkmcnt(0)
    buffer_store_dwordx4 a[204:207], v238, s[20:23], s52 offen offset:2176
    v_pk_mul_f32 v[32:33], v[32:33], v[228:229] op_sel:[0,1] op_sel_hi:[1,1]
    v_pk_mul_f32 v[34:35], v[34:35], v[228:229] op_sel:[0,1] op_sel_hi:[1,1]
    v_pk_mul_f32 v[36:37], v[36:37], v[228:229] op_sel:[0,1] op_sel_hi:[1,1]
    v_pk_mul_f32 v[38:39], v[38:39], v[228:229] op_sel:[0,1] op_sel_hi:[1,1]
    v_cvt_pk_bf16_f32 v32, v32, v33
    v_cvt_pk_bf16_f32 v33, v34, v35
    v_cvt_pk_bf16_f32 v34, v36, v37
    v_cvt_pk_bf16_f32 v35, v38, v39
    v_pk_mul_f32 v[40:41], v[40:41], v[228:229] op_sel:[0,1] op_sel_hi:[1,1]
    v_pk_mul_f32 v[42:43], v[42:43], v[228:229] op_sel:[0,1] op_sel_hi:[1,1]
    v_pk_mul_f32 v[44:45], v[44:45], v[228:229] op_sel:[0,1] op_sel_hi:[1,1]
    v_pk_mul_f32 v[46:47], v[46:47], v[228:229] op_sel:[0,1] op_sel_hi:[1,1]
    v_cvt_pk_bf16_f32 v40, v40, v41
    v_cvt_pk_bf16_f32 v41, v42, v43
    v_cvt_pk_bf16_f32 v42, v44, v45
    v_cvt_pk_bf16_f32 v43, v46, v47
    v_pk_mul_f32 v[48:49], v[48:49], v[228:229] op_sel:[0,1] op_sel_hi:[1,1]
    v_pk_mul_f32 v[50:51], v[50:51], v[228:229] op_sel:[0,1] op_sel_hi:[1,1]
    v_pk_mul_f32 v[52:53], v[52:53], v[228:229] op_sel:[0,1] op_sel_hi:[1,1]
    v_pk_mul_f32 v[54:55], v[54:55], v[228:229] op_sel:[0,1] op_sel_hi:[1,1]
    v_cvt_pk_bf16_f32 v48, v48, v49
    v_cvt_pk_bf16_f32 v49, v50, v51
    v_cvt_pk_bf16_f32 v50, v52, v53
    v_cvt_pk_bf16_f32 v51, v54, v55
    v_pk_mul_f32 v[56:57], v[56:57], v[228:229] op_sel:[0,1] op_sel_hi:[1,1]
    v_pk_mul_f32 v[58:59], v[58:59], v[228:229] op_sel:[0,1] op_sel_hi:[1,1]
    v_pk_mul_f32 v[60:61], v[60:61], v[228:229] op_sel:[0,1] op_sel_hi:[1,1]
    v_pk_mul_f32 v[62:63], v[62:63], v[228:229] op_sel:[0,1] op_sel_hi:[1,1]
    v_cvt_pk_bf16_f32 v56, v56, v57
    v_cvt_pk_bf16_f32 v57, v58, v59
    v_cvt_pk_bf16_f32 v58, v60, v61
    v_cvt_pk_bf16_f32 v59, v62, v63
    ds_write_b64 v248, v[32:33] offset:2048
    ds_write_b64 v249, v[34:35] offset:2048
    ds_write_b64 v244, v[40:41] offset:2048
    ds_write_b64 v245, v[42:43] offset:2048
    ds_read_b128 a[208:211], v250 offset:2048
    ds_read_b64 a[214:215], v250 offset:3072
    ds_read_b64 a[212:213], v250 offset:3080
    s_waitcnt lgkmcnt(2)
    buffer_store_dwordx4 a[208:211], v238, s[20:23], s53 offen offset:0
    s_waitcnt lgkmcnt(0)
    buffer_store_dwordx4 a[212:215], v238, s[20:23], s53 offen offset:2048
    ds_write_b64 v248, v[48:49] offset:4096
    ds_write_b64 v249, v[50:51] offset:4096
    ds_write_b64 v244, v[56:57] offset:4096
    ds_write_b64 v245, v[58:59] offset:4096
    ds_read_b128 a[216:219], v250 offset:4096
    ds_read_b64 a[222:223], v250 offset:5120
    ds_read_b64 a[220:221], v250 offset:5128
    s_waitcnt lgkmcnt(2)
    buffer_store_dwordx4 a[216:219], v238, s[20:23], s53 offen offset:128
    s_waitcnt lgkmcnt(0)
    buffer_store_dwordx4 a[220:223], v238, s[20:23], s53 offen offset:2176
    v_pk_mul_f32 v[64:65], v[64:65], v[230:231] op_sel_hi:[1,0]
    v_pk_mul_f32 v[66:67], v[66:67], v[230:231] op_sel_hi:[1,0]
    v_pk_mul_f32 v[68:69], v[68:69], v[230:231] op_sel_hi:[1,0]
    v_pk_mul_f32 v[70:71], v[70:71], v[230:231] op_sel_hi:[1,0]
    v_cvt_pk_bf16_f32 v64, v64, v65
    v_cvt_pk_bf16_f32 v65, v66, v67
    v_cvt_pk_bf16_f32 v66, v68, v69
    v_cvt_pk_bf16_f32 v67, v70, v71
    v_pk_mul_f32 v[72:73], v[72:73], v[230:231] op_sel_hi:[1,0]
    v_pk_mul_f32 v[74:75], v[74:75], v[230:231] op_sel_hi:[1,0]
    v_pk_mul_f32 v[76:77], v[76:77], v[230:231] op_sel_hi:[1,0]
    v_pk_mul_f32 v[78:79], v[78:79], v[230:231] op_sel_hi:[1,0]
    v_cvt_pk_bf16_f32 v72, v72, v73
    v_cvt_pk_bf16_f32 v73, v74, v75
    v_cvt_pk_bf16_f32 v74, v76, v77
    v_cvt_pk_bf16_f32 v75, v78, v79
    v_pk_mul_f32 v[80:81], v[80:81], v[230:231] op_sel_hi:[1,0]
    v_pk_mul_f32 v[82:83], v[82:83], v[230:231] op_sel_hi:[1,0]
    v_pk_mul_f32 v[84:85], v[84:85], v[230:231] op_sel_hi:[1,0]
    v_pk_mul_f32 v[86:87], v[86:87], v[230:231] op_sel_hi:[1,0]
    v_cvt_pk_bf16_f32 v80, v80, v81
    v_cvt_pk_bf16_f32 v81, v82, v83
    v_cvt_pk_bf16_f32 v82, v84, v85
    v_cvt_pk_bf16_f32 v83, v86, v87
    v_pk_mul_f32 v[88:89], v[88:89], v[230:231] op_sel_hi:[1,0]
    v_pk_mul_f32 v[90:91], v[90:91], v[230:231] op_sel_hi:[1,0]
    v_pk_mul_f32 v[92:93], v[92:93], v[230:231] op_sel_hi:[1,0]
    v_pk_mul_f32 v[94:95], v[94:95], v[230:231] op_sel_hi:[1,0]
    v_cvt_pk_bf16_f32 v88, v88, v89
    v_cvt_pk_bf16_f32 v89, v90, v91
    v_cvt_pk_bf16_f32 v90, v92, v93
    v_cvt_pk_bf16_f32 v91, v94, v95
    ds_write_b64 v248, v[64:65] offset:4096
    ds_write_b64 v249, v[66:67] offset:4096
    ds_write_b64 v244, v[72:73] offset:4096
    ds_write_b64 v245, v[74:75] offset:4096
    ds_read_b128 a[224:227], v250 offset:4096
    ds_read_b64 a[230:231], v250 offset:5120
    ds_read_b64 a[228:229], v250 offset:5128
    s_waitcnt lgkmcnt(2)
    buffer_store_dwordx4 a[224:227], v238, s[24:27], s54 offen offset:0
    s_waitcnt lgkmcnt(0)
    buffer_store_dwordx4 a[228:231], v238, s[24:27], s54 offen offset:2048
    ds_write_b64 v248, v[80:81] offset:0
    ds_write_b64 v249, v[82:83] offset:0
    ds_write_b64 v244, v[88:89] offset:0
    ds_write_b64 v245, v[90:91] offset:0
    ds_read_b128 a[232:235], v250 offset:0
    ds_read_b64 a[238:239], v250 offset:1024
    ds_read_b64 a[236:237], v250 offset:1032
    s_waitcnt lgkmcnt(2)
    buffer_store_dwordx4 a[232:235], v238, s[24:27], s54 offen offset:128
    s_waitcnt lgkmcnt(0)
    buffer_store_dwordx4 a[236:239], v238, s[24:27], s54 offen offset:2176
    v_pk_mul_f32 v[96:97], v[96:97], v[230:231] op_sel:[0,1] op_sel_hi:[1,1]
    v_pk_mul_f32 v[98:99], v[98:99], v[230:231] op_sel:[0,1] op_sel_hi:[1,1]
    v_pk_mul_f32 v[100:101], v[100:101], v[230:231] op_sel:[0,1] op_sel_hi:[1,1]
    v_pk_mul_f32 v[102:103], v[102:103], v[230:231] op_sel:[0,1] op_sel_hi:[1,1]
    v_cvt_pk_bf16_f32 v96, v96, v97
    v_cvt_pk_bf16_f32 v97, v98, v99
    v_cvt_pk_bf16_f32 v98, v100, v101
    v_cvt_pk_bf16_f32 v99, v102, v103
    v_pk_mul_f32 v[104:105], v[104:105], v[230:231] op_sel:[0,1] op_sel_hi:[1,1]
    v_pk_mul_f32 v[106:107], v[106:107], v[230:231] op_sel:[0,1] op_sel_hi:[1,1]
    v_pk_mul_f32 v[108:109], v[108:109], v[230:231] op_sel:[0,1] op_sel_hi:[1,1]
    v_pk_mul_f32 v[110:111], v[110:111], v[230:231] op_sel:[0,1] op_sel_hi:[1,1]
    v_cvt_pk_bf16_f32 v104, v104, v105
    v_cvt_pk_bf16_f32 v105, v106, v107
    v_cvt_pk_bf16_f32 v106, v108, v109
    v_cvt_pk_bf16_f32 v107, v110, v111
    v_pk_mul_f32 v[112:113], v[112:113], v[230:231] op_sel:[0,1] op_sel_hi:[1,1]
    v_pk_mul_f32 v[114:115], v[114:115], v[230:231] op_sel:[0,1] op_sel_hi:[1,1]
    v_pk_mul_f32 v[116:117], v[116:117], v[230:231] op_sel:[0,1] op_sel_hi:[1,1]
    v_pk_mul_f32 v[118:119], v[118:119], v[230:231] op_sel:[0,1] op_sel_hi:[1,1]
    v_cvt_pk_bf16_f32 v112, v112, v113
    v_cvt_pk_bf16_f32 v113, v114, v115
    v_cvt_pk_bf16_f32 v114, v116, v117
    v_cvt_pk_bf16_f32 v115, v118, v119
    v_pk_mul_f32 v[120:121], v[120:121], v[230:231] op_sel:[0,1] op_sel_hi:[1,1]
    v_pk_mul_f32 v[122:123], v[122:123], v[230:231] op_sel:[0,1] op_sel_hi:[1,1]
    v_pk_mul_f32 v[124:125], v[124:125], v[230:231] op_sel:[0,1] op_sel_hi:[1,1]
    v_pk_mul_f32 v[126:127], v[126:127], v[230:231] op_sel:[0,1] op_sel_hi:[1,1]
    v_cvt_pk_bf16_f32 v120, v120, v121
    v_cvt_pk_bf16_f32 v121, v122, v123
    v_cvt_pk_bf16_f32 v122, v124, v125
    v_cvt_pk_bf16_f32 v123, v126, v127
    ds_write_b64 v248, v[96:97] offset:0
    ds_write_b64 v249, v[98:99] offset:0
    ds_write_b64 v244, v[104:105] offset:0
    ds_write_b64 v245, v[106:107] offset:0
    ds_read_b128 a[240:243], v250 offset:0
    ds_read_b64 a[246:247], v250 offset:1024
    ds_read_b64 a[244:245], v250 offset:1032
    s_waitcnt lgkmcnt(2)
    buffer_store_dwordx4 a[240:243], v238, s[24:27], s55 offen offset:0
    s_waitcnt lgkmcnt(0)
    buffer_store_dwordx4 a[244:247], v238, s[24:27], s55 offen offset:2048
    ds_write_b64 v248, v[112:113] offset:2048
    ds_write_b64 v249, v[114:115] offset:2048
    ds_write_b64 v244, v[120:121] offset:2048
    ds_write_b64 v245, v[122:123] offset:2048
    ds_read_b128 a[248:251], v250 offset:2048
    ds_read_b64 a[254:255], v250 offset:3072
    ds_read_b64 a[252:253], v250 offset:3080
    s_waitcnt lgkmcnt(2)
    buffer_store_dwordx4 a[248:251], v238, s[24:27], s55 offen offset:128
    s_waitcnt lgkmcnt(0)
    buffer_store_dwordx4 a[252:255], v238, s[24:27], s55 offen offset:2176
    s_waitcnt vmcnt(0)
L_slow_next:
    s_lshl_b32 s47, s47, 1
    s_mov_b32 s84, s85
    s_mov_b32 s85, s86
    s_mov_b32 s87, s88
    s_mov_b32 s88, s89
    s_mov_b32 s90, s91
    s_mov_b32 s91, s92
    s_add_u32 s46, s46, 1
    s_cmp_lt_u32 s46, 3
    s_cbranch_scc1 L_slow_item
L_end:
    s_endpgm
.section .rodata,"a"
.p2align 6
.amdhsa_kernel standalone__mha_softmax__near_ridge_kernel
  .amdhsa_next_free_vgpr 512
  .amdhsa_next_free_sgpr 102
  .amdhsa_accum_offset 256
  .amdhsa_group_segment_fixed_size 0
  .amdhsa_kernarg_size 48
  .amdhsa_user_sgpr_count 2
  .amdhsa_user_sgpr_kernarg_segment_ptr 1
  .amdhsa_system_sgpr_workgroup_id_x 1
.end_amdhsa_kernel
```
